```python
import torch

def _softmax(x, axis=-1):
    return torch.softmax(x, dim=axis)
def _gelu(x):
    return torch.nn.functional.gelu(x, approximate="tanh")
def _silu(x):
    return torch.nn.functional.silu(x)
def _sigmoid(x):
    return torch.sigmoid(x)
def _layernorm(x, axis=-1, eps=1e-5):
    m = x.mean(dim=axis, keepdim=True)
    v = x.var(dim=axis, keepdim=True, unbiased=False)
    return (x - m) / torch.sqrt(v + eps)
def _scatter_add(tgt, idx, src, axis=0):
    return tgt.clone().index_add_(axis, idx, src)
def _segment_sum(src, seg, n):
    out = torch.zeros((n,) + src.shape[1:], dtype=src.dtype)
    return out.index_add_(0, seg, src)
def _pad(x, pw):
    flat = tuple(v for pair in reversed(pw) for v in pair)
    return torch.nn.functional.pad(x, flat)

kernel_name = 'interleave_layers__gqa_block_cached__glu_gated_bilinear__decode'

def setup_inputs():

    _w = (lambda a: (lambda t: t.to(torch.bfloat16) if t.is_floating_point() else t)(torch.as_tensor(a)))
    def _A_setup():
        B, Sq, D = 1, 1, 512
        Hq, Hkv, Sk, Dh = 32, 32, 32768, 128
        assert Hq % Hkv == 0, (Hq, Hkv)
        return {
            "x": _w((lambda *s: torch.randn(*s, dtype=torch.bfloat16) * 0.1)(B, Sq, D)),
            "k_cache": _w((lambda *s: torch.randn(*s, dtype=torch.bfloat16) * 0.8)(B, Hkv, Sk, Dh)),
            "v_cache": _w((lambda *s: torch.randn(*s, dtype=torch.bfloat16) * 3.2)(B, Hkv, Sk, Dh)),
            "wq": _w((lambda *s: torch.randn(*s, dtype=torch.bfloat16) * 0.8)(D, Hq * Dh) * (D ** -0.5)),
            "wo": _w((lambda *s: torch.randn(*s, dtype=torch.bfloat16) * 3.2)(Hq * Dh, D) * ((Hq * Dh) ** -0.5)),
        }
    _A_in = _A_setup()

    def _B_setup():
        B, S, D, F = 1, 1, 512, 1376
        return {
            "x": _w((lambda *s: torch.randn(*s, dtype=torch.bfloat16) * 0.1)(B, S, D)),
            "w_gate": _w((lambda *s: torch.randn(*s, dtype=torch.bfloat16) * 0.8)(D, F) * (D ** -0.5)),
            "w_up": _w((lambda *s: torch.randn(*s, dtype=torch.bfloat16) * 0.8)(D, F) * (D ** -0.5)),
            "w_down": _w((lambda *s: torch.randn(*s, dtype=torch.bfloat16) * 0.8)(F, D) * (F ** -0.5)),
        }
    _B_in = _B_setup()

    return {
        "A_x": _A_in["x"],
        "A_k_cache": _A_in["k_cache"],
        "A_v_cache": _A_in["v_cache"],
        "A_wq": _A_in["wq"],
        "A_wo": _A_in["wo"],
        "B_x": _B_in["x"],
        "B_w_gate": _B_in["w_gate"],
        "B_w_up": _B_in["w_up"],
        "B_w_down": _B_in["w_down"],
    }

def reference(A_x, A_k_cache, A_v_cache, A_wq, A_wo, B_x, B_w_gate, B_w_up, B_w_down):
    def _A_ref(x, k_cache, v_cache, wq, wo):
        B, Sq, D = x.shape
        Hq, Dh = 32, 128
        Hkv = k_cache.shape[1]
        rep = Hq // Hkv
        q = (lambda x, *d: x.permute(*d))((x @ wq).reshape(B, Sq, Hq, Dh), 0, 2, 1, 3)
        k = (lambda x, n, axis: torch.repeat_interleave(x, n, dim=axis))(k_cache, rep, axis=1)
        v = (lambda x, n, axis: torch.repeat_interleave(x, n, dim=axis))(v_cache, rep, axis=1)
        scores = torch.einsum("bhqd,bhkd->bhqk", q, k) * (Dh ** -0.5)
        p = _softmax(scores, axis=-1)
        o = torch.einsum("bhqk,bhkd->bhqd", p, v)
        return (lambda x, *d: x.permute(*d))(o, 0, 2, 1, 3).reshape(B, Sq, Hq * Dh) @ wo

    def _B_ref(x, w_gate, w_up, w_down):
        g = torch.einsum("bsd,df->bsf", x, w_gate)
        u = torch.einsum("bsd,df->bsf", x, w_up)
        h = g * u
        return torch.einsum("bsf,fd->bsd", h, w_down)

    x = A_x
    x = x + _A_ref(_layernorm(x, axis=-1), A_k_cache, A_v_cache, A_wq, A_wo)
    x = x + _B_ref(_layernorm(x, axis=-1), B_w_gate, B_w_up, B_w_down)
    x = x + _A_ref(_layernorm(x, axis=-1), A_k_cache, A_v_cache, A_wq, A_wo)
    x = x + _B_ref(_layernorm(x, axis=-1), B_w_gate, B_w_up, B_w_down)
    return x
```

```asm
; @launch grid=(256,1,1) block=(256,1,1) lds=163840
.amdgcn_target "amdgcn-amd-amdhsa--gfx950"
.text
.globl interleave_layers__gqa_block_cached__glu_gated_bilinear__decode_kernel
.p2align 8
.type interleave_layers__gqa_block_cached__glu_gated_bilinear__decode_kernel,@function
interleave_layers__gqa_block_cached__glu_gated_bilinear__decode_kernel:
s_cmp_ge_u32 s2, 256
s_cbranch_scc1 END
s_load_dwordx16 s[24:39], s[0:1], 0
s_load_dwordx8 s[40:47], s[0:1], 64
v_lshrrev_b32 v1, 6, v0
v_and_b32 v0, 63, v0
v_readfirstlane_b32 s3, v1
v_lshlrev_b32 v1, 4, v0
s_lshr_b32 s48, s2, 3
s_and_b32 s49, s2, 7
s_and_b32 s57, s2, 3
s_lshr_b32 s58, s49, 2
s_lshr_b32 s59, s3, 1
s_xor_b32 s58, s58, s59
s_xor_b32 s58, s58, s57
s_lshl_b32 s61, s57, 21
s_xor_b32 s59, s57, s58
s_and_b32 s59, s59, 1
s_lshl_b32 s59, s59, 13
s_add_u32 s61, s61, s59
s_lshr_b32 s59, s3, 1
s_lshl_b32 s59, s59, 14
s_add_u32 s61, s61, s59
s_and_b32 s59, s3, 1
s_lshl_b32 s59, s59, 12
s_add_u32 s61, s61, s59
s_mov_b32 s53, 0
s_mov_b32 s70, 1
s_mov_b32 s71, 2
s_mov_b32 s54, 300000
s_waitcnt lgkmcnt(0)
s_lshl_b32 s57, s48, 23
s_add_u32 s8, s26, s57
s_addc_u32 s9, s27, 0
s_and_b32 s9, s9, 0xffff
s_mov_b32 s10, 0x800000
s_mov_b32 s11, 0x20000
s_add_u32 s12, s28, s57
s_addc_u32 s13, s29, 0
s_and_b32 s13, s13, 0xffff
s_mov_b32 s14, 0x800000
s_mov_b32 s15, 0x20000
s_mov_b32 s16, s46
s_and_b32 s17, s47, 0xffff
s_mov_b32 s18, 0x1000000
s_mov_b32 s19, 0x20000
s_and_b32 s57, s48, 7
s_xor_b32 s78, s57, s49
s_cbranch_scc1 SK_1
s_and_b32 s57, s61, 0xffffdfff
s_and_b32 s58, s3, 1
s_lshl_b32 s58, s58, 13
s_add_u32 s57, s57, 2064384
s_add_u32 s57, s57, s58
s_xor_b32 s58, s57, 0x2000
s_mov_b64 exec, 1
s_cmp_ge_u32 s3, 2
s_cbranch_scc1 SK_2
buffer_load_dword v20, v1, s[8:11], s57 offen nt
buffer_load_dword v21, v1, s[8:11], s58 offen nt
s_branch SK_3
SK_2:
buffer_load_dword v20, v1, s[12:15], s57 offen nt
buffer_load_dword v21, v1, s[12:15], s58 offen nt
SK_3:
s_mov_b64 exec, -1
v_mov_b32 v8, -1
v_mov_b32 v9, -1
v_mov_b32 v10, -1
v_mov_b32 v11, -1
s_lshl_b32 s57, s48, 12
s_lshl_b32 s58, s3, 10
s_add_u32 s57, s57, s58
buffer_store_dwordx4 v[8:11], v1, s[16:19], s57 offen sc1
s_lshl_b32 s57, s48, 10
s_lshl_b32 s58, s3, 8
s_add_u32 s57, s57, s58
s_add_u32 s57, s57, 2097152
s_mov_b64 exec, 0xffff
buffer_store_dwordx4 v[8:11], v1, s[16:19], s57 offen sc1
v_mov_b32 v12, 0
v_mov_b32 v13, 0
v_mov_b32 v14, 0
v_mov_b32 v15, 0
s_lshl_b32 s57, s48, 9
s_lshl_b32 s58, s3, 7
s_add_u32 s57, s57, s58
s_add_u32 s57, s57, 2162688
s_mov_b64 exec, 0xff
buffer_store_dwordx4 v[12:15], v1, s[16:19], s57 offen sc1
s_mov_b64 exec, -1
s_waitcnt vmcnt(4)
s_memtime s[64:65]
s_waitcnt vmcnt(3)
s_memtime s[66:67]
s_lshl_b32 s58, s3, 2
s_add_u32 s58, s58, 163072
v_mov_b32 v21, s58
s_waitcnt lgkmcnt(0)
s_sub_u32 s57, s66, s64
v_mov_b32 v20, s57
ds_write_b32 v21, v20
s_waitcnt vmcnt(0) lgkmcnt(0)
s_barrier
s_cmp_lg_u32 s3, 3
s_cbranch_scc1 SK_1
v_mov_b32 v20, 163072
ds_read_b128 v[24:27], v20
s_and_b32 s57, s48, 1
s_lshl_b32 s57, s57, 5
s_lshr_b32 s58, s48, 1
s_add_u32 s57, s57, s58
s_lshl_b32 s57, s57, 2
s_add_u32 s57, s57, 64
s_lshr_b32 s58, s49, 2
s_xor_b32 s58, s58, s49
s_and_b32 s58, s58, 1
s_waitcnt lgkmcnt(0)
v_mov_b32 v21, 1
v_cmp_lt_u32 vcc, v24, v25
s_nop 1
v_cndmask_b32 v22, 0, 1, vcc
v_xor_b32 v22, s58, v22
v_sub_u32 v22, 2, v22
v_sad_u32 v23, v24, v25, 0
v_cmp_gt_u32 vcc, 40, v23
s_nop 1
v_cndmask_b32 v22, v22, 0, vcc
v_lshl_add_u32 v21, v22, 1, v21
v_cmp_lt_u32 vcc, v26, v27
s_nop 1
v_cndmask_b32 v22, 0, 1, vcc
v_xor_b32 v22, s58, v22
v_sub_u32 v22, 2, v22
v_sad_u32 v23, v26, v27, 0
v_cmp_gt_u32 vcc, 40, v23
s_nop 1
v_cndmask_b32 v22, v22, 0, vcc
v_lshl_add_u32 v21, v22, 3, v21
v_mov_b32 v20, s57
s_mov_b64 exec, 1
global_atomic_add v20, v21, s[44:45] sc1
s_mov_b64 exec, -1
SK_1:
s_mov_b32 s4, s24
s_and_b32 s5, s25, 0xffff
s_mov_b32 s6, 0x400
s_mov_b32 s7, 0x20000
v_lshrrev_b32 v16, 4, v0
v_bfe_u32 v17, v0, 2, 2
v_lshl_add_u32 v17, v17, 2, v16
s_lshl_b32 s57, s49, 6
s_lshl_b32 s58, s3, 4
s_add_u32 s58, s57, s58
v_add_u32 v17, s58, v17
v_lshlrev_b32 v18, 1, v17
buffer_load_dwordx4 v[28:31], v1, s[4:7], 0 offen
buffer_load_ushort v22, v18, s[4:7], 0 offen
v_and_b32 v18, 7, v0
v_bfe_u32 v19, v0, 3, 1
v_lshl_add_u32 v18, v19, 5, v18
v_lshrrev_b32 v19, 4, v0
v_lshl_add_u32 v18, v19, 3, v18
s_lshl_b32 s57, s49, 6
v_add_u32 v18, s57, v18
v_lshlrev_b32 v18, 1, v18
buffer_load_ushort v40, v18, s[4:7], 0 offen
s_mov_b32 s4, s30
s_and_b32 s5, s31, 0xffff
s_mov_b32 s6, 0x400000
s_mov_b32 s7, 0x20000
v_and_b32 v19, 15, v0
v_lshlrev_b32 v19, 4, v19
v_lshl_add_u32 v19, v16, 13, v19
s_lshl_b32 s58, s58, 13
s_lshl_b32 s59, s48, 8
s_add_u32 s58, s58, s59
buffer_load_dwordx4 a[208:211], v19, s[4:7], s58 offen nt
s_add_u32 s58, s58, 32768
buffer_load_dwordx4 a[212:215], v19, s[4:7], s58 offen nt
s_add_u32 s58, s58, 32768
buffer_load_dwordx4 a[216:219], v19, s[4:7], s58 offen nt
s_add_u32 s58, s58, 32768
buffer_load_dwordx4 a[220:223], v19, s[4:7], s58 offen nt
s_add_u32 s57, s61, 0
buffer_load_dwordx4 v[48:51], v1, s[8:11], s57 offen offset:0
buffer_load_dwordx4 v[52:55], v1, s[8:11], s57 offen offset:1024
buffer_load_dwordx4 v[56:59], v1, s[8:11], s57 offen offset:2048
buffer_load_dwordx4 v[60:63], v1, s[8:11], s57 offen offset:3072
s_add_u32 s57, s61, 32768
buffer_load_dwordx4 v[64:67], v1, s[8:11], s57 offen offset:0 nt
buffer_load_dwordx4 v[68:71], v1, s[8:11], s57 offen offset:1024 nt
buffer_load_dwordx4 v[72:75], v1, s[8:11], s57 offen offset:2048 nt
buffer_load_dwordx4 v[76:79], v1, s[8:11], s57 offen offset:3072 nt
v_and_b32 v41, 7, v17
v_bfe_u32 v18, v17, 5, 4
v_lshl_add_u32 v41, v18, 3, v41
v_bfe_u32 v18, v17, 3, 2
v_lshl_add_u32 v41, v41, 2, v18
v_lshlrev_b32 v41, 2, v41
s_lshl_b32 s57, s3, 7
v_add_u32 v16, s57, v0
v_add_u32 v17, 64, v16
v_and_b32 v42, 7, v16
v_bfe_u32 v18, v16, 5, 4
v_lshl_add_u32 v42, v18, 3, v42
v_bfe_u32 v18, v16, 3, 2
v_lshl_add_u32 v42, v42, 2, v18
v_lshlrev_b32 v42, 2, v42
v_and_b32 v43, 7, v17
v_bfe_u32 v18, v17, 5, 4
v_lshl_add_u32 v43, v18, 3, v43
v_bfe_u32 v18, v17, 3, 2
v_lshl_add_u32 v43, v43, 2, v18
v_lshlrev_b32 v43, 2, v43
v_and_b32 v16, 1, v0
v_cmp_eq_u32 s[68:69], 1, v16
v_and_b32 v17, 2, v0
v_cmp_eq_u32 s[66:67], 2, v17
v_mov_b32 v18, 0xffff
v_mov_b32 v19, 0xffff0000
v_cndmask_b32 v18, v18, v19, s[68:69]
v_bfe_u32 v17, v0, 1, 2
v_cmp_eq_u32 vcc, 0, v17
s_nop 1
v_cndmask_b32 v2, 0, v18, vcc
v_cmp_eq_u32 vcc, 1, v17
s_nop 1
v_cndmask_b32 v3, 0, v18, vcc
v_cmp_eq_u32 vcc, 2, v17
s_nop 1
v_cndmask_b32 v4, 0, v18, vcc
v_cmp_eq_u32 vcc, 3, v17
s_nop 1
v_cndmask_b32 v5, 0, v18, vcc
s_lshl_b32 s62, s49, 5
s_add_u32 s62, s62, s48
s_and_b32 s62, s62, 31
s_mul_i32 s50, s49, 22
s_add_u32 s50, s50, s62
s_add_u32 s51, s62, 10
s_lshr_b32 s51, s51, 5
s_lshl_b32 s51, s51, 8
s_add_u32 s51, s51, s50
s_waitcnt vmcnt(12)
v_lshlrev_b32 v8, 16, v28
v_and_b32 v9, 0xffff0000, v28
v_lshlrev_b32 v10, 16, v29
v_and_b32 v11, 0xffff0000, v29
v_lshlrev_b32 v12, 16, v30
v_and_b32 v13, 0xffff0000, v30
v_lshlrev_b32 v14, 16, v31
v_and_b32 v15, 0xffff0000, v31
v_lshlrev_b32 v22, 16, v22
v_readfirstlane_b32 s57, v8
s_nop 1
v_subrev_f32 v8, s57, v8
v_subrev_f32 v9, s57, v9
v_subrev_f32 v10, s57, v10
v_subrev_f32 v11, s57, v11
v_subrev_f32 v12, s57, v12
v_subrev_f32 v13, s57, v13
v_subrev_f32 v14, s57, v14
v_subrev_f32 v15, s57, v15
v_add_f32 v16, v8, v9
v_mul_f32 v17, v8, v8
v_add_f32 v18, v10, v11
v_mul_f32 v19, v9, v9
v_add_f32 v16, v16, v12
v_add_f32 v18, v18, v13
v_add_f32 v16, v16, v14
v_add_f32 v18, v18, v15
v_fmac_f32 v17, v10, v10
v_fmac_f32 v19, v11, v11
v_fmac_f32 v17, v12, v12
v_fmac_f32 v19, v13, v13
v_fmac_f32 v17, v14, v14
v_fmac_f32 v19, v15, v15
v_add_f32 v16, v16, v18
v_add_f32 v17, v17, v19
s_nop 0
v_add_f32_dpp v16, v16, v16 row_ror:8 row_mask:0xf bank_mask:0xf
v_add_f32_dpp v17, v17, v17 row_ror:8 row_mask:0xf bank_mask:0xf
s_nop 0
v_add_f32_dpp v16, v16, v16 row_ror:4 row_mask:0xf bank_mask:0xf
v_add_f32_dpp v17, v17, v17 row_ror:4 row_mask:0xf bank_mask:0xf
s_nop 0
v_add_f32_dpp v16, v16, v16 row_ror:2 row_mask:0xf bank_mask:0xf
v_add_f32_dpp v17, v17, v17 row_ror:2 row_mask:0xf bank_mask:0xf
s_nop 0
v_add_f32_dpp v16, v16, v16 row_ror:1 row_mask:0xf bank_mask:0xf
v_add_f32_dpp v17, v17, v17 row_ror:1 row_mask:0xf bank_mask:0xf
s_nop 0
v_add_f32_dpp v16, v16, v16 row_bcast:15 row_mask:0xa bank_mask:0xf
v_add_f32_dpp v17, v17, v17 row_bcast:15 row_mask:0xa bank_mask:0xf
s_nop 0
v_add_f32_dpp v16, v16, v16 row_bcast:31 row_mask:0xc bank_mask:0xf
v_add_f32_dpp v17, v17, v17 row_bcast:31 row_mask:0xc bank_mask:0xf
v_readlane_b32 s58, v16, 63
v_readlane_b32 s59, v17, 63
v_mov_b32 v18, 0x3b000000
v_mul_f32 v16, s58, v18
v_mul_f32 v17, s59, v18
v_fma_f32 v17, -v16, v16, v17
v_add_f32 v16, s57, v16
v_max_f32 v17, 0, v17
v_cvt_pk_bf16_f32 v16, v16, v16
v_and_b32 v16, 0xffff0000, v16
v_cvt_pk_bf16_f32 v17, v17, v17
v_and_b32 v17, 0xffff0000, v17
v_add_f32 v17, 0x3727c5ac, v17
v_cvt_pk_bf16_f32 v17, v17, v17
v_and_b32 v17, 0xffff0000, v17
v_sqrt_f32 v17, v17
v_sub_f32 v22, v22, v16
v_cvt_pk_bf16_f32 v17, v17, v17
v_and_b32 v17, 0xffff0000, v17
v_rcp_f32 v18, v17
v_cvt_pk_bf16_f32 v22, v22, v22
v_and_b32 v22, 0xffff0000, v22
v_mul_f32 v19, v22, v18
v_fma_f32 v22, -v19, v17, v22
v_fma_f32 v22, v22, v18, v19
s_add_u32 s57, s61, 65536
buffer_load_dwordx4 v[80:83], v1, s[8:11], s57 offen offset:0
buffer_load_dwordx4 v[84:87], v1, s[8:11], s57 offen offset:1024
buffer_load_dwordx4 v[88:91], v1, s[8:11], s57 offen offset:2048
buffer_load_dwordx4 v[92:95], v1, s[8:11], s57 offen offset:3072
s_add_u32 s57, s61, 98304
buffer_load_dwordx4 v[96:99], v1, s[8:11], s57 offen offset:0 nt
buffer_load_dwordx4 v[100:103], v1, s[8:11], s57 offen offset:1024 nt
buffer_load_dwordx4 v[104:107], v1, s[8:11], s57 offen offset:2048 nt
buffer_load_dwordx4 v[108:111], v1, s[8:11], s57 offen offset:3072 nt
v_cvt_pk_bf16_f32 v23, v22, v22
s_nop 1
v_and_b32_dpp v24, v23, v2 row_newbcast:0 row_mask:0xf bank_mask:0xf
v_and_b32_dpp v25, v23, v3 row_newbcast:0 row_mask:0xf bank_mask:0xf
v_and_b32_dpp v26, v23, v4 row_newbcast:0 row_mask:0xf bank_mask:0xf
v_and_b32_dpp v27, v23, v5 row_newbcast:0 row_mask:0xf bank_mask:0xf
v_and_b32_dpp v28, v23, v2 row_newbcast:4 row_mask:0xf bank_mask:0xf
v_and_b32_dpp v29, v23, v3 row_newbcast:4 row_mask:0xf bank_mask:0xf
v_and_b32_dpp v30, v23, v4 row_newbcast:4 row_mask:0xf bank_mask:0xf
v_and_b32_dpp v31, v23, v5 row_newbcast:4 row_mask:0xf bank_mask:0xf
s_waitcnt vmcnt(16)
v_mfma_f32_16x16x32_bf16 v[8:11], a[208:211], v[24:27], 0
v_and_b32_dpp v24, v23, v2 row_newbcast:8 row_mask:0xf bank_mask:0xf
v_and_b32_dpp v25, v23, v3 row_newbcast:8 row_mask:0xf bank_mask:0xf
v_and_b32_dpp v26, v23, v4 row_newbcast:8 row_mask:0xf bank_mask:0xf
v_and_b32_dpp v27, v23, v5 row_newbcast:8 row_mask:0xf bank_mask:0xf
v_mfma_f32_16x16x32_bf16 v[8:11], a[212:215], v[28:31], v[8:11]
v_and_b32_dpp v28, v23, v2 row_newbcast:12 row_mask:0xf bank_mask:0xf
v_and_b32_dpp v29, v23, v3 row_newbcast:12 row_mask:0xf bank_mask:0xf
v_and_b32_dpp v30, v23, v4 row_newbcast:12 row_mask:0xf bank_mask:0xf
v_and_b32_dpp v31, v23, v5 row_newbcast:12 row_mask:0xf bank_mask:0xf
v_lshrrev_b32 v16, 4, v0
v_and_b32 v17, 7, v0
v_mfma_f32_16x16x32_bf16 v[8:11], a[216:219], v[24:27], v[8:11]
v_mfma_f32_16x16x32_bf16 v[8:11], a[220:223], v[28:31], v[8:11]
v_lshlrev_b32 v16, 7, v16
v_lshl_add_u32 v16, v17, 2, v16
s_lshl_b32 s57, s3, 9
s_add_u32 s57, s57, 155648
v_add_u32 v16, s57, v16
v_add_u32 v17, 155648, v1
s_mov_b32 exec_lo, 0x00ff00ff
s_mov_b32 exec_hi, 0x00ff00ff
ds_write_b32 v16, v8 offset:0
ds_write_b32 v16, v9 offset:32
ds_write_b32 v16, v10 offset:64
ds_write_b32 v16, v11 offset:96
s_mov_b64 exec, -1
s_waitcnt lgkmcnt(0)
s_barrier
s_cmp_lg_u32 s3, 0
s_cbranch_scc1 SK_4
s_mov_b32 exec_hi, 0
ds_read_b128 v[8:11], v17 offset:0
ds_read_b128 v[20:23], v17 offset:512
ds_read_b128 v[24:27], v17 offset:1024
ds_read_b128 v[28:31], v17 offset:1536
s_waitcnt lgkmcnt(0)
v_add_f32 v8, v8, v20
v_add_f32 v24, v24, v28
v_add_f32 v9, v9, v21
v_add_f32 v25, v25, v29
v_add_f32 v10, v10, v22
v_add_f32 v26, v26, v30
v_add_f32 v11, v11, v23
v_add_f32 v27, v27, v31
v_add_f32 v8, v8, v24
v_add_f32 v9, v9, v25
v_add_f32 v10, v10, v26
v_add_f32 v11, v11, v27
v_and_or_b32 v8, v8, -4, s70
v_and_or_b32 v9, v9, -4, s70
v_and_or_b32 v10, v10, -4, s70
v_and_or_b32 v11, v11, -4, s70
s_cmp_lg_u32 s78, 0
s_cbranch_scc1 SK_5
s_lshl_b32 s57, s2, 9
buffer_store_dwordx4 v[8:11], v1, s[16:19], s57 offen sc1
SK_5:
s_mov_b64 exec, -1
SK_4:
s_mov_b32 s4, s32
s_and_b32 s5, s33, 0xffff
s_mov_b32 s6, 0x400000
s_mov_b32 s7, 0x20000
v_lshrrev_b32 v16, 3, v0
v_and_b32 v17, 7, v0
v_lshlrev_b32 v17, 4, v17
v_lshl_add_u32 v16, v16, 10, v17
s_lshl_b32 s57, s48, 17
s_lshl_b32 s58, s3, 15
s_add_u32 s57, s57, s58
s_lshl_b32 s58, s49, 7
s_add_u32 s57, s57, s58
s_add_u32 s57, s57, 0
buffer_load_dwordx4 a[248:251], v16, s[4:7], s57 offen nt
s_mov_b32 s4, s32
s_and_b32 s5, s33, 0xffff
s_mov_b32 s6, 0x400000
s_mov_b32 s7, 0x20000
v_lshrrev_b32 v16, 3, v0
v_and_b32 v17, 7, v0
v_lshlrev_b32 v17, 4, v17
v_lshl_add_u32 v16, v16, 10, v17
s_lshl_b32 s57, s48, 17
s_lshl_b32 s58, s3, 15
s_add_u32 s57, s57, s58
s_lshl_b32 s58, s49, 7
s_add_u32 s57, s57, s58
s_add_u32 s57, s57, 8192
buffer_load_dwordx4 a[252:255], v16, s[4:7], s57 offen nt
s_mov_b32 s4, s32
s_and_b32 s5, s33, 0xffff
s_mov_b32 s6, 0x400000
s_mov_b32 s7, 0x20000
v_lshrrev_b32 v16, 3, v0
v_and_b32 v17, 7, v0
v_lshlrev_b32 v17, 4, v17
v_lshl_add_u32 v16, v16, 10, v17
s_lshl_b32 s57, s48, 17
s_lshl_b32 s58, s3, 15
s_add_u32 s57, s57, s58
s_lshl_b32 s58, s49, 7
s_add_u32 s57, s57, s58
s_add_u32 s57, s57, 16384
buffer_load_dwordx4 v[32:35], v16, s[4:7], s57 offen nt
s_mov_b32 s4, s32
s_and_b32 s5, s33, 0xffff
s_mov_b32 s6, 0x400000
s_mov_b32 s7, 0x20000
v_lshrrev_b32 v16, 3, v0
v_and_b32 v17, 7, v0
v_lshlrev_b32 v17, 4, v17
v_lshl_add_u32 v16, v16, 10, v17
s_lshl_b32 s57, s48, 17
s_lshl_b32 s58, s3, 15
s_add_u32 s57, s57, s58
s_lshl_b32 s58, s49, 7
s_add_u32 s57, s57, s58
s_add_u32 s57, s57, 24576
buffer_load_dwordx4 v[36:39], v16, s[4:7], s57 offen nt
s_cmp_ge_u32 s51, 172
s_cbranch_scc1 SK_6
s_mov_b32 s4, s40
s_and_b32 s5, s41, 0xffff
s_mov_b32 s6, 0x158000
s_mov_b32 s7, 0x20000
v_lshrrev_b32 v16, 4, v0
v_and_b32 v17, 15, v0
v_lshlrev_b32 v17, 4, v17
v_lshl_add_u32 v16, v16, 10, v17
s_lshl_b32 s57, s50, 13
s_lshl_b32 s58, s3, 8
s_add_u32 s57, s57, s58
s_add_u32 s57, s57, 0
buffer_load_dwordx4 a[240:243], v16, s[4:7], s57 offen nt
SK_6:
s_cmp_ge_u32 s51, 172
s_cbranch_scc1 SK_7
s_mov_b32 s4, s40
s_and_b32 s5, s41, 0xffff
s_mov_b32 s6, 0x158000
s_mov_b32 s7, 0x20000
v_lshrrev_b32 v16, 4, v0
v_and_b32 v17, 15, v0
v_lshlrev_b32 v17, 4, v17
v_lshl_add_u32 v16, v16, 10, v17
s_lshl_b32 s57, s50, 13
s_lshl_b32 s58, s3, 8
s_add_u32 s57, s57, s58
s_add_u32 s57, s57, 4096
buffer_load_dwordx4 a[244:247], v16, s[4:7], s57 offen nt
SK_7:
s_waitcnt vmcnt(10)
v_and_b32 v6, 15, v0
v_lshlrev_b32 v6, 2, v6
v_and_b32 v7, 16, v0
v_lshl_add_u32 v6, v7, 3, v6
v_add_u32 v6, 64, v6
global_load_dword v7, v6, s[44:45] sc1
s_add_u32 s57, s61, 131072
buffer_load_dwordx4 v[112:115], v1, s[8:11], s57 offen offset:0
buffer_load_dwordx4 v[116:119], v1, s[8:11], s57 offen offset:1024
buffer_load_dwordx4 v[120:123], v1, s[8:11], s57 offen offset:2048
buffer_load_dwordx4 v[124:127], v1, s[8:11], s57 offen offset:3072
s_add_u32 s57, s61, 163840
buffer_load_dwordx4 v[128:131], v1, s[8:11], s57 offen offset:0 nt
buffer_load_dwordx4 v[132:135], v1, s[8:11], s57 offen offset:1024 nt
buffer_load_dwordx4 v[136:139], v1, s[8:11], s57 offen offset:2048 nt
buffer_load_dwordx4 v[140:143], v1, s[8:11], s57 offen offset:3072 nt
s_add_u32 s57, s61, 196608
buffer_load_dwordx4 v[144:147], v1, s[8:11], s57 offen offset:0
buffer_load_dwordx4 v[148:151], v1, s[8:11], s57 offen offset:1024
buffer_load_dwordx4 v[152:155], v1, s[8:11], s57 offen offset:2048
buffer_load_dwordx4 v[156:159], v1, s[8:11], s57 offen offset:3072
s_add_u32 s57, s61, 229376
buffer_load_dwordx4 v[160:163], v1, s[8:11], s57 offen offset:0 nt
buffer_load_dwordx4 v[164:167], v1, s[8:11], s57 offen offset:1024 nt
buffer_load_dwordx4 v[168:171], v1, s[8:11], s57 offen offset:2048 nt
buffer_load_dwordx4 v[172:175], v1, s[8:11], s57 offen offset:3072 nt
s_waitcnt vmcnt(16)
v_cmp_gt_u32 vcc, 1, v7
s_cbranch_vccnz CTR_SLOW
CTR_OK:
v_bfe_u32 v6, v7, 1, 2
v_cmp_eq_u32 vcc, 1, v6
v_cmp_eq_u32 s[64:65], 2, v6
s_lshr_b32 s57, s49, 2
s_bcnt1_i32_b32 s52, vcc_lo
s_bcnt1_i32_b32 s58, s64
s_sub_u32 s52, s58, s52
s_lshr_b32 s52, s52, 31
s_xor_b32 s52, s52, s57
s_and_b32 s57, s2, 3
s_lshl_b32 s77, s57, 21
s_xor_b32 s58, s57, s52
s_and_b32 s58, s58, 1
s_lshl_b32 s58, s58, 13
s_add_u32 s77, s77, s58
s_lshr_b32 s58, s3, 1
s_lshl_b32 s58, s58, 14
s_add_u32 s77, s77, s58
s_and_b32 s58, s3, 1
s_lshl_b32 s58, s58, 12
s_add_u32 s77, s77, s58
v_bfe_u32 v6, v7, 3, 2
v_cmp_eq_u32 vcc, 1, v6
v_cmp_eq_u32 s[64:65], 2, v6
s_lshr_b32 s57, s49, 2
s_bcnt1_i32_b32 s52, vcc_lo
s_bcnt1_i32_b32 s58, s64
s_sub_u32 s52, s58, s52
s_lshr_b32 s52, s52, 31
s_xor_b32 s52, s52, s57
s_and_b32 s57, s2, 3
s_lshl_b32 s63, s57, 21
s_xor_b32 s58, s57, s52
s_and_b32 s58, s58, 1
s_lshl_b32 s58, s58, 13
s_add_u32 s63, s63, s58
s_lshr_b32 s58, s3, 1
s_lshl_b32 s58, s58, 14
s_add_u32 s63, s63, s58
s_and_b32 s58, s3, 1
s_lshl_b32 s58, s58, 12
s_add_u32 s63, s63, s58
s_cmp_lg_u32 s3, 0
s_cbranch_scc1 SK_8
s_cmp_eq_u32 s78, 0
s_cbranch_scc1 SK_8
s_mov_b32 exec_hi, 0
s_lshl_b32 s57, s2, 9
buffer_store_dwordx4 v[8:11], v1, s[16:19], s57 offen sc1
s_mov_b64 exec, -1
SK_8:
s_and_b32 s57, s2, 3
s_lshl_b32 s72, s57, 2
s_add_u32 s72, s72, s3
s_lshl_b32 s72, s72, 1
s_bfe_u32 s58, s77, 0x1000d
s_add_u32 s72, s72, s58
s_lshl_b32 s58, s48, 5
s_add_u32 s72, s72, s58
s_lshl_b32 s72, s72, 11
s_add_u32 s72, s72, 4194304
s_lshl_b32 s73, s57, 2
s_add_u32 s73, s73, s3
s_lshl_b32 s73, s73, 1
s_bfe_u32 s58, s63, 0x1000d
s_add_u32 s73, s73, s58
s_lshl_b32 s58, s48, 5
s_add_u32 s73, s73, s58
s_lshl_b32 s73, s73, 11
s_add_u32 s73, s73, 4194304
s_add_u32 s57, s77, 262144
buffer_load_dwordx4 v[176:179], v1, s[8:11], s57 offen offset:0
buffer_load_dwordx4 v[180:183], v1, s[8:11], s57 offen offset:1024
buffer_load_dwordx4 v[184:187], v1, s[8:11], s57 offen offset:2048
buffer_load_dwordx4 v[188:191], v1, s[8:11], s57 offen offset:3072
s_add_u32 s57, s77, 294912
buffer_load_dwordx4 v[192:195], v1, s[8:11], s57 offen offset:0 nt
buffer_load_dwordx4 v[196:199], v1, s[8:11], s57 offen offset:1024 nt
buffer_load_dwordx4 v[200:203], v1, s[8:11], s57 offen offset:2048 nt
buffer_load_dwordx4 v[204:207], v1, s[8:11], s57 offen offset:3072 nt
s_waitcnt vmcnt(20)
s_add_u32 s57, s77, 327680
buffer_load_dwordx4 v[208:211], v1, s[8:11], s57 offen offset:0
buffer_load_dwordx4 v[212:215], v1, s[8:11], s57 offen offset:1024
buffer_load_dwordx4 v[216:219], v1, s[8:11], s57 offen offset:2048
buffer_load_dwordx4 v[220:223], v1, s[8:11], s57 offen offset:3072
s_waitcnt vmcnt(20)
s_add_u32 s57, s77, 360448
buffer_load_dwordx4 v[224:227], v1, s[8:11], s57 offen offset:0 nt
buffer_load_dwordx4 v[228:231], v1, s[8:11], s57 offen offset:1024 nt
buffer_load_dwordx4 v[232:235], v1, s[8:11], s57 offen offset:2048 nt
buffer_load_dwordx4 v[236:239], v1, s[8:11], s57 offen offset:3072 nt
v_lshrrev_b32 v6, 4, v0
v_and_b32 v7, 15, v0
v_lshlrev_b32 v6, 10, v6
v_lshl_add_u32 v6, v7, 5, v6
s_lshl_b32 s60, s48, 12
buffer_load_dwordx4 v[16:19], v6, s[16:19], s60 offen offset:0 sc1
buffer_load_dwordx4 v[20:23], v6, s[16:19], s60 offen offset:16 sc1
buffer_load_dwordx4 v[24:27], v6, s[16:19], s60 offen offset:512 sc1
buffer_load_dwordx4 v[28:31], v6, s[16:19], s60 offen offset:528 sc1
s_waitcnt vmcnt(20)
s_add_u32 s57, s61, 0
buffer_load_dwordx4 a[64:67], v1, s[12:15], s57 offen offset:0 nt
buffer_load_dwordx4 a[68:71], v1, s[12:15], s57 offen offset:1024 nt
buffer_load_dwordx4 a[72:75], v1, s[12:15], s57 offen offset:2048 nt
buffer_load_dwordx4 a[76:79], v1, s[12:15], s57 offen offset:3072 nt
s_waitcnt vmcnt(20)
s_add_u32 s57, s61, 32768
buffer_load_dwordx4 a[80:83], v1, s[12:15], s57 offen offset:0 nt
buffer_load_dwordx4 a[84:87], v1, s[12:15], s57 offen offset:1024 nt
buffer_load_dwordx4 a[88:91], v1, s[12:15], s57 offen offset:2048 nt
buffer_load_dwordx4 a[92:95], v1, s[12:15], s57 offen offset:3072 nt
s_waitcnt vmcnt(20)
s_add_u32 s57, s61, 65536
buffer_load_dwordx4 a[96:99], v1, s[12:15], s57 offen offset:0 nt
buffer_load_dwordx4 a[100:103], v1, s[12:15], s57 offen offset:1024 nt
buffer_load_dwordx4 a[104:107], v1, s[12:15], s57 offen offset:2048 nt
buffer_load_dwordx4 a[108:111], v1, s[12:15], s57 offen offset:3072 nt
s_waitcnt vmcnt(20)
s_add_u32 s57, s61, 98304
buffer_load_dwordx4 a[112:115], v1, s[12:15], s57 offen offset:0 nt
buffer_load_dwordx4 a[116:119], v1, s[12:15], s57 offen offset:1024 nt
buffer_load_dwordx4 a[120:123], v1, s[12:15], s57 offen offset:2048 nt
buffer_load_dwordx4 a[124:127], v1, s[12:15], s57 offen offset:3072 nt
s_waitcnt vmcnt(16)
v_or3_b32 v7, v16, v17, v18
v_or3_b32 v7, v19, v20, v7
v_or3_b32 v7, v21, v22, v7
v_or3_b32 v7, v23, v24, v7
v_or3_b32 v7, v25, v26, v7
v_or3_b32 v7, v27, v28, v7
v_or3_b32 v7, v29, v30, v7
v_or_b32 v7, v31, v7
v_and_b32 v7, s71, v7
v_cmp_ne_u32 vcc, 0, v7
s_cbranch_vccnz QG_SLOW
QG_OK:
v_add_f32 v16, v16, v24
v_add_f32 v17, v17, v25
v_add_f32 v18, v18, v26
v_add_f32 v19, v19, v27
v_add_f32 v20, v20, v28
v_add_f32 v21, v21, v29
v_add_f32 v22, v22, v30
v_add_f32 v23, v23, v31
v_permlane32_swap_b32 v16, v20
v_permlane32_swap_b32 v17, v21
v_permlane32_swap_b32 v18, v22
v_permlane32_swap_b32 v19, v23
v_add_f32 v16, v16, v20
v_add_f32 v17, v17, v21
v_add_f32 v18, v18, v22
v_add_f32 v19, v19, v23
s_nop 0
v_permlane16_swap_b32 v16, v18
v_permlane16_swap_b32 v17, v19
v_add_f32 v16, v16, v18
v_add_f32 v17, v17, v19
v_cvt_pk_bf16_f32 v12, v16, v17
v_mov_b32 v13, v12
s_nop 1
v_permlane16_swap_b32 v12, v13
v_mov_b32 v14, v12
v_mov_b32 v15, v13
s_nop 0
v_permlane32_swap_b32 v12, v14
v_permlane32_swap_b32 v13, v15
v_lshlrev_b32 v40, 16, v40
v_mov_b32 v6, 0x7149f2ca
v_mov_b32 v7, 0
v_mov_b32 v8, 0
v_mov_b32 v9, 0
v_mov_b32 v10, 0
v_mov_b32 v11, 0
s_mul_i32 s57, s3, 40960
s_min_u32 s57, s57, 118784
v_add_u32 v44, s57, v1
v_mov_b32 v16, -1
v_mov_b32 v17, -1
v_mov_b32 v18, -1
v_mov_b32 v19, -1
s_lshl_b32 s57, s2, 2
s_add_u32 s57, s57, s3
s_mul_i32 s57, s57, 640
s_add_u32 s57, s57, 131072
s_mov_b32 exec_hi, 0xff
buffer_store_dwordx4 v[16:19], v1, s[16:19], s57 offen sc1
s_mov_b64 exec, -1
s_nop 0
v_dot2_f32_bf16 v16, v48, v12, 0
v_dot2_f32_bf16 v17, v52, v12, 0
v_dot2_f32_bf16 v18, v56, v12, 0
v_dot2_f32_bf16 v19, v60, v12, 0
v_dot2_f32_bf16 v16, v49, v13, v16
v_dot2_f32_bf16 v17, v53, v13, v17
v_dot2_f32_bf16 v18, v57, v13, v18
v_dot2_f32_bf16 v19, v61, v13, v19
v_dot2_f32_bf16 v16, v50, v14, v16
v_dot2_f32_bf16 v17, v54, v14, v17
v_dot2_f32_bf16 v18, v58, v14, v18
v_dot2_f32_bf16 v19, v62, v14, v19
v_dot2_f32_bf16 v16, v51, v15, v16
v_dot2_f32_bf16 v17, v55, v15, v17
v_dot2_f32_bf16 v18, v59, v15, v18
v_dot2_f32_bf16 v19, v63, v15, v19
s_add_u32 s57, s77, 393216
buffer_load_dwordx4 v[48:51], v1, s[8:11], s57 offen offset:0
buffer_load_dwordx4 v[52:55], v1, s[8:11], s57 offen offset:1024
buffer_load_dwordx4 v[56:59], v1, s[8:11], s57 offen offset:2048
buffer_load_dwordx4 v[60:63], v1, s[8:11], s57 offen offset:3072
s_add_u32 s57, s61, 131072
buffer_load_dwordx4 a[128:131], v1, s[12:15], s57 offen offset:0 nt
buffer_load_dwordx4 a[132:135], v1, s[12:15], s57 offen offset:1024 nt
buffer_load_dwordx4 a[136:139], v1, s[12:15], s57 offen offset:2048 nt
buffer_load_dwordx4 a[140:143], v1, s[12:15], s57 offen offset:3072 nt
v_add_f32_dpp v20, v16, v16 row_ror:8 row_mask:0xf bank_mask:0x3
v_add_f32_dpp v21, v17, v17 row_ror:8 row_mask:0xf bank_mask:0x3
s_nop 0
v_add_f32_dpp v20, v18, v18 row_ror:8 row_mask:0xf bank_mask:0xc
v_add_f32_dpp v21, v19, v19 row_ror:8 row_mask:0xf bank_mask:0xc
s_nop 0
v_add_f32_dpp v24, v20, v20 row_half_mirror row_mask:0xf bank_mask:0x5
s_nop 1
v_add_f32_dpp v24, v21, v21 row_half_mirror row_mask:0xf bank_mask:0xa
v_dot2_f32_bf16 v16, v64, v12, 0
v_dot2_f32_bf16 v17, v68, v12, 0
v_dot2_f32_bf16 v18, v72, v12, 0
v_dot2_f32_bf16 v19, v76, v12, 0
v_dot2_f32_bf16 v16, v65, v13, v16
v_dot2_f32_bf16 v17, v69, v13, v17
v_dot2_f32_bf16 v18, v73, v13, v18
v_dot2_f32_bf16 v19, v77, v13, v19
v_dot2_f32_bf16 v16, v66, v14, v16
v_dot2_f32_bf16 v17, v70, v14, v17
v_dot2_f32_bf16 v18, v74, v14, v18
v_dot2_f32_bf16 v19, v78, v14, v19
v_dot2_f32_bf16 v16, v67, v15, v16
v_dot2_f32_bf16 v17, v71, v15, v17
v_dot2_f32_bf16 v18, v75, v15, v18
v_dot2_f32_bf16 v19, v79, v15, v19
s_add_u32 s57, s77, 425984
buffer_load_dwordx4 v[64:67], v1, s[8:11], s57 offen offset:0 nt
buffer_load_dwordx4 v[68:71], v1, s[8:11], s57 offen offset:1024 nt
buffer_load_dwordx4 v[72:75], v1, s[8:11], s57 offen offset:2048 nt
buffer_load_dwordx4 v[76:79], v1, s[8:11], s57 offen offset:3072 nt
s_add_u32 s57, s61, 163840
buffer_load_dwordx4 a[144:147], v1, s[12:15], s57 offen offset:0 nt
buffer_load_dwordx4 a[148:151], v1, s[12:15], s57 offen offset:1024 nt
buffer_load_dwordx4 a[152:155], v1, s[12:15], s57 offen offset:2048 nt
buffer_load_dwordx4 a[156:159], v1, s[12:15], s57 offen offset:3072 nt
v_add_f32_dpp v20, v16, v16 row_ror:8 row_mask:0xf bank_mask:0x3
v_add_f32_dpp v21, v17, v17 row_ror:8 row_mask:0xf bank_mask:0x3
s_nop 0
v_add_f32_dpp v20, v18, v18 row_ror:8 row_mask:0xf bank_mask:0xc
v_add_f32_dpp v21, v19, v19 row_ror:8 row_mask:0xf bank_mask:0xc
s_nop 0
v_add_f32_dpp v25, v20, v20 row_half_mirror row_mask:0xf bank_mask:0x5
s_nop 1
v_add_f32_dpp v25, v21, v21 row_half_mirror row_mask:0xf bank_mask:0xa
v_dot2_f32_bf16 v16, v80, v12, 0
v_dot2_f32_bf16 v17, v84, v12, 0
v_dot2_f32_bf16 v18, v88, v12, 0
v_dot2_f32_bf16 v19, v92, v12, 0
v_dot2_f32_bf16 v16, v81, v13, v16
v_dot2_f32_bf16 v17, v85, v13, v17
v_dot2_f32_bf16 v18, v89, v13, v18
v_dot2_f32_bf16 v19, v93, v13, v19
v_dot2_f32_bf16 v16, v82, v14, v16
v_dot2_f32_bf16 v17, v86, v14, v17
v_dot2_f32_bf16 v18, v90, v14, v18
v_dot2_f32_bf16 v19, v94, v14, v19
v_dot2_f32_bf16 v16, v83, v15, v16
v_dot2_f32_bf16 v17, v87, v15, v17
v_dot2_f32_bf16 v18, v91, v15, v18
v_dot2_f32_bf16 v19, v95, v15, v19
s_add_u32 s57, s77, 458752
buffer_load_dwordx4 v[80:83], v1, s[8:11], s57 offen offset:0
buffer_load_dwordx4 v[84:87], v1, s[8:11], s57 offen offset:1024
buffer_load_dwordx4 v[88:91], v1, s[8:11], s57 offen offset:2048
buffer_load_dwordx4 v[92:95], v1, s[8:11], s57 offen offset:3072
s_waitcnt vmcnt(36)
s_add_u32 s57, s61, 196608
buffer_load_dwordx4 a[160:163], v1, s[12:15], s57 offen offset:0 nt
buffer_load_dwordx4 a[164:167], v1, s[12:15], s57 offen offset:1024 nt
buffer_load_dwordx4 a[168:171], v1, s[12:15], s57 offen offset:2048 nt
buffer_load_dwordx4 a[172:175], v1, s[12:15], s57 offen offset:3072 nt
v_add_f32_dpp v20, v16, v16 row_ror:8 row_mask:0xf bank_mask:0x3
v_add_f32_dpp v21, v17, v17 row_ror:8 row_mask:0xf bank_mask:0x3
s_nop 0
v_add_f32_dpp v20, v18, v18 row_ror:8 row_mask:0xf bank_mask:0xc
v_add_f32_dpp v21, v19, v19 row_ror:8 row_mask:0xf bank_mask:0xc
s_nop 0
v_add_f32_dpp v26, v20, v20 row_half_mirror row_mask:0xf bank_mask:0x5
s_nop 1
v_add_f32_dpp v26, v21, v21 row_half_mirror row_mask:0xf bank_mask:0xa
v_dot2_f32_bf16 v16, v96, v12, 0
v_dot2_f32_bf16 v17, v100, v12, 0
v_dot2_f32_bf16 v18, v104, v12, 0
v_dot2_f32_bf16 v19, v108, v12, 0
v_dot2_f32_bf16 v16, v97, v13, v16
v_dot2_f32_bf16 v17, v101, v13, v17
v_dot2_f32_bf16 v18, v105, v13, v18
v_dot2_f32_bf16 v19, v109, v13, v19
v_dot2_f32_bf16 v16, v98, v14, v16
v_dot2_f32_bf16 v17, v102, v14, v17
v_dot2_f32_bf16 v18, v106, v14, v18
v_dot2_f32_bf16 v19, v110, v14, v19
v_dot2_f32_bf16 v16, v99, v15, v16
v_dot2_f32_bf16 v17, v103, v15, v17
v_dot2_f32_bf16 v18, v107, v15, v18
v_dot2_f32_bf16 v19, v111, v15, v19
s_add_u32 s57, s77, 491520
buffer_load_dwordx4 v[96:99], v1, s[8:11], s57 offen offset:0 nt
buffer_load_dwordx4 v[100:103], v1, s[8:11], s57 offen offset:1024 nt
buffer_load_dwordx4 v[104:107], v1, s[8:11], s57 offen offset:2048 nt
buffer_load_dwordx4 v[108:111], v1, s[8:11], s57 offen offset:3072 nt
s_waitcnt vmcnt(36)
s_add_u32 s57, s61, 229376
buffer_load_dwordx4 a[176:179], v1, s[12:15], s57 offen offset:0 nt
buffer_load_dwordx4 a[180:183], v1, s[12:15], s57 offen offset:1024 nt
buffer_load_dwordx4 a[184:187], v1, s[12:15], s57 offen offset:2048 nt
buffer_load_dwordx4 a[188:191], v1, s[12:15], s57 offen offset:3072 nt
v_add_f32_dpp v20, v16, v16 row_ror:8 row_mask:0xf bank_mask:0x3
v_add_f32_dpp v21, v17, v17 row_ror:8 row_mask:0xf bank_mask:0x3
s_nop 0
v_add_f32_dpp v20, v18, v18 row_ror:8 row_mask:0xf bank_mask:0xc
v_add_f32_dpp v21, v19, v19 row_ror:8 row_mask:0xf bank_mask:0xc
s_nop 0
v_add_f32_dpp v27, v20, v20 row_half_mirror row_mask:0xf bank_mask:0x5
s_nop 1
v_add_f32_dpp v27, v21, v21 row_half_mirror row_mask:0xf bank_mask:0xa
v_add_f32_dpp v24, v24, v24 quad_perm:[2,3,0,1] row_mask:0xf bank_mask:0xf
v_add_f32_dpp v25, v25, v25 quad_perm:[2,3,0,1] row_mask:0xf bank_mask:0xf
v_add_f32_dpp v26, v26, v26 quad_perm:[2,3,0,1] row_mask:0xf bank_mask:0xf
v_add_f32_dpp v27, v27, v27 quad_perm:[2,3,0,1] row_mask:0xf bank_mask:0xf
v_cndmask_b32 v24, v24, v26, s[66:67]
v_cndmask_b32 v25, v25, v27, s[66:67]
s_nop 0
v_add_f32_dpp v24, v24, v24 quad_perm:[1,0,3,2] row_mask:0xf bank_mask:0xf
v_add_f32_dpp v25, v25, v25 quad_perm:[1,0,3,2] row_mask:0xf bank_mask:0xf
v_cndmask_b32 v45, v24, v25, s[68:69]
v_dot2_f32_bf16 v16, v112, v12, 0
v_dot2_f32_bf16 v17, v116, v12, 0
v_dot2_f32_bf16 v18, v120, v12, 0
v_dot2_f32_bf16 v19, v124, v12, 0
v_dot2_f32_bf16 v16, v113, v13, v16
v_dot2_f32_bf16 v17, v117, v13, v17
v_dot2_f32_bf16 v18, v121, v13, v18
v_dot2_f32_bf16 v19, v125, v13, v19
v_dot2_f32_bf16 v16, v114, v14, v16
v_dot2_f32_bf16 v17, v118, v14, v17
v_dot2_f32_bf16 v18, v122, v14, v18
v_dot2_f32_bf16 v19, v126, v14, v19
v_dot2_f32_bf16 v16, v115, v15, v16
v_dot2_f32_bf16 v17, v119, v15, v17
v_dot2_f32_bf16 v18, v123, v15, v18
v_dot2_f32_bf16 v19, v127, v15, v19
v_mov_b32 v22, v16
s_cmp_ge_u32 s51, 172
s_cbranch_scc1 SK_10
s_mov_b32 s4, s36
s_and_b32 s5, s37, 0xffff
s_mov_b32 s6, 0x158000
s_mov_b32 s7, 0x20000
s_lshl_b32 s57, s3, 7
s_add_u32 s57, s57, 0
v_add_u32 v16, s57, v0
v_mul_u32_u24 v16, 2752, v16
s_lshl_b32 s57, s50, 4
buffer_load_dwordx4 a[224:227], v16, s[4:7], s57 offen
SK_10:
v_mov_b32 v16, v22
s_nop 1
v_add_f32_dpp v20, v16, v16 row_ror:8 row_mask:0xf bank_mask:0x3
v_add_f32_dpp v21, v17, v17 row_ror:8 row_mask:0xf bank_mask:0x3
s_nop 0
v_add_f32_dpp v20, v18, v18 row_ror:8 row_mask:0xf bank_mask:0xc
v_add_f32_dpp v21, v19, v19 row_ror:8 row_mask:0xf bank_mask:0xc
s_nop 0
v_add_f32_dpp v24, v20, v20 row_half_mirror row_mask:0xf bank_mask:0x5
s_nop 1
v_add_f32_dpp v24, v21, v21 row_half_mirror row_mask:0xf bank_mask:0xa
v_dot2_f32_bf16 v16, v128, v12, 0
v_dot2_f32_bf16 v17, v132, v12, 0
v_dot2_f32_bf16 v18, v136, v12, 0
v_dot2_f32_bf16 v19, v140, v12, 0
v_dot2_f32_bf16 v16, v129, v13, v16
v_dot2_f32_bf16 v17, v133, v13, v17
v_dot2_f32_bf16 v18, v137, v13, v18
v_dot2_f32_bf16 v19, v141, v13, v19
v_dot2_f32_bf16 v16, v130, v14, v16
v_dot2_f32_bf16 v17, v134, v14, v17
v_dot2_f32_bf16 v18, v138, v14, v18
v_dot2_f32_bf16 v19, v142, v14, v19
v_dot2_f32_bf16 v16, v131, v15, v16
v_dot2_f32_bf16 v17, v135, v15, v17
v_dot2_f32_bf16 v18, v139, v15, v18
v_dot2_f32_bf16 v19, v143, v15, v19
v_add_f32_dpp v20, v16, v16 row_ror:8 row_mask:0xf bank_mask:0x3
v_add_f32_dpp v21, v17, v17 row_ror:8 row_mask:0xf bank_mask:0x3
s_nop 0
v_add_f32_dpp v20, v18, v18 row_ror:8 row_mask:0xf bank_mask:0xc
v_add_f32_dpp v21, v19, v19 row_ror:8 row_mask:0xf bank_mask:0xc
s_nop 0
v_add_f32_dpp v25, v20, v20 row_half_mirror row_mask:0xf bank_mask:0x5
s_nop 1
v_add_f32_dpp v25, v21, v21 row_half_mirror row_mask:0xf bank_mask:0xa
v_dot2_f32_bf16 v16, v144, v12, 0
v_dot2_f32_bf16 v17, v148, v12, 0
v_dot2_f32_bf16 v18, v152, v12, 0
v_dot2_f32_bf16 v19, v156, v12, 0
v_dot2_f32_bf16 v16, v145, v13, v16
v_dot2_f32_bf16 v17, v149, v13, v17
v_dot2_f32_bf16 v18, v153, v13, v18
v_dot2_f32_bf16 v19, v157, v13, v19
v_dot2_f32_bf16 v16, v146, v14, v16
v_dot2_f32_bf16 v17, v150, v14, v17
v_dot2_f32_bf16 v18, v154, v14, v18
v_dot2_f32_bf16 v19, v158, v14, v19
v_dot2_f32_bf16 v16, v147, v15, v16
v_dot2_f32_bf16 v17, v151, v15, v17
v_dot2_f32_bf16 v18, v155, v15, v18
v_dot2_f32_bf16 v19, v159, v15, v19
v_mov_b32 v22, v16
s_cmp_ge_u32 s51, 172
s_cbranch_scc1 SK_11
s_mov_b32 s4, s36
s_and_b32 s5, s37, 0xffff
s_mov_b32 s6, 0x158000
s_mov_b32 s7, 0x20000
s_lshl_b32 s57, s3, 7
s_add_u32 s57, s57, 64
v_add_u32 v16, s57, v0
v_mul_u32_u24 v16, 2752, v16
s_lshl_b32 s57, s50, 4
buffer_load_dwordx4 a[228:231], v16, s[4:7], s57 offen
SK_11:
v_mov_b32 v16, v22
s_nop 1
v_add_f32_dpp v20, v16, v16 row_ror:8 row_mask:0xf bank_mask:0x3
v_add_f32_dpp v21, v17, v17 row_ror:8 row_mask:0xf bank_mask:0x3
s_nop 0
v_add_f32_dpp v20, v18, v18 row_ror:8 row_mask:0xf bank_mask:0xc
v_add_f32_dpp v21, v19, v19 row_ror:8 row_mask:0xf bank_mask:0xc
s_nop 0
v_add_f32_dpp v26, v20, v20 row_half_mirror row_mask:0xf bank_mask:0x5
s_nop 1
v_add_f32_dpp v26, v21, v21 row_half_mirror row_mask:0xf bank_mask:0xa
v_dot2_f32_bf16 v16, v160, v12, 0
v_dot2_f32_bf16 v17, v164, v12, 0
v_dot2_f32_bf16 v18, v168, v12, 0
v_dot2_f32_bf16 v19, v172, v12, 0
v_dot2_f32_bf16 v16, v161, v13, v16
v_dot2_f32_bf16 v17, v165, v13, v17
v_dot2_f32_bf16 v18, v169, v13, v18
v_dot2_f32_bf16 v19, v173, v13, v19
v_dot2_f32_bf16 v16, v162, v14, v16
v_dot2_f32_bf16 v17, v166, v14, v17
v_dot2_f32_bf16 v18, v170, v14, v18
v_dot2_f32_bf16 v19, v174, v14, v19
v_dot2_f32_bf16 v16, v163, v15, v16
v_dot2_f32_bf16 v17, v167, v15, v17
v_dot2_f32_bf16 v18, v171, v15, v18
v_dot2_f32_bf16 v19, v175, v15, v19
v_add_f32_dpp v20, v16, v16 row_ror:8 row_mask:0xf bank_mask:0x3
v_add_f32_dpp v21, v17, v17 row_ror:8 row_mask:0xf bank_mask:0x3
s_nop 0
v_add_f32_dpp v20, v18, v18 row_ror:8 row_mask:0xf bank_mask:0xc
v_add_f32_dpp v21, v19, v19 row_ror:8 row_mask:0xf bank_mask:0xc
s_nop 0
v_add_f32_dpp v27, v20, v20 row_half_mirror row_mask:0xf bank_mask:0x5
s_nop 1
v_add_f32_dpp v27, v21, v21 row_half_mirror row_mask:0xf bank_mask:0xa
v_add_f32_dpp v24, v24, v24 quad_perm:[2,3,0,1] row_mask:0xf bank_mask:0xf
v_add_f32_dpp v25, v25, v25 quad_perm:[2,3,0,1] row_mask:0xf bank_mask:0xf
v_add_f32_dpp v26, v26, v26 quad_perm:[2,3,0,1] row_mask:0xf bank_mask:0xf
v_add_f32_dpp v27, v27, v27 quad_perm:[2,3,0,1] row_mask:0xf bank_mask:0xf
v_cndmask_b32 v24, v24, v26, s[66:67]
v_cndmask_b32 v25, v25, v27, s[66:67]
s_nop 0
v_add_f32_dpp v24, v24, v24 quad_perm:[1,0,3,2] row_mask:0xf bank_mask:0xf
v_add_f32_dpp v25, v25, v25 quad_perm:[1,0,3,2] row_mask:0xf bank_mask:0xf
v_cndmask_b32 v23, v24, v25, s[68:69]
v_cvt_pk_bf16_f32 v47, v45, v23
v_dot2_f32_bf16 v16, v176, v12, 0
v_dot2_f32_bf16 v17, v180, v12, 0
v_dot2_f32_bf16 v18, v184, v12, 0
v_dot2_f32_bf16 v19, v188, v12, 0
v_dot2_f32_bf16 v16, v177, v13, v16
v_dot2_f32_bf16 v17, v181, v13, v17
v_dot2_f32_bf16 v18, v185, v13, v18
v_dot2_f32_bf16 v19, v189, v13, v19
v_dot2_f32_bf16 v16, v178, v14, v16
v_dot2_f32_bf16 v17, v182, v14, v17
v_dot2_f32_bf16 v18, v186, v14, v18
v_dot2_f32_bf16 v19, v190, v14, v19
v_dot2_f32_bf16 v16, v179, v15, v16
v_dot2_f32_bf16 v17, v183, v15, v17
v_dot2_f32_bf16 v18, v187, v15, v18
v_dot2_f32_bf16 v19, v191, v15, v19
v_mov_b32 v22, v16
s_cmp_ge_u32 s51, 172
s_cbranch_scc1 SK_12
s_mov_b32 s4, s38
s_and_b32 s5, s39, 0xffff
s_mov_b32 s6, 0x158000
s_mov_b32 s7, 0x20000
s_lshl_b32 s57, s3, 7
s_add_u32 s57, s57, 0
v_add_u32 v16, s57, v0
v_mul_u32_u24 v16, 2752, v16
s_lshl_b32 s57, s50, 4
buffer_load_dwordx4 a[232:235], v16, s[4:7], s57 offen
SK_12:
v_mov_b32 v16, v22
s_nop 1
v_add_f32_dpp v20, v16, v16 row_ror:8 row_mask:0xf bank_mask:0x3
v_add_f32_dpp v21, v17, v17 row_ror:8 row_mask:0xf bank_mask:0x3
s_nop 0
v_add_f32_dpp v20, v18, v18 row_ror:8 row_mask:0xf bank_mask:0xc
v_add_f32_dpp v21, v19, v19 row_ror:8 row_mask:0xf bank_mask:0xc
s_nop 0
v_add_f32_dpp v24, v20, v20 row_half_mirror row_mask:0xf bank_mask:0x5
s_nop 1
v_add_f32_dpp v24, v21, v21 row_half_mirror row_mask:0xf bank_mask:0xa
v_dot2_f32_bf16 v16, v192, v12, 0
v_dot2_f32_bf16 v17, v196, v12, 0
v_dot2_f32_bf16 v18, v200, v12, 0
v_dot2_f32_bf16 v19, v204, v12, 0
v_dot2_f32_bf16 v16, v193, v13, v16
v_dot2_f32_bf16 v17, v197, v13, v17
v_dot2_f32_bf16 v18, v201, v13, v18
v_dot2_f32_bf16 v19, v205, v13, v19
v_dot2_f32_bf16 v16, v194, v14, v16
v_dot2_f32_bf16 v17, v198, v14, v17
v_dot2_f32_bf16 v18, v202, v14, v18
v_dot2_f32_bf16 v19, v206, v14, v19
v_dot2_f32_bf16 v16, v195, v15, v16
v_dot2_f32_bf16 v17, v199, v15, v17
v_dot2_f32_bf16 v18, v203, v15, v18
v_dot2_f32_bf16 v19, v207, v15, v19
v_add_f32_dpp v20, v16, v16 row_ror:8 row_mask:0xf bank_mask:0x3
v_add_f32_dpp v21, v17, v17 row_ror:8 row_mask:0xf bank_mask:0x3
s_nop 0
v_add_f32_dpp v20, v18, v18 row_ror:8 row_mask:0xf bank_mask:0xc
v_add_f32_dpp v21, v19, v19 row_ror:8 row_mask:0xf bank_mask:0xc
s_nop 0
v_add_f32_dpp v25, v20, v20 row_half_mirror row_mask:0xf bank_mask:0x5
s_nop 1
v_add_f32_dpp v25, v21, v21 row_half_mirror row_mask:0xf bank_mask:0xa
v_dot2_f32_bf16 v16, v208, v12, 0
v_dot2_f32_bf16 v17, v212, v12, 0
v_dot2_f32_bf16 v18, v216, v12, 0
v_dot2_f32_bf16 v19, v220, v12, 0
v_dot2_f32_bf16 v16, v209, v13, v16
v_dot2_f32_bf16 v17, v213, v13, v17
v_dot2_f32_bf16 v18, v217, v13, v18
v_dot2_f32_bf16 v19, v221, v13, v19
v_dot2_f32_bf16 v16, v210, v14, v16
v_dot2_f32_bf16 v17, v214, v14, v17
v_dot2_f32_bf16 v18, v218, v14, v18
v_dot2_f32_bf16 v19, v222, v14, v19
v_dot2_f32_bf16 v16, v211, v15, v16
v_dot2_f32_bf16 v17, v215, v15, v17
v_dot2_f32_bf16 v18, v219, v15, v18
v_dot2_f32_bf16 v19, v223, v15, v19
v_mov_b32 v22, v16
s_cmp_ge_u32 s51, 172
s_cbranch_scc1 SK_13
s_mov_b32 s4, s38
s_and_b32 s5, s39, 0xffff
s_mov_b32 s6, 0x158000
s_mov_b32 s7, 0x20000
s_lshl_b32 s57, s3, 7
s_add_u32 s57, s57, 64
v_add_u32 v16, s57, v0
v_mul_u32_u24 v16, 2752, v16
s_lshl_b32 s57, s50, 4
buffer_load_dwordx4 a[236:239], v16, s[4:7], s57 offen
SK_13:
v_mov_b32 v16, v22
s_nop 1
v_add_f32_dpp v20, v16, v16 row_ror:8 row_mask:0xf bank_mask:0x3
v_add_f32_dpp v21, v17, v17 row_ror:8 row_mask:0xf bank_mask:0x3
s_nop 0
v_add_f32_dpp v20, v18, v18 row_ror:8 row_mask:0xf bank_mask:0xc
v_add_f32_dpp v21, v19, v19 row_ror:8 row_mask:0xf bank_mask:0xc
s_nop 0
v_add_f32_dpp v26, v20, v20 row_half_mirror row_mask:0xf bank_mask:0x5
s_nop 1
v_add_f32_dpp v26, v21, v21 row_half_mirror row_mask:0xf bank_mask:0xa
v_dot2_f32_bf16 v16, v224, v12, 0
v_dot2_f32_bf16 v17, v228, v12, 0
v_dot2_f32_bf16 v18, v232, v12, 0
v_dot2_f32_bf16 v19, v236, v12, 0
v_dot2_f32_bf16 v16, v225, v13, v16
v_dot2_f32_bf16 v17, v229, v13, v17
v_dot2_f32_bf16 v18, v233, v13, v18
v_dot2_f32_bf16 v19, v237, v13, v19
v_dot2_f32_bf16 v16, v226, v14, v16
v_dot2_f32_bf16 v17, v230, v14, v17
v_dot2_f32_bf16 v18, v234, v14, v18
v_dot2_f32_bf16 v19, v238, v14, v19
v_dot2_f32_bf16 v16, v227, v15, v16
v_dot2_f32_bf16 v17, v231, v15, v17
v_dot2_f32_bf16 v18, v235, v15, v18
v_dot2_f32_bf16 v19, v239, v15, v19
v_add_f32_dpp v20, v16, v16 row_ror:8 row_mask:0xf bank_mask:0x3
v_add_f32_dpp v21, v17, v17 row_ror:8 row_mask:0xf bank_mask:0x3
s_nop 0
v_add_f32_dpp v20, v18, v18 row_ror:8 row_mask:0xf bank_mask:0xc
v_add_f32_dpp v21, v19, v19 row_ror:8 row_mask:0xf bank_mask:0xc
s_nop 0
v_add_f32_dpp v27, v20, v20 row_half_mirror row_mask:0xf bank_mask:0x5
s_nop 1
v_add_f32_dpp v27, v21, v21 row_half_mirror row_mask:0xf bank_mask:0xa
v_add_f32_dpp v24, v24, v24 quad_perm:[2,3,0,1] row_mask:0xf bank_mask:0xf
v_add_f32_dpp v25, v25, v25 quad_perm:[2,3,0,1] row_mask:0xf bank_mask:0xf
v_add_f32_dpp v26, v26, v26 quad_perm:[2,3,0,1] row_mask:0xf bank_mask:0xf
v_add_f32_dpp v27, v27, v27 quad_perm:[2,3,0,1] row_mask:0xf bank_mask:0xf
v_cndmask_b32 v24, v24, v26, s[66:67]
v_cndmask_b32 v25, v25, v27, s[66:67]
s_nop 0
v_add_f32_dpp v24, v24, v24 quad_perm:[1,0,3,2] row_mask:0xf bank_mask:0xf
v_add_f32_dpp v25, v25, v25 quad_perm:[1,0,3,2] row_mask:0xf bank_mask:0xf
v_cndmask_b32 v45, v24, v25, s[68:69]
s_waitcnt vmcnt(28)
v_dot2_f32_bf16 v16, v48, v12, 0
v_dot2_f32_bf16 v17, v52, v12, 0
v_dot2_f32_bf16 v18, v56, v12, 0
v_dot2_f32_bf16 v19, v60, v12, 0
v_dot2_f32_bf16 v16, v49, v13, v16
v_dot2_f32_bf16 v17, v53, v13, v17
v_dot2_f32_bf16 v18, v57, v13, v18
v_dot2_f32_bf16 v19, v61, v13, v19
v_dot2_f32_bf16 v16, v50, v14, v16
v_dot2_f32_bf16 v17, v54, v14, v17
v_dot2_f32_bf16 v18, v58, v14, v18
v_dot2_f32_bf16 v19, v62, v14, v19
v_dot2_f32_bf16 v16, v51, v15, v16
v_dot2_f32_bf16 v17, v55, v15, v17
v_dot2_f32_bf16 v18, v59, v15, v18
v_dot2_f32_bf16 v19, v63, v15, v19
s_add_u32 s57, s77, 524288
buffer_load_dwordx4 v[48:51], v1, s[8:11], s57 offen offset:0
buffer_load_dwordx4 v[52:55], v1, s[8:11], s57 offen offset:1024
buffer_load_dwordx4 v[56:59], v1, s[8:11], s57 offen offset:2048
buffer_load_dwordx4 v[60:63], v1, s[8:11], s57 offen offset:3072
v_add_f32_dpp v20, v16, v16 row_ror:8 row_mask:0xf bank_mask:0x3
v_add_f32_dpp v21, v17, v17 row_ror:8 row_mask:0xf bank_mask:0x3
s_nop 0
v_add_f32_dpp v20, v18, v18 row_ror:8 row_mask:0xf bank_mask:0xc
v_add_f32_dpp v21, v19, v19 row_ror:8 row_mask:0xf bank_mask:0xc
s_nop 0
v_add_f32_dpp v24, v20, v20 row_half_mirror row_mask:0xf bank_mask:0x5
s_nop 1
v_add_f32_dpp v24, v21, v21 row_half_mirror row_mask:0xf bank_mask:0xa
s_waitcnt vmcnt(24)
v_dot2_f32_bf16 v16, v64, v12, 0
v_dot2_f32_bf16 v17, v68, v12, 0
v_dot2_f32_bf16 v18, v72, v12, 0
v_dot2_f32_bf16 v19, v76, v12, 0
v_dot2_f32_bf16 v16, v65, v13, v16
v_dot2_f32_bf16 v17, v69, v13, v17
v_dot2_f32_bf16 v18, v73, v13, v18
v_dot2_f32_bf16 v19, v77, v13, v19
v_dot2_f32_bf16 v16, v66, v14, v16
v_dot2_f32_bf16 v17, v70, v14, v17
v_dot2_f32_bf16 v18, v74, v14, v18
v_dot2_f32_bf16 v19, v78, v14, v19
v_dot2_f32_bf16 v16, v67, v15, v16
v_dot2_f32_bf16 v17, v71, v15, v17
v_dot2_f32_bf16 v18, v75, v15, v18
v_dot2_f32_bf16 v19, v79, v15, v19
s_add_u32 s57, s77, 557056
buffer_load_dwordx4 v[64:67], v1, s[8:11], s57 offen offset:0 nt
buffer_load_dwordx4 v[68:71], v1, s[8:11], s57 offen offset:1024 nt
buffer_load_dwordx4 v[72:75], v1, s[8:11], s57 offen offset:2048 nt
buffer_load_dwordx4 v[76:79], v1, s[8:11], s57 offen offset:3072 nt
v_add_f32_dpp v20, v16, v16 row_ror:8 row_mask:0xf bank_mask:0x3
v_add_f32_dpp v21, v17, v17 row_ror:8 row_mask:0xf bank_mask:0x3
s_nop 0
v_add_f32_dpp v20, v18, v18 row_ror:8 row_mask:0xf bank_mask:0xc
v_add_f32_dpp v21, v19, v19 row_ror:8 row_mask:0xf bank_mask:0xc
s_nop 0
v_add_f32_dpp v25, v20, v20 row_half_mirror row_mask:0xf bank_mask:0x5
s_nop 1
v_add_f32_dpp v25, v21, v21 row_half_mirror row_mask:0xf bank_mask:0xa
s_waitcnt vmcnt(20)
v_dot2_f32_bf16 v16, v80, v12, 0
v_dot2_f32_bf16 v17, v84, v12, 0
v_dot2_f32_bf16 v18, v88, v12, 0
v_dot2_f32_bf16 v19, v92, v12, 0
v_dot2_f32_bf16 v16, v81, v13, v16
v_dot2_f32_bf16 v17, v85, v13, v17
v_dot2_f32_bf16 v18, v89, v13, v18
v_dot2_f32_bf16 v19, v93, v13, v19
v_dot2_f32_bf16 v16, v82, v14, v16
v_dot2_f32_bf16 v17, v86, v14, v17
v_dot2_f32_bf16 v18, v90, v14, v18
v_dot2_f32_bf16 v19, v94, v14, v19
v_dot2_f32_bf16 v16, v83, v15, v16
v_dot2_f32_bf16 v17, v87, v15, v17
v_dot2_f32_bf16 v18, v91, v15, v18
v_dot2_f32_bf16 v19, v95, v15, v19
s_add_u32 s57, s77, 589824
buffer_load_dwordx4 v[80:83], v1, s[8:11], s57 offen offset:0
buffer_load_dwordx4 v[84:87], v1, s[8:11], s57 offen offset:1024
buffer_load_dwordx4 v[88:91], v1, s[8:11], s57 offen offset:2048
buffer_load_dwordx4 v[92:95], v1, s[8:11], s57 offen offset:3072
v_add_f32_dpp v20, v16, v16 row_ror:8 row_mask:0xf bank_mask:0x3
v_add_f32_dpp v21, v17, v17 row_ror:8 row_mask:0xf bank_mask:0x3
s_nop 0
v_add_f32_dpp v20, v18, v18 row_ror:8 row_mask:0xf bank_mask:0xc
v_add_f32_dpp v21, v19, v19 row_ror:8 row_mask:0xf bank_mask:0xc
s_nop 0
v_add_f32_dpp v26, v20, v20 row_half_mirror row_mask:0xf bank_mask:0x5
s_nop 1
v_add_f32_dpp v26, v21, v21 row_half_mirror row_mask:0xf bank_mask:0xa
s_waitcnt vmcnt(16)
v_dot2_f32_bf16 v16, v96, v12, 0
v_dot2_f32_bf16 v17, v100, v12, 0
v_dot2_f32_bf16 v18, v104, v12, 0
v_dot2_f32_bf16 v19, v108, v12, 0
v_dot2_f32_bf16 v16, v97, v13, v16
v_dot2_f32_bf16 v17, v101, v13, v17
v_dot2_f32_bf16 v18, v105, v13, v18
v_dot2_f32_bf16 v19, v109, v13, v19
v_dot2_f32_bf16 v16, v98, v14, v16
v_dot2_f32_bf16 v17, v102, v14, v17
v_dot2_f32_bf16 v18, v106, v14, v18
v_dot2_f32_bf16 v19, v110, v14, v19
v_dot2_f32_bf16 v16, v99, v15, v16
v_dot2_f32_bf16 v17, v103, v15, v17
v_dot2_f32_bf16 v18, v107, v15, v18
v_dot2_f32_bf16 v19, v111, v15, v19
s_add_u32 s57, s77, 622592
buffer_load_dwordx4 v[96:99], v1, s[8:11], s57 offen offset:0 nt
buffer_load_dwordx4 v[100:103], v1, s[8:11], s57 offen offset:1024 nt
buffer_load_dwordx4 v[104:107], v1, s[8:11], s57 offen offset:2048 nt
buffer_load_dwordx4 v[108:111], v1, s[8:11], s57 offen offset:3072 nt
v_add_f32_dpp v20, v16, v16 row_ror:8 row_mask:0xf bank_mask:0x3
v_add_f32_dpp v21, v17, v17 row_ror:8 row_mask:0xf bank_mask:0x3
s_nop 0
v_add_f32_dpp v20, v18, v18 row_ror:8 row_mask:0xf bank_mask:0xc
v_add_f32_dpp v21, v19, v19 row_ror:8 row_mask:0xf bank_mask:0xc
s_nop 0
v_add_f32_dpp v27, v20, v20 row_half_mirror row_mask:0xf bank_mask:0x5
s_nop 1
v_add_f32_dpp v27, v21, v21 row_half_mirror row_mask:0xf bank_mask:0xa
v_add_f32_dpp v24, v24, v24 quad_perm:[2,3,0,1] row_mask:0xf bank_mask:0xf
v_add_f32_dpp v25, v25, v25 quad_perm:[2,3,0,1] row_mask:0xf bank_mask:0xf
v_add_f32_dpp v26, v26, v26 quad_perm:[2,3,0,1] row_mask:0xf bank_mask:0xf
v_add_f32_dpp v27, v27, v27 quad_perm:[2,3,0,1] row_mask:0xf bank_mask:0xf
v_cndmask_b32 v24, v24, v26, s[66:67]
v_cndmask_b32 v25, v25, v27, s[66:67]
s_nop 0
v_add_f32_dpp v24, v24, v24 quad_perm:[1,0,3,2] row_mask:0xf bank_mask:0xf
v_add_f32_dpp v25, v25, v25 quad_perm:[1,0,3,2] row_mask:0xf bank_mask:0xf
v_cndmask_b32 v23, v24, v25, s[68:69]
v_mov_b32 v28, v29
v_mov_b32 v29, v30
v_mov_b32 v30, v31
v_cvt_pk_bf16_f32 v31, v45, v23
s_add_u32 s56, s77, 655360
s_mov_b32 s55, 2
LOOP_14:
s_waitcnt vmcnt(12)
v_dot2_f32_bf16 v16, v48, v12, 0
v_dot2_f32_bf16 v17, v52, v12, 0
v_dot2_f32_bf16 v18, v56, v12, 0
v_dot2_f32_bf16 v19, v60, v12, 0
v_dot2_f32_bf16 v16, v49, v13, v16
v_dot2_f32_bf16 v17, v53, v13, v17
v_dot2_f32_bf16 v18, v57, v13, v18
v_dot2_f32_bf16 v19, v61, v13, v19
v_dot2_f32_bf16 v16, v50, v14, v16
v_dot2_f32_bf16 v17, v54, v14, v17
v_dot2_f32_bf16 v18, v58, v14, v18
v_dot2_f32_bf16 v19, v62, v14, v19
v_dot2_f32_bf16 v16, v51, v15, v16
v_dot2_f32_bf16 v17, v55, v15, v17
v_dot2_f32_bf16 v18, v59, v15, v18
v_dot2_f32_bf16 v19, v63, v15, v19
buffer_load_dwordx4 v[48:51], v1, s[8:11], s56 offen offset:0
buffer_load_dwordx4 v[52:55], v1, s[8:11], s56 offen offset:1024
buffer_load_dwordx4 v[56:59], v1, s[8:11], s56 offen offset:2048
buffer_load_dwordx4 v[60:63], v1, s[8:11], s56 offen offset:3072
s_add_u32 s56, s56, 32768
v_add_f32_dpp v20, v16, v16 row_ror:8 row_mask:0xf bank_mask:0x3
v_add_f32_dpp v21, v17, v17 row_ror:8 row_mask:0xf bank_mask:0x3
s_nop 0
v_add_f32_dpp v20, v18, v18 row_ror:8 row_mask:0xf bank_mask:0xc
v_add_f32_dpp v21, v19, v19 row_ror:8 row_mask:0xf bank_mask:0xc
s_nop 0
v_add_f32_dpp v24, v20, v20 row_half_mirror row_mask:0xf bank_mask:0x5
s_nop 1
v_add_f32_dpp v24, v21, v21 row_half_mirror row_mask:0xf bank_mask:0xa
s_waitcnt vmcnt(12)
v_dot2_f32_bf16 v16, v64, v12, 0
v_dot2_f32_bf16 v17, v68, v12, 0
v_dot2_f32_bf16 v18, v72, v12, 0
v_dot2_f32_bf16 v19, v76, v12, 0
v_dot2_f32_bf16 v16, v65, v13, v16
v_dot2_f32_bf16 v17, v69, v13, v17
v_dot2_f32_bf16 v18, v73, v13, v18
v_dot2_f32_bf16 v19, v77, v13, v19
v_dot2_f32_bf16 v16, v66, v14, v16
v_dot2_f32_bf16 v17, v70, v14, v17
v_dot2_f32_bf16 v18, v74, v14, v18
v_dot2_f32_bf16 v19, v78, v14, v19
v_dot2_f32_bf16 v16, v67, v15, v16
v_dot2_f32_bf16 v17, v71, v15, v17
v_dot2_f32_bf16 v18, v75, v15, v18
v_dot2_f32_bf16 v19, v79, v15, v19
buffer_load_dwordx4 v[64:67], v1, s[8:11], s56 offen offset:0 nt
buffer_load_dwordx4 v[68:71], v1, s[8:11], s56 offen offset:1024 nt
buffer_load_dwordx4 v[72:75], v1, s[8:11], s56 offen offset:2048 nt
buffer_load_dwordx4 v[76:79], v1, s[8:11], s56 offen offset:3072 nt
s_add_u32 s56, s56, 32768
v_add_f32_dpp v20, v16, v16 row_ror:8 row_mask:0xf bank_mask:0x3
v_add_f32_dpp v21, v17, v17 row_ror:8 row_mask:0xf bank_mask:0x3
s_nop 0
v_add_f32_dpp v20, v18, v18 row_ror:8 row_mask:0xf bank_mask:0xc
v_add_f32_dpp v21, v19, v19 row_ror:8 row_mask:0xf bank_mask:0xc
s_nop 0
v_add_f32_dpp v25, v20, v20 row_half_mirror row_mask:0xf bank_mask:0x5
s_nop 1
v_add_f32_dpp v25, v21, v21 row_half_mirror row_mask:0xf bank_mask:0xa
s_waitcnt vmcnt(12)
v_dot2_f32_bf16 v16, v80, v12, 0
v_dot2_f32_bf16 v17, v84, v12, 0
v_dot2_f32_bf16 v18, v88, v12, 0
v_dot2_f32_bf16 v19, v92, v12, 0
v_dot2_f32_bf16 v16, v81, v13, v16
v_dot2_f32_bf16 v17, v85, v13, v17
v_dot2_f32_bf16 v18, v89, v13, v18
v_dot2_f32_bf16 v19, v93, v13, v19
v_dot2_f32_bf16 v16, v82, v14, v16
v_dot2_f32_bf16 v17, v86, v14, v17
v_dot2_f32_bf16 v18, v90, v14, v18
v_dot2_f32_bf16 v19, v94, v14, v19
v_dot2_f32_bf16 v16, v83, v15, v16
v_dot2_f32_bf16 v17, v87, v15, v17
v_dot2_f32_bf16 v18, v91, v15, v18
v_dot2_f32_bf16 v19, v95, v15, v19
buffer_load_dwordx4 v[80:83], v1, s[8:11], s56 offen offset:0
buffer_load_dwordx4 v[84:87], v1, s[8:11], s56 offen offset:1024
buffer_load_dwordx4 v[88:91], v1, s[8:11], s56 offen offset:2048
buffer_load_dwordx4 v[92:95], v1, s[8:11], s56 offen offset:3072
s_add_u32 s56, s56, 32768
v_add_f32_dpp v20, v16, v16 row_ror:8 row_mask:0xf bank_mask:0x3
v_add_f32_dpp v21, v17, v17 row_ror:8 row_mask:0xf bank_mask:0x3
s_nop 0
v_add_f32_dpp v20, v18, v18 row_ror:8 row_mask:0xf bank_mask:0xc
v_add_f32_dpp v21, v19, v19 row_ror:8 row_mask:0xf bank_mask:0xc
s_nop 0
v_add_f32_dpp v26, v20, v20 row_half_mirror row_mask:0xf bank_mask:0x5
s_nop 1
v_add_f32_dpp v26, v21, v21 row_half_mirror row_mask:0xf bank_mask:0xa
s_waitcnt vmcnt(12)
v_dot2_f32_bf16 v16, v96, v12, 0
v_dot2_f32_bf16 v17, v100, v12, 0
v_dot2_f32_bf16 v18, v104, v12, 0
v_dot2_f32_bf16 v19, v108, v12, 0
v_dot2_f32_bf16 v16, v97, v13, v16
v_dot2_f32_bf16 v17, v101, v13, v17
v_dot2_f32_bf16 v18, v105, v13, v18
v_dot2_f32_bf16 v19, v109, v13, v19
v_dot2_f32_bf16 v16, v98, v14, v16
v_dot2_f32_bf16 v17, v102, v14, v17
v_dot2_f32_bf16 v18, v106, v14, v18
v_dot2_f32_bf16 v19, v110, v14, v19
v_dot2_f32_bf16 v16, v99, v15, v16
v_dot2_f32_bf16 v17, v103, v15, v17
v_dot2_f32_bf16 v18, v107, v15, v18
v_dot2_f32_bf16 v19, v111, v15, v19
buffer_load_dwordx4 v[96:99], v1, s[8:11], s56 offen offset:0 nt
buffer_load_dwordx4 v[100:103], v1, s[8:11], s56 offen offset:1024 nt
buffer_load_dwordx4 v[104:107], v1, s[8:11], s56 offen offset:2048 nt
buffer_load_dwordx4 v[108:111], v1, s[8:11], s56 offen offset:3072 nt
s_add_u32 s56, s56, 32768
v_add_f32_dpp v20, v16, v16 row_ror:8 row_mask:0xf bank_mask:0x3
v_add_f32_dpp v21, v17, v17 row_ror:8 row_mask:0xf bank_mask:0x3
s_nop 0
v_add_f32_dpp v20, v18, v18 row_ror:8 row_mask:0xf bank_mask:0xc
v_add_f32_dpp v21, v19, v19 row_ror:8 row_mask:0xf bank_mask:0xc
s_nop 0
v_add_f32_dpp v27, v20, v20 row_half_mirror row_mask:0xf bank_mask:0x5
s_nop 1
v_add_f32_dpp v27, v21, v21 row_half_mirror row_mask:0xf bank_mask:0xa
v_add_f32_dpp v24, v24, v24 quad_perm:[2,3,0,1] row_mask:0xf bank_mask:0xf
v_add_f32_dpp v25, v25, v25 quad_perm:[2,3,0,1] row_mask:0xf bank_mask:0xf
v_add_f32_dpp v26, v26, v26 quad_perm:[2,3,0,1] row_mask:0xf bank_mask:0xf
v_add_f32_dpp v27, v27, v27 quad_perm:[2,3,0,1] row_mask:0xf bank_mask:0xf
v_cndmask_b32 v24, v24, v26, s[66:67]
v_cndmask_b32 v25, v25, v27, s[66:67]
s_nop 0
v_add_f32_dpp v24, v24, v24 quad_perm:[1,0,3,2] row_mask:0xf bank_mask:0xf
v_add_f32_dpp v25, v25, v25 quad_perm:[1,0,3,2] row_mask:0xf bank_mask:0xf
v_cndmask_b32 v45, v24, v25, s[68:69]
s_waitcnt vmcnt(12)
v_dot2_f32_bf16 v16, v48, v12, 0
v_dot2_f32_bf16 v17, v52, v12, 0
v_dot2_f32_bf16 v18, v56, v12, 0
v_dot2_f32_bf16 v19, v60, v12, 0
v_dot2_f32_bf16 v16, v49, v13, v16
v_dot2_f32_bf16 v17, v53, v13, v17
v_dot2_f32_bf16 v18, v57, v13, v18
v_dot2_f32_bf16 v19, v61, v13, v19
v_dot2_f32_bf16 v16, v50, v14, v16
v_dot2_f32_bf16 v17, v54, v14, v17
v_dot2_f32_bf16 v18, v58, v14, v18
v_dot2_f32_bf16 v19, v62, v14, v19
v_dot2_f32_bf16 v16, v51, v15, v16
v_dot2_f32_bf16 v17, v55, v15, v17
v_dot2_f32_bf16 v18, v59, v15, v18
v_dot2_f32_bf16 v19, v63, v15, v19
buffer_load_dwordx4 v[48:51], v1, s[8:11], s56 offen offset:0
buffer_load_dwordx4 v[52:55], v1, s[8:11], s56 offen offset:1024
buffer_load_dwordx4 v[56:59], v1, s[8:11], s56 offen offset:2048
buffer_load_dwordx4 v[60:63], v1, s[8:11], s56 offen offset:3072
s_add_u32 s56, s56, 32768
v_add_f32_dpp v20, v16, v16 row_ror:8 row_mask:0xf bank_mask:0x3
v_add_f32_dpp v21, v17, v17 row_ror:8 row_mask:0xf bank_mask:0x3
s_nop 0
v_add_f32_dpp v20, v18, v18 row_ror:8 row_mask:0xf bank_mask:0xc
v_add_f32_dpp v21, v19, v19 row_ror:8 row_mask:0xf bank_mask:0xc
s_nop 0
v_add_f32_dpp v24, v20, v20 row_half_mirror row_mask:0xf bank_mask:0x5
s_nop 1
v_add_f32_dpp v24, v21, v21 row_half_mirror row_mask:0xf bank_mask:0xa
s_waitcnt vmcnt(12)
v_dot2_f32_bf16 v16, v64, v12, 0
v_dot2_f32_bf16 v17, v68, v12, 0
v_dot2_f32_bf16 v18, v72, v12, 0
v_dot2_f32_bf16 v19, v76, v12, 0
v_dot2_f32_bf16 v16, v65, v13, v16
v_dot2_f32_bf16 v17, v69, v13, v17
v_dot2_f32_bf16 v18, v73, v13, v18
v_dot2_f32_bf16 v19, v77, v13, v19
v_dot2_f32_bf16 v16, v66, v14, v16
v_dot2_f32_bf16 v17, v70, v14, v17
v_dot2_f32_bf16 v18, v74, v14, v18
v_dot2_f32_bf16 v19, v78, v14, v19
v_dot2_f32_bf16 v16, v67, v15, v16
v_dot2_f32_bf16 v17, v71, v15, v17
v_dot2_f32_bf16 v18, v75, v15, v18
v_dot2_f32_bf16 v19, v79, v15, v19
buffer_load_dwordx4 v[64:67], v1, s[8:11], s56 offen offset:0 nt
buffer_load_dwordx4 v[68:71], v1, s[8:11], s56 offen offset:1024 nt
buffer_load_dwordx4 v[72:75], v1, s[8:11], s56 offen offset:2048 nt
buffer_load_dwordx4 v[76:79], v1, s[8:11], s56 offen offset:3072 nt
s_add_u32 s56, s56, 32768
v_add_f32_dpp v20, v16, v16 row_ror:8 row_mask:0xf bank_mask:0x3
v_add_f32_dpp v21, v17, v17 row_ror:8 row_mask:0xf bank_mask:0x3
s_nop 0
v_add_f32_dpp v20, v18, v18 row_ror:8 row_mask:0xf bank_mask:0xc
v_add_f32_dpp v21, v19, v19 row_ror:8 row_mask:0xf bank_mask:0xc
s_nop 0
v_add_f32_dpp v25, v20, v20 row_half_mirror row_mask:0xf bank_mask:0x5
s_nop 1
v_add_f32_dpp v25, v21, v21 row_half_mirror row_mask:0xf bank_mask:0xa
s_waitcnt vmcnt(12)
v_dot2_f32_bf16 v16, v80, v12, 0
v_dot2_f32_bf16 v17, v84, v12, 0
v_dot2_f32_bf16 v18, v88, v12, 0
v_dot2_f32_bf16 v19, v92, v12, 0
v_dot2_f32_bf16 v16, v81, v13, v16
v_dot2_f32_bf16 v17, v85, v13, v17
v_dot2_f32_bf16 v18, v89, v13, v18
v_dot2_f32_bf16 v19, v93, v13, v19
v_dot2_f32_bf16 v16, v82, v14, v16
v_dot2_f32_bf16 v17, v86, v14, v17
v_dot2_f32_bf16 v18, v90, v14, v18
v_dot2_f32_bf16 v19, v94, v14, v19
v_dot2_f32_bf16 v16, v83, v15, v16
v_dot2_f32_bf16 v17, v87, v15, v17
v_dot2_f32_bf16 v18, v91, v15, v18
v_dot2_f32_bf16 v19, v95, v15, v19
buffer_load_dwordx4 v[80:83], v1, s[8:11], s56 offen offset:0
buffer_load_dwordx4 v[84:87], v1, s[8:11], s56 offen offset:1024
buffer_load_dwordx4 v[88:91], v1, s[8:11], s56 offen offset:2048
buffer_load_dwordx4 v[92:95], v1, s[8:11], s56 offen offset:3072
s_add_u32 s56, s56, 32768
v_add_f32_dpp v20, v16, v16 row_ror:8 row_mask:0xf bank_mask:0x3
v_add_f32_dpp v21, v17, v17 row_ror:8 row_mask:0xf bank_mask:0x3
s_nop 0
v_add_f32_dpp v20, v18, v18 row_ror:8 row_mask:0xf bank_mask:0xc
v_add_f32_dpp v21, v19, v19 row_ror:8 row_mask:0xf bank_mask:0xc
s_nop 0
v_add_f32_dpp v26, v20, v20 row_half_mirror row_mask:0xf bank_mask:0x5
s_nop 1
v_add_f32_dpp v26, v21, v21 row_half_mirror row_mask:0xf bank_mask:0xa
s_waitcnt vmcnt(12)
v_dot2_f32_bf16 v16, v96, v12, 0
v_dot2_f32_bf16 v17, v100, v12, 0
v_dot2_f32_bf16 v18, v104, v12, 0
v_dot2_f32_bf16 v19, v108, v12, 0
v_dot2_f32_bf16 v16, v97, v13, v16
v_dot2_f32_bf16 v17, v101, v13, v17
v_dot2_f32_bf16 v18, v105, v13, v18
v_dot2_f32_bf16 v19, v109, v13, v19
v_dot2_f32_bf16 v16, v98, v14, v16
v_dot2_f32_bf16 v17, v102, v14, v17
v_dot2_f32_bf16 v18, v106, v14, v18
v_dot2_f32_bf16 v19, v110, v14, v19
v_dot2_f32_bf16 v16, v99, v15, v16
v_dot2_f32_bf16 v17, v103, v15, v17
v_dot2_f32_bf16 v18, v107, v15, v18
v_dot2_f32_bf16 v19, v111, v15, v19
buffer_load_dwordx4 v[96:99], v1, s[8:11], s56 offen offset:0 nt
buffer_load_dwordx4 v[100:103], v1, s[8:11], s56 offen offset:1024 nt
buffer_load_dwordx4 v[104:107], v1, s[8:11], s56 offen offset:2048 nt
buffer_load_dwordx4 v[108:111], v1, s[8:11], s56 offen offset:3072 nt
s_add_u32 s56, s56, 32768
v_add_f32_dpp v20, v16, v16 row_ror:8 row_mask:0xf bank_mask:0x3
v_add_f32_dpp v21, v17, v17 row_ror:8 row_mask:0xf bank_mask:0x3
s_nop 0
v_add_f32_dpp v20, v18, v18 row_ror:8 row_mask:0xf bank_mask:0xc
v_add_f32_dpp v21, v19, v19 row_ror:8 row_mask:0xf bank_mask:0xc
s_nop 0
v_add_f32_dpp v27, v20, v20 row_half_mirror row_mask:0xf bank_mask:0x5
s_nop 1
v_add_f32_dpp v27, v21, v21 row_half_mirror row_mask:0xf bank_mask:0xa
v_add_f32_dpp v24, v24, v24 quad_perm:[2,3,0,1] row_mask:0xf bank_mask:0xf
v_add_f32_dpp v25, v25, v25 quad_perm:[2,3,0,1] row_mask:0xf bank_mask:0xf
v_add_f32_dpp v26, v26, v26 quad_perm:[2,3,0,1] row_mask:0xf bank_mask:0xf
v_add_f32_dpp v27, v27, v27 quad_perm:[2,3,0,1] row_mask:0xf bank_mask:0xf
v_cndmask_b32 v24, v24, v26, s[66:67]
v_cndmask_b32 v25, v25, v27, s[66:67]
s_nop 0
v_add_f32_dpp v24, v24, v24 quad_perm:[1,0,3,2] row_mask:0xf bank_mask:0xf
v_add_f32_dpp v25, v25, v25 quad_perm:[1,0,3,2] row_mask:0xf bank_mask:0xf
v_cndmask_b32 v23, v24, v25, s[68:69]
v_mov_b32 v28, v29
v_mov_b32 v29, v30
v_mov_b32 v30, v31
v_cvt_pk_bf16_f32 v31, v45, v23
s_sub_u32 s55, s55, 1
s_cmp_lg_u32 s55, 0
s_cbranch_scc1 LOOP_14
buffer_store_dwordx4 v[28:31], v1, s[16:19], s72 offen offset:0 sc1
s_waitcnt vmcnt(13)
v_dot2_f32_bf16 v16, v48, v12, 0
v_dot2_f32_bf16 v17, v52, v12, 0
v_dot2_f32_bf16 v18, v56, v12, 0
v_dot2_f32_bf16 v19, v60, v12, 0
v_dot2_f32_bf16 v16, v49, v13, v16
v_dot2_f32_bf16 v17, v53, v13, v17
v_dot2_f32_bf16 v18, v57, v13, v18
v_dot2_f32_bf16 v19, v61, v13, v19
v_dot2_f32_bf16 v16, v50, v14, v16
v_dot2_f32_bf16 v17, v54, v14, v17
v_dot2_f32_bf16 v18, v58, v14, v18
v_dot2_f32_bf16 v19, v62, v14, v19
v_dot2_f32_bf16 v16, v51, v15, v16
v_dot2_f32_bf16 v17, v55, v15, v17
v_dot2_f32_bf16 v18, v59, v15, v18
v_dot2_f32_bf16 v19, v63, v15, v19
s_add_u32 s57, s77, 1179648
buffer_load_dwordx4 v[48:51], v1, s[8:11], s57 offen offset:0
buffer_load_dwordx4 v[52:55], v1, s[8:11], s57 offen offset:1024
buffer_load_dwordx4 v[56:59], v1, s[8:11], s57 offen offset:2048
buffer_load_dwordx4 v[60:63], v1, s[8:11], s57 offen offset:3072
v_add_f32_dpp v20, v16, v16 row_ror:8 row_mask:0xf bank_mask:0x3
v_add_f32_dpp v21, v17, v17 row_ror:8 row_mask:0xf bank_mask:0x3
s_nop 0
v_add_f32_dpp v20, v18, v18 row_ror:8 row_mask:0xf bank_mask:0xc
v_add_f32_dpp v21, v19, v19 row_ror:8 row_mask:0xf bank_mask:0xc
s_nop 0
v_add_f32_dpp v24, v20, v20 row_half_mirror row_mask:0xf bank_mask:0x5
s_nop 1
v_add_f32_dpp v24, v21, v21 row_half_mirror row_mask:0xf bank_mask:0xa
s_waitcnt vmcnt(13)
v_dot2_f32_bf16 v16, v64, v12, 0
v_dot2_f32_bf16 v17, v68, v12, 0
v_dot2_f32_bf16 v18, v72, v12, 0
v_dot2_f32_bf16 v19, v76, v12, 0
v_dot2_f32_bf16 v16, v65, v13, v16
v_dot2_f32_bf16 v17, v69, v13, v17
v_dot2_f32_bf16 v18, v73, v13, v18
v_dot2_f32_bf16 v19, v77, v13, v19
v_dot2_f32_bf16 v16, v66, v14, v16
v_dot2_f32_bf16 v17, v70, v14, v17
v_dot2_f32_bf16 v18, v74, v14, v18
v_dot2_f32_bf16 v19, v78, v14, v19
v_dot2_f32_bf16 v16, v67, v15, v16
v_dot2_f32_bf16 v17, v71, v15, v17
v_dot2_f32_bf16 v18, v75, v15, v18
v_dot2_f32_bf16 v19, v79, v15, v19
s_add_u32 s57, s77, 1212416
buffer_load_dwordx4 v[64:67], v1, s[8:11], s57 offen offset:0 nt
buffer_load_dwordx4 v[68:71], v1, s[8:11], s57 offen offset:1024 nt
buffer_load_dwordx4 v[72:75], v1, s[8:11], s57 offen offset:2048 nt
buffer_load_dwordx4 v[76:79], v1, s[8:11], s57 offen offset:3072 nt
v_add_f32_dpp v20, v16, v16 row_ror:8 row_mask:0xf bank_mask:0x3
v_add_f32_dpp v21, v17, v17 row_ror:8 row_mask:0xf bank_mask:0x3
s_nop 0
v_add_f32_dpp v20, v18, v18 row_ror:8 row_mask:0xf bank_mask:0xc
v_add_f32_dpp v21, v19, v19 row_ror:8 row_mask:0xf bank_mask:0xc
s_nop 0
v_add_f32_dpp v25, v20, v20 row_half_mirror row_mask:0xf bank_mask:0x5
s_nop 1
v_add_f32_dpp v25, v21, v21 row_half_mirror row_mask:0xf bank_mask:0xa
s_waitcnt vmcnt(13)
v_dot2_f32_bf16 v16, v80, v12, 0
v_dot2_f32_bf16 v17, v84, v12, 0
v_dot2_f32_bf16 v18, v88, v12, 0
v_dot2_f32_bf16 v19, v92, v12, 0
v_dot2_f32_bf16 v16, v81, v13, v16
v_dot2_f32_bf16 v17, v85, v13, v17
v_dot2_f32_bf16 v18, v89, v13, v18
v_dot2_f32_bf16 v19, v93, v13, v19
v_dot2_f32_bf16 v16, v82, v14, v16
v_dot2_f32_bf16 v17, v86, v14, v17
v_dot2_f32_bf16 v18, v90, v14, v18
v_dot2_f32_bf16 v19, v94, v14, v19
v_dot2_f32_bf16 v16, v83, v15, v16
v_dot2_f32_bf16 v17, v87, v15, v17
v_dot2_f32_bf16 v18, v91, v15, v18
v_dot2_f32_bf16 v19, v95, v15, v19
s_add_u32 s57, s77, 1245184
buffer_load_dwordx4 v[80:83], v1, s[8:11], s57 offen offset:0
buffer_load_dwordx4 v[84:87], v1, s[8:11], s57 offen offset:1024
buffer_load_dwordx4 v[88:91], v1, s[8:11], s57 offen offset:2048
buffer_load_dwordx4 v[92:95], v1, s[8:11], s57 offen offset:3072
v_add_f32_dpp v20, v16, v16 row_ror:8 row_mask:0xf bank_mask:0x3
v_add_f32_dpp v21, v17, v17 row_ror:8 row_mask:0xf bank_mask:0x3
s_nop 0
v_add_f32_dpp v20, v18, v18 row_ror:8 row_mask:0xf bank_mask:0xc
v_add_f32_dpp v21, v19, v19 row_ror:8 row_mask:0xf bank_mask:0xc
s_nop 0
v_add_f32_dpp v26, v20, v20 row_half_mirror row_mask:0xf bank_mask:0x5
s_nop 1
v_add_f32_dpp v26, v21, v21 row_half_mirror row_mask:0xf bank_mask:0xa
s_waitcnt vmcnt(13)
v_dot2_f32_bf16 v16, v96, v12, 0
v_dot2_f32_bf16 v17, v100, v12, 0
v_dot2_f32_bf16 v18, v104, v12, 0
v_dot2_f32_bf16 v19, v108, v12, 0
v_dot2_f32_bf16 v16, v97, v13, v16
v_dot2_f32_bf16 v17, v101, v13, v17
v_dot2_f32_bf16 v18, v105, v13, v18
v_dot2_f32_bf16 v19, v109, v13, v19
v_dot2_f32_bf16 v16, v98, v14, v16
v_dot2_f32_bf16 v17, v102, v14, v17
v_dot2_f32_bf16 v18, v106, v14, v18
v_dot2_f32_bf16 v19, v110, v14, v19
v_dot2_f32_bf16 v16, v99, v15, v16
v_dot2_f32_bf16 v17, v103, v15, v17
v_dot2_f32_bf16 v18, v107, v15, v18
v_dot2_f32_bf16 v19, v111, v15, v19
s_add_u32 s57, s77, 1277952
buffer_load_dwordx4 v[96:99], v1, s[8:11], s57 offen offset:0 nt
buffer_load_dwordx4 v[100:103], v1, s[8:11], s57 offen offset:1024 nt
buffer_load_dwordx4 v[104:107], v1, s[8:11], s57 offen offset:2048 nt
buffer_load_dwordx4 v[108:111], v1, s[8:11], s57 offen offset:3072 nt
v_add_f32_dpp v20, v16, v16 row_ror:8 row_mask:0xf bank_mask:0x3
v_add_f32_dpp v21, v17, v17 row_ror:8 row_mask:0xf bank_mask:0x3
s_nop 0
v_add_f32_dpp v20, v18, v18 row_ror:8 row_mask:0xf bank_mask:0xc
v_add_f32_dpp v21, v19, v19 row_ror:8 row_mask:0xf bank_mask:0xc
s_nop 0
v_add_f32_dpp v27, v20, v20 row_half_mirror row_mask:0xf bank_mask:0x5
s_nop 1
v_add_f32_dpp v27, v21, v21 row_half_mirror row_mask:0xf bank_mask:0xa
v_add_f32_dpp v24, v24, v24 quad_perm:[2,3,0,1] row_mask:0xf bank_mask:0xf
v_add_f32_dpp v25, v25, v25 quad_perm:[2,3,0,1] row_mask:0xf bank_mask:0xf
v_add_f32_dpp v26, v26, v26 quad_perm:[2,3,0,1] row_mask:0xf bank_mask:0xf
v_add_f32_dpp v27, v27, v27 quad_perm:[2,3,0,1] row_mask:0xf bank_mask:0xf
v_cndmask_b32 v24, v24, v26, s[66:67]
v_cndmask_b32 v25, v25, v27, s[66:67]
s_nop 0
v_add_f32_dpp v24, v24, v24 quad_perm:[1,0,3,2] row_mask:0xf bank_mask:0xf
v_add_f32_dpp v25, v25, v25 quad_perm:[1,0,3,2] row_mask:0xf bank_mask:0xf
v_cndmask_b32 v45, v24, v25, s[68:69]
s_waitcnt vmcnt(12)
v_dot2_f32_bf16 v16, v48, v12, 0
v_dot2_f32_bf16 v17, v52, v12, 0
v_dot2_f32_bf16 v18, v56, v12, 0
v_dot2_f32_bf16 v19, v60, v12, 0
v_dot2_f32_bf16 v16, v49, v13, v16
v_dot2_f32_bf16 v17, v53, v13, v17
v_dot2_f32_bf16 v18, v57, v13, v18
v_dot2_f32_bf16 v19, v61, v13, v19
v_dot2_f32_bf16 v16, v50, v14, v16
v_dot2_f32_bf16 v17, v54, v14, v17
v_dot2_f32_bf16 v18, v58, v14, v18
v_dot2_f32_bf16 v19, v62, v14, v19
v_dot2_f32_bf16 v16, v51, v15, v16
v_dot2_f32_bf16 v17, v55, v15, v17
v_dot2_f32_bf16 v18, v59, v15, v18
v_dot2_f32_bf16 v19, v63, v15, v19
s_add_u32 s57, s77, 1310720
buffer_load_dwordx4 v[48:51], v1, s[8:11], s57 offen offset:0
buffer_load_dwordx4 v[52:55], v1, s[8:11], s57 offen offset:1024
buffer_load_dwordx4 v[56:59], v1, s[8:11], s57 offen offset:2048
buffer_load_dwordx4 v[60:63], v1, s[8:11], s57 offen offset:3072
v_add_f32_dpp v20, v16, v16 row_ror:8 row_mask:0xf bank_mask:0x3
v_add_f32_dpp v21, v17, v17 row_ror:8 row_mask:0xf bank_mask:0x3
s_nop 0
v_add_f32_dpp v20, v18, v18 row_ror:8 row_mask:0xf bank_mask:0xc
v_add_f32_dpp v21, v19, v19 row_ror:8 row_mask:0xf bank_mask:0xc
s_nop 0
v_add_f32_dpp v24, v20, v20 row_half_mirror row_mask:0xf bank_mask:0x5
s_nop 1
v_add_f32_dpp v24, v21, v21 row_half_mirror row_mask:0xf bank_mask:0xa
s_waitcnt vmcnt(12)
v_dot2_f32_bf16 v16, v64, v12, 0
v_dot2_f32_bf16 v17, v68, v12, 0
v_dot2_f32_bf16 v18, v72, v12, 0
v_dot2_f32_bf16 v19, v76, v12, 0
v_dot2_f32_bf16 v16, v65, v13, v16
v_dot2_f32_bf16 v17, v69, v13, v17
v_dot2_f32_bf16 v18, v73, v13, v18
v_dot2_f32_bf16 v19, v77, v13, v19
v_dot2_f32_bf16 v16, v66, v14, v16
v_dot2_f32_bf16 v17, v70, v14, v17
v_dot2_f32_bf16 v18, v74, v14, v18
v_dot2_f32_bf16 v19, v78, v14, v19
v_dot2_f32_bf16 v16, v67, v15, v16
v_dot2_f32_bf16 v17, v71, v15, v17
v_dot2_f32_bf16 v18, v75, v15, v18
v_dot2_f32_bf16 v19, v79, v15, v19
s_add_u32 s57, s77, 1343488
buffer_load_dwordx4 v[64:67], v1, s[8:11], s57 offen offset:0 nt
buffer_load_dwordx4 v[68:71], v1, s[8:11], s57 offen offset:1024 nt
buffer_load_dwordx4 v[72:75], v1, s[8:11], s57 offen offset:2048 nt
buffer_load_dwordx4 v[76:79], v1, s[8:11], s57 offen offset:3072 nt
v_add_f32_dpp v20, v16, v16 row_ror:8 row_mask:0xf bank_mask:0x3
v_add_f32_dpp v21, v17, v17 row_ror:8 row_mask:0xf bank_mask:0x3
s_nop 0
v_add_f32_dpp v20, v18, v18 row_ror:8 row_mask:0xf bank_mask:0xc
v_add_f32_dpp v21, v19, v19 row_ror:8 row_mask:0xf bank_mask:0xc
s_nop 0
v_add_f32_dpp v25, v20, v20 row_half_mirror row_mask:0xf bank_mask:0x5
s_nop 1
v_add_f32_dpp v25, v21, v21 row_half_mirror row_mask:0xf bank_mask:0xa
s_waitcnt vmcnt(12)
v_dot2_f32_bf16 v16, v80, v12, 0
v_dot2_f32_bf16 v17, v84, v12, 0
v_dot2_f32_bf16 v18, v88, v12, 0
v_dot2_f32_bf16 v19, v92, v12, 0
v_dot2_f32_bf16 v16, v81, v13, v16
v_dot2_f32_bf16 v17, v85, v13, v17
v_dot2_f32_bf16 v18, v89, v13, v18
v_dot2_f32_bf16 v19, v93, v13, v19
v_dot2_f32_bf16 v16, v82, v14, v16
v_dot2_f32_bf16 v17, v86, v14, v17
v_dot2_f32_bf16 v18, v90, v14, v18
v_dot2_f32_bf16 v19, v94, v14, v19
v_dot2_f32_bf16 v16, v83, v15, v16
v_dot2_f32_bf16 v17, v87, v15, v17
v_dot2_f32_bf16 v18, v91, v15, v18
v_dot2_f32_bf16 v19, v95, v15, v19
s_add_u32 s57, s77, 1376256
buffer_load_dwordx4 v[80:83], v1, s[8:11], s57 offen offset:0
buffer_load_dwordx4 v[84:87], v1, s[8:11], s57 offen offset:1024
buffer_load_dwordx4 v[88:91], v1, s[8:11], s57 offen offset:2048
buffer_load_dwordx4 v[92:95], v1, s[8:11], s57 offen offset:3072
v_add_f32_dpp v20, v16, v16 row_ror:8 row_mask:0xf bank_mask:0x3
v_add_f32_dpp v21, v17, v17 row_ror:8 row_mask:0xf bank_mask:0x3
s_nop 0
v_add_f32_dpp v20, v18, v18 row_ror:8 row_mask:0xf bank_mask:0xc
v_add_f32_dpp v21, v19, v19 row_ror:8 row_mask:0xf bank_mask:0xc
s_nop 0
v_add_f32_dpp v26, v20, v20 row_half_mirror row_mask:0xf bank_mask:0x5
s_nop 1
v_add_f32_dpp v26, v21, v21 row_half_mirror row_mask:0xf bank_mask:0xa
s_waitcnt vmcnt(12)
v_dot2_f32_bf16 v16, v96, v12, 0
v_dot2_f32_bf16 v17, v100, v12, 0
v_dot2_f32_bf16 v18, v104, v12, 0
v_dot2_f32_bf16 v19, v108, v12, 0
v_dot2_f32_bf16 v16, v97, v13, v16
v_dot2_f32_bf16 v17, v101, v13, v17
v_dot2_f32_bf16 v18, v105, v13, v18
v_dot2_f32_bf16 v19, v109, v13, v19
v_dot2_f32_bf16 v16, v98, v14, v16
v_dot2_f32_bf16 v17, v102, v14, v17
v_dot2_f32_bf16 v18, v106, v14, v18
v_dot2_f32_bf16 v19, v110, v14, v19
v_dot2_f32_bf16 v16, v99, v15, v16
v_dot2_f32_bf16 v17, v103, v15, v17
v_dot2_f32_bf16 v18, v107, v15, v18
v_dot2_f32_bf16 v19, v111, v15, v19
s_add_u32 s57, s77, 1409024
buffer_load_dwordx4 v[96:99], v1, s[8:11], s57 offen offset:0 nt
buffer_load_dwordx4 v[100:103], v1, s[8:11], s57 offen offset:1024 nt
buffer_load_dwordx4 v[104:107], v1, s[8:11], s57 offen offset:2048 nt
buffer_load_dwordx4 v[108:111], v1, s[8:11], s57 offen offset:3072 nt
v_add_f32_dpp v20, v16, v16 row_ror:8 row_mask:0xf bank_mask:0x3
v_add_f32_dpp v21, v17, v17 row_ror:8 row_mask:0xf bank_mask:0x3
s_nop 0
v_add_f32_dpp v20, v18, v18 row_ror:8 row_mask:0xf bank_mask:0xc
v_add_f32_dpp v21, v19, v19 row_ror:8 row_mask:0xf bank_mask:0xc
s_nop 0
v_add_f32_dpp v27, v20, v20 row_half_mirror row_mask:0xf bank_mask:0x5
s_nop 1
v_add_f32_dpp v27, v21, v21 row_half_mirror row_mask:0xf bank_mask:0xa
v_add_f32_dpp v24, v24, v24 quad_perm:[2,3,0,1] row_mask:0xf bank_mask:0xf
v_add_f32_dpp v25, v25, v25 quad_perm:[2,3,0,1] row_mask:0xf bank_mask:0xf
v_add_f32_dpp v26, v26, v26 quad_perm:[2,3,0,1] row_mask:0xf bank_mask:0xf
v_add_f32_dpp v27, v27, v27 quad_perm:[2,3,0,1] row_mask:0xf bank_mask:0xf
v_cndmask_b32 v24, v24, v26, s[66:67]
v_cndmask_b32 v25, v25, v27, s[66:67]
s_nop 0
v_add_f32_dpp v24, v24, v24 quad_perm:[1,0,3,2] row_mask:0xf bank_mask:0xf
v_add_f32_dpp v25, v25, v25 quad_perm:[1,0,3,2] row_mask:0xf bank_mask:0xf
v_cndmask_b32 v23, v24, v25, s[68:69]
v_mov_b32 v28, v29
v_mov_b32 v29, v30
v_mov_b32 v30, v31
v_cvt_pk_bf16_f32 v31, v45, v23
s_barrier
s_cmp_lg_u32 s3, 3
s_cbranch_scc1 SK_15
v_mov_b32 v24, 1
v_mov_b32 v25, 1
v_mov_b32 v26, 1
v_mov_b32 v27, 1
s_lshl_b32 s57, s2, 7
s_add_u32 s57, s57, 2097152
s_mov_b64 exec, 0xff
buffer_store_dwordx4 v[24:27], v1, s[16:19], s57 offen sc1
s_mov_b64 exec, -1
SK_15:
s_add_u32 s56, s77, 1441792
s_mov_b32 s55, 2
LOOP_16:
s_waitcnt vmcnt(12)
v_dot2_f32_bf16 v16, v48, v12, 0
v_dot2_f32_bf16 v17, v52, v12, 0
v_dot2_f32_bf16 v18, v56, v12, 0
v_dot2_f32_bf16 v19, v60, v12, 0
v_dot2_f32_bf16 v16, v49, v13, v16
v_dot2_f32_bf16 v17, v53, v13, v17
v_dot2_f32_bf16 v18, v57, v13, v18
v_dot2_f32_bf16 v19, v61, v13, v19
v_dot2_f32_bf16 v16, v50, v14, v16
v_dot2_f32_bf16 v17, v54, v14, v17
v_dot2_f32_bf16 v18, v58, v14, v18
v_dot2_f32_bf16 v19, v62, v14, v19
v_dot2_f32_bf16 v16, v51, v15, v16
v_dot2_f32_bf16 v17, v55, v15, v17
v_dot2_f32_bf16 v18, v59, v15, v18
v_dot2_f32_bf16 v19, v63, v15, v19
buffer_load_dwordx4 v[48:51], v1, s[8:11], s56 offen offset:0
buffer_load_dwordx4 v[52:55], v1, s[8:11], s56 offen offset:1024
buffer_load_dwordx4 v[56:59], v1, s[8:11], s56 offen offset:2048
buffer_load_dwordx4 v[60:63], v1, s[8:11], s56 offen offset:3072
s_add_u32 s56, s56, 32768
v_add_f32_dpp v20, v16, v16 row_ror:8 row_mask:0xf bank_mask:0x3
v_add_f32_dpp v21, v17, v17 row_ror:8 row_mask:0xf bank_mask:0x3
s_nop 0
v_add_f32_dpp v20, v18, v18 row_ror:8 row_mask:0xf bank_mask:0xc
v_add_f32_dpp v21, v19, v19 row_ror:8 row_mask:0xf bank_mask:0xc
s_nop 0
v_add_f32_dpp v24, v20, v20 row_half_mirror row_mask:0xf bank_mask:0x5
s_nop 1
v_add_f32_dpp v24, v21, v21 row_half_mirror row_mask:0xf bank_mask:0xa
s_waitcnt vmcnt(12)
v_dot2_f32_bf16 v16, v64, v12, 0
v_dot2_f32_bf16 v17, v68, v12, 0
v_dot2_f32_bf16 v18, v72, v12, 0
v_dot2_f32_bf16 v19, v76, v12, 0
v_dot2_f32_bf16 v16, v65, v13, v16
v_dot2_f32_bf16 v17, v69, v13, v17
v_dot2_f32_bf16 v18, v73, v13, v18
v_dot2_f32_bf16 v19, v77, v13, v19
v_dot2_f32_bf16 v16, v66, v14, v16
v_dot2_f32_bf16 v17, v70, v14, v17
v_dot2_f32_bf16 v18, v74, v14, v18
v_dot2_f32_bf16 v19, v78, v14, v19
v_dot2_f32_bf16 v16, v67, v15, v16
v_dot2_f32_bf16 v17, v71, v15, v17
v_dot2_f32_bf16 v18, v75, v15, v18
v_dot2_f32_bf16 v19, v79, v15, v19
buffer_load_dwordx4 v[64:67], v1, s[8:11], s56 offen offset:0 nt
buffer_load_dwordx4 v[68:71], v1, s[8:11], s56 offen offset:1024 nt
buffer_load_dwordx4 v[72:75], v1, s[8:11], s56 offen offset:2048 nt
buffer_load_dwordx4 v[76:79], v1, s[8:11], s56 offen offset:3072 nt
s_add_u32 s56, s56, 32768
v_add_f32_dpp v20, v16, v16 row_ror:8 row_mask:0xf bank_mask:0x3
v_add_f32_dpp v21, v17, v17 row_ror:8 row_mask:0xf bank_mask:0x3
s_nop 0
v_add_f32_dpp v20, v18, v18 row_ror:8 row_mask:0xf bank_mask:0xc
v_add_f32_dpp v21, v19, v19 row_ror:8 row_mask:0xf bank_mask:0xc
s_nop 0
v_add_f32_dpp v25, v20, v20 row_half_mirror row_mask:0xf bank_mask:0x5
s_nop 1
v_add_f32_dpp v25, v21, v21 row_half_mirror row_mask:0xf bank_mask:0xa
s_waitcnt vmcnt(12)
v_dot2_f32_bf16 v16, v80, v12, 0
v_dot2_f32_bf16 v17, v84, v12, 0
v_dot2_f32_bf16 v18, v88, v12, 0
v_dot2_f32_bf16 v19, v92, v12, 0
v_dot2_f32_bf16 v16, v81, v13, v16
v_dot2_f32_bf16 v17, v85, v13, v17
v_dot2_f32_bf16 v18, v89, v13, v18
v_dot2_f32_bf16 v19, v93, v13, v19
v_dot2_f32_bf16 v16, v82, v14, v16
v_dot2_f32_bf16 v17, v86, v14, v17
v_dot2_f32_bf16 v18, v90, v14, v18
v_dot2_f32_bf16 v19, v94, v14, v19
v_dot2_f32_bf16 v16, v83, v15, v16
v_dot2_f32_bf16 v17, v87, v15, v17
v_dot2_f32_bf16 v18, v91, v15, v18
v_dot2_f32_bf16 v19, v95, v15, v19
buffer_load_dwordx4 v[80:83], v1, s[8:11], s56 offen offset:0
buffer_load_dwordx4 v[84:87], v1, s[8:11], s56 offen offset:1024
buffer_load_dwordx4 v[88:91], v1, s[8:11], s56 offen offset:2048
buffer_load_dwordx4 v[92:95], v1, s[8:11], s56 offen offset:3072
s_add_u32 s56, s56, 32768
v_add_f32_dpp v20, v16, v16 row_ror:8 row_mask:0xf bank_mask:0x3
v_add_f32_dpp v21, v17, v17 row_ror:8 row_mask:0xf bank_mask:0x3
s_nop 0
v_add_f32_dpp v20, v18, v18 row_ror:8 row_mask:0xf bank_mask:0xc
v_add_f32_dpp v21, v19, v19 row_ror:8 row_mask:0xf bank_mask:0xc
s_nop 0
v_add_f32_dpp v26, v20, v20 row_half_mirror row_mask:0xf bank_mask:0x5
s_nop 1
v_add_f32_dpp v26, v21, v21 row_half_mirror row_mask:0xf bank_mask:0xa
s_waitcnt vmcnt(12)
v_dot2_f32_bf16 v16, v96, v12, 0
v_dot2_f32_bf16 v17, v100, v12, 0
v_dot2_f32_bf16 v18, v104, v12, 0
v_dot2_f32_bf16 v19, v108, v12, 0
v_dot2_f32_bf16 v16, v97, v13, v16
v_dot2_f32_bf16 v17, v101, v13, v17
v_dot2_f32_bf16 v18, v105, v13, v18
v_dot2_f32_bf16 v19, v109, v13, v19
v_dot2_f32_bf16 v16, v98, v14, v16
v_dot2_f32_bf16 v17, v102, v14, v17
v_dot2_f32_bf16 v18, v106, v14, v18
v_dot2_f32_bf16 v19, v110, v14, v19
v_dot2_f32_bf16 v16, v99, v15, v16
v_dot2_f32_bf16 v17, v103, v15, v17
v_dot2_f32_bf16 v18, v107, v15, v18
v_dot2_f32_bf16 v19, v111, v15, v19
buffer_load_dwordx4 v[96:99], v1, s[8:11], s56 offen offset:0 nt
buffer_load_dwordx4 v[100:103], v1, s[8:11], s56 offen offset:1024 nt
buffer_load_dwordx4 v[104:107], v1, s[8:11], s56 offen offset:2048 nt
buffer_load_dwordx4 v[108:111], v1, s[8:11], s56 offen offset:3072 nt
s_add_u32 s56, s56, 32768
v_add_f32_dpp v20, v16, v16 row_ror:8 row_mask:0xf bank_mask:0x3
v_add_f32_dpp v21, v17, v17 row_ror:8 row_mask:0xf bank_mask:0x3
s_nop 0
v_add_f32_dpp v20, v18, v18 row_ror:8 row_mask:0xf bank_mask:0xc
v_add_f32_dpp v21, v19, v19 row_ror:8 row_mask:0xf bank_mask:0xc
s_nop 0
v_add_f32_dpp v27, v20, v20 row_half_mirror row_mask:0xf bank_mask:0x5
s_nop 1
v_add_f32_dpp v27, v21, v21 row_half_mirror row_mask:0xf bank_mask:0xa
v_add_f32_dpp v24, v24, v24 quad_perm:[2,3,0,1] row_mask:0xf bank_mask:0xf
v_add_f32_dpp v25, v25, v25 quad_perm:[2,3,0,1] row_mask:0xf bank_mask:0xf
v_add_f32_dpp v26, v26, v26 quad_perm:[2,3,0,1] row_mask:0xf bank_mask:0xf
v_add_f32_dpp v27, v27, v27 quad_perm:[2,3,0,1] row_mask:0xf bank_mask:0xf
v_cndmask_b32 v24, v24, v26, s[66:67]
v_cndmask_b32 v25, v25, v27, s[66:67]
s_nop 0
v_add_f32_dpp v24, v24, v24 quad_perm:[1,0,3,2] row_mask:0xf bank_mask:0xf
v_add_f32_dpp v25, v25, v25 quad_perm:[1,0,3,2] row_mask:0xf bank_mask:0xf
v_cndmask_b32 v45, v24, v25, s[68:69]
s_waitcnt vmcnt(12)
v_dot2_f32_bf16 v16, v48, v12, 0
v_dot2_f32_bf16 v17, v52, v12, 0
v_dot2_f32_bf16 v18, v56, v12, 0
v_dot2_f32_bf16 v19, v60, v12, 0
v_dot2_f32_bf16 v16, v49, v13, v16
v_dot2_f32_bf16 v17, v53, v13, v17
v_dot2_f32_bf16 v18, v57, v13, v18
v_dot2_f32_bf16 v19, v61, v13, v19
v_dot2_f32_bf16 v16, v50, v14, v16
v_dot2_f32_bf16 v17, v54, v14, v17
v_dot2_f32_bf16 v18, v58, v14, v18
v_dot2_f32_bf16 v19, v62, v14, v19
v_dot2_f32_bf16 v16, v51, v15, v16
v_dot2_f32_bf16 v17, v55, v15, v17
v_dot2_f32_bf16 v18, v59, v15, v18
v_dot2_f32_bf16 v19, v63, v15, v19
buffer_load_dwordx4 v[48:51], v1, s[8:11], s56 offen offset:0
buffer_load_dwordx4 v[52:55], v1, s[8:11], s56 offen offset:1024
buffer_load_dwordx4 v[56:59], v1, s[8:11], s56 offen offset:2048
buffer_load_dwordx4 v[60:63], v1, s[8:11], s56 offen offset:3072
s_add_u32 s56, s56, 32768
v_add_f32_dpp v20, v16, v16 row_ror:8 row_mask:0xf bank_mask:0x3
v_add_f32_dpp v21, v17, v17 row_ror:8 row_mask:0xf bank_mask:0x3
s_nop 0
v_add_f32_dpp v20, v18, v18 row_ror:8 row_mask:0xf bank_mask:0xc
v_add_f32_dpp v21, v19, v19 row_ror:8 row_mask:0xf bank_mask:0xc
s_nop 0
v_add_f32_dpp v24, v20, v20 row_half_mirror row_mask:0xf bank_mask:0x5
s_nop 1
v_add_f32_dpp v24, v21, v21 row_half_mirror row_mask:0xf bank_mask:0xa
s_waitcnt vmcnt(12)
v_dot2_f32_bf16 v16, v64, v12, 0
v_dot2_f32_bf16 v17, v68, v12, 0
v_dot2_f32_bf16 v18, v72, v12, 0
v_dot2_f32_bf16 v19, v76, v12, 0
v_dot2_f32_bf16 v16, v65, v13, v16
v_dot2_f32_bf16 v17, v69, v13, v17
v_dot2_f32_bf16 v18, v73, v13, v18
v_dot2_f32_bf16 v19, v77, v13, v19
v_dot2_f32_bf16 v16, v66, v14, v16
v_dot2_f32_bf16 v17, v70, v14, v17
v_dot2_f32_bf16 v18, v74, v14, v18
v_dot2_f32_bf16 v19, v78, v14, v19
v_dot2_f32_bf16 v16, v67, v15, v16
v_dot2_f32_bf16 v17, v71, v15, v17
v_dot2_f32_bf16 v18, v75, v15, v18
v_dot2_f32_bf16 v19, v79, v15, v19
buffer_load_dwordx4 v[64:67], v1, s[8:11], s56 offen offset:0 nt
buffer_load_dwordx4 v[68:71], v1, s[8:11], s56 offen offset:1024 nt
buffer_load_dwordx4 v[72:75], v1, s[8:11], s56 offen offset:2048 nt
buffer_load_dwordx4 v[76:79], v1, s[8:11], s56 offen offset:3072 nt
s_add_u32 s56, s56, 32768
v_add_f32_dpp v20, v16, v16 row_ror:8 row_mask:0xf bank_mask:0x3
v_add_f32_dpp v21, v17, v17 row_ror:8 row_mask:0xf bank_mask:0x3
s_nop 0
v_add_f32_dpp v20, v18, v18 row_ror:8 row_mask:0xf bank_mask:0xc
v_add_f32_dpp v21, v19, v19 row_ror:8 row_mask:0xf bank_mask:0xc
s_nop 0
v_add_f32_dpp v25, v20, v20 row_half_mirror row_mask:0xf bank_mask:0x5
s_nop 1
v_add_f32_dpp v25, v21, v21 row_half_mirror row_mask:0xf bank_mask:0xa
s_waitcnt vmcnt(12)
v_dot2_f32_bf16 v16, v80, v12, 0
v_dot2_f32_bf16 v17, v84, v12, 0
v_dot2_f32_bf16 v18, v88, v12, 0
v_dot2_f32_bf16 v19, v92, v12, 0
v_dot2_f32_bf16 v16, v81, v13, v16
v_dot2_f32_bf16 v17, v85, v13, v17
v_dot2_f32_bf16 v18, v89, v13, v18
v_dot2_f32_bf16 v19, v93, v13, v19
v_dot2_f32_bf16 v16, v82, v14, v16
v_dot2_f32_bf16 v17, v86, v14, v17
v_dot2_f32_bf16 v18, v90, v14, v18
v_dot2_f32_bf16 v19, v94, v14, v19
v_dot2_f32_bf16 v16, v83, v15, v16
v_dot2_f32_bf16 v17, v87, v15, v17
v_dot2_f32_bf16 v18, v91, v15, v18
v_dot2_f32_bf16 v19, v95, v15, v19
buffer_load_dwordx4 v[80:83], v1, s[8:11], s56 offen offset:0
buffer_load_dwordx4 v[84:87], v1, s[8:11], s56 offen offset:1024
buffer_load_dwordx4 v[88:91], v1, s[8:11], s56 offen offset:2048
buffer_load_dwordx4 v[92:95], v1, s[8:11], s56 offen offset:3072
s_add_u32 s56, s56, 32768
v_add_f32_dpp v20, v16, v16 row_ror:8 row_mask:0xf bank_mask:0x3
v_add_f32_dpp v21, v17, v17 row_ror:8 row_mask:0xf bank_mask:0x3
s_nop 0
v_add_f32_dpp v20, v18, v18 row_ror:8 row_mask:0xf bank_mask:0xc
v_add_f32_dpp v21, v19, v19 row_ror:8 row_mask:0xf bank_mask:0xc
s_nop 0
v_add_f32_dpp v26, v20, v20 row_half_mirror row_mask:0xf bank_mask:0x5
s_nop 1
v_add_f32_dpp v26, v21, v21 row_half_mirror row_mask:0xf bank_mask:0xa
s_waitcnt vmcnt(12)
v_dot2_f32_bf16 v16, v96, v12, 0
v_dot2_f32_bf16 v17, v100, v12, 0
v_dot2_f32_bf16 v18, v104, v12, 0
v_dot2_f32_bf16 v19, v108, v12, 0
v_dot2_f32_bf16 v16, v97, v13, v16
v_dot2_f32_bf16 v17, v101, v13, v17
v_dot2_f32_bf16 v18, v105, v13, v18
v_dot2_f32_bf16 v19, v109, v13, v19
v_dot2_f32_bf16 v16, v98, v14, v16
v_dot2_f32_bf16 v17, v102, v14, v17
v_dot2_f32_bf16 v18, v106, v14, v18
v_dot2_f32_bf16 v19, v110, v14, v19
v_dot2_f32_bf16 v16, v99, v15, v16
v_dot2_f32_bf16 v17, v103, v15, v17
v_dot2_f32_bf16 v18, v107, v15, v18
v_dot2_f32_bf16 v19, v111, v15, v19
buffer_load_dwordx4 v[96:99], v1, s[8:11], s56 offen offset:0 nt
buffer_load_dwordx4 v[100:103], v1, s[8:11], s56 offen offset:1024 nt
buffer_load_dwordx4 v[104:107], v1, s[8:11], s56 offen offset:2048 nt
buffer_load_dwordx4 v[108:111], v1, s[8:11], s56 offen offset:3072 nt
s_add_u32 s56, s56, 32768
v_add_f32_dpp v20, v16, v16 row_ror:8 row_mask:0xf bank_mask:0x3
v_add_f32_dpp v21, v17, v17 row_ror:8 row_mask:0xf bank_mask:0x3
s_nop 0
v_add_f32_dpp v20, v18, v18 row_ror:8 row_mask:0xf bank_mask:0xc
v_add_f32_dpp v21, v19, v19 row_ror:8 row_mask:0xf bank_mask:0xc
s_nop 0
v_add_f32_dpp v27, v20, v20 row_half_mirror row_mask:0xf bank_mask:0x5
s_nop 1
v_add_f32_dpp v27, v21, v21 row_half_mirror row_mask:0xf bank_mask:0xa
v_add_f32_dpp v24, v24, v24 quad_perm:[2,3,0,1] row_mask:0xf bank_mask:0xf
v_add_f32_dpp v25, v25, v25 quad_perm:[2,3,0,1] row_mask:0xf bank_mask:0xf
v_add_f32_dpp v26, v26, v26 quad_perm:[2,3,0,1] row_mask:0xf bank_mask:0xf
v_add_f32_dpp v27, v27, v27 quad_perm:[2,3,0,1] row_mask:0xf bank_mask:0xf
v_cndmask_b32 v24, v24, v26, s[66:67]
v_cndmask_b32 v25, v25, v27, s[66:67]
s_nop 0
v_add_f32_dpp v24, v24, v24 quad_perm:[1,0,3,2] row_mask:0xf bank_mask:0xf
v_add_f32_dpp v25, v25, v25 quad_perm:[1,0,3,2] row_mask:0xf bank_mask:0xf
v_cndmask_b32 v23, v24, v25, s[68:69]
v_mov_b32 v28, v29
v_mov_b32 v29, v30
v_mov_b32 v30, v31
v_cvt_pk_bf16_f32 v31, v45, v23
s_sub_u32 s55, s55, 1
s_cmp_lg_u32 s55, 0
s_cbranch_scc1 LOOP_16
s_xor_b32 s57, s2, 4
s_lshl_b32 s57, s57, 7
s_add_u32 s57, s57, 2097152
s_add_u32 s0, s46, s57
s_addc_u32 s1, s47, 0
s_load_dword s20, s[0:1], 0 glc
s_waitcnt vmcnt(12)
v_dot2_f32_bf16 v16, v48, v12, 0
v_dot2_f32_bf16 v17, v52, v12, 0
v_dot2_f32_bf16 v18, v56, v12, 0
v_dot2_f32_bf16 v19, v60, v12, 0
v_dot2_f32_bf16 v16, v49, v13, v16
v_dot2_f32_bf16 v17, v53, v13, v17
v_dot2_f32_bf16 v18, v57, v13, v18
v_dot2_f32_bf16 v19, v61, v13, v19
v_dot2_f32_bf16 v16, v50, v14, v16
v_dot2_f32_bf16 v17, v54, v14, v17
v_dot2_f32_bf16 v18, v58, v14, v18
v_dot2_f32_bf16 v19, v62, v14, v19
v_dot2_f32_bf16 v16, v51, v15, v16
v_dot2_f32_bf16 v17, v55, v15, v17
v_dot2_f32_bf16 v18, v59, v15, v18
v_dot2_f32_bf16 v19, v63, v15, v19
s_add_u32 s57, s77, 1966080
buffer_load_dwordx4 v[48:51], v1, s[8:11], s57 offen offset:0 nt
buffer_load_dwordx4 v[52:55], v1, s[8:11], s57 offen offset:1024 nt
buffer_load_dwordx4 v[56:59], v1, s[8:11], s57 offen offset:2048 nt
buffer_load_dwordx4 v[60:63], v1, s[8:11], s57 offen offset:3072 nt
s_add_u32 s57, s63, 262144
buffer_load_dwordx4 a[192:195], v1, s[12:15], s57 offen offset:0 nt
buffer_load_dwordx4 a[196:199], v1, s[12:15], s57 offen offset:1024 nt
buffer_load_dwordx4 a[200:203], v1, s[12:15], s57 offen offset:2048 nt
buffer_load_dwordx4 a[204:207], v1, s[12:15], s57 offen offset:3072 nt
v_add_f32_dpp v20, v16, v16 row_ror:8 row_mask:0xf bank_mask:0x3
v_add_f32_dpp v21, v17, v17 row_ror:8 row_mask:0xf bank_mask:0x3
s_nop 0
v_add_f32_dpp v20, v18, v18 row_ror:8 row_mask:0xf bank_mask:0xc
v_add_f32_dpp v21, v19, v19 row_ror:8 row_mask:0xf bank_mask:0xc
s_nop 0
v_add_f32_dpp v24, v20, v20 row_half_mirror row_mask:0xf bank_mask:0x5
s_nop 1
v_add_f32_dpp v24, v21, v21 row_half_mirror row_mask:0xf bank_mask:0xa
s_waitcnt vmcnt(16)
v_dot2_f32_bf16 v16, v64, v12, 0
v_dot2_f32_bf16 v17, v68, v12, 0
v_dot2_f32_bf16 v18, v72, v12, 0
v_dot2_f32_bf16 v19, v76, v12, 0
v_dot2_f32_bf16 v16, v65, v13, v16
v_dot2_f32_bf16 v17, v69, v13, v17
v_dot2_f32_bf16 v18, v73, v13, v18
v_dot2_f32_bf16 v19, v77, v13, v19
v_dot2_f32_bf16 v16, v66, v14, v16
v_dot2_f32_bf16 v17, v70, v14, v17
v_dot2_f32_bf16 v18, v74, v14, v18
v_dot2_f32_bf16 v19, v78, v14, v19
v_dot2_f32_bf16 v16, v67, v15, v16
v_dot2_f32_bf16 v17, v71, v15, v17
v_dot2_f32_bf16 v18, v75, v15, v18
v_dot2_f32_bf16 v19, v79, v15, v19
s_add_u32 s57, s77, 1998848
buffer_load_dwordx4 v[64:67], v1, s[8:11], s57 offen offset:0 nt
buffer_load_dwordx4 v[68:71], v1, s[8:11], s57 offen offset:1024 nt
buffer_load_dwordx4 v[72:75], v1, s[8:11], s57 offen offset:2048 nt
buffer_load_dwordx4 v[76:79], v1, s[8:11], s57 offen offset:3072 nt
s_add_u32 s57, s63, 294912
buffer_load_dwordx4 v[240:243], v1, s[12:15], s57 offen offset:0 nt
buffer_load_dwordx4 v[244:247], v1, s[12:15], s57 offen offset:1024 nt
buffer_load_dwordx4 v[248:251], v1, s[12:15], s57 offen offset:2048 nt
buffer_load_dwordx4 v[252:255], v1, s[12:15], s57 offen offset:3072 nt
v_add_f32_dpp v20, v16, v16 row_ror:8 row_mask:0xf bank_mask:0x3
v_add_f32_dpp v21, v17, v17 row_ror:8 row_mask:0xf bank_mask:0x3
s_nop 0
v_add_f32_dpp v20, v18, v18 row_ror:8 row_mask:0xf bank_mask:0xc
v_add_f32_dpp v21, v19, v19 row_ror:8 row_mask:0xf bank_mask:0xc
s_nop 0
v_add_f32_dpp v25, v20, v20 row_half_mirror row_mask:0xf bank_mask:0x5
s_nop 1
v_add_f32_dpp v25, v21, v21 row_half_mirror row_mask:0xf bank_mask:0xa
s_waitcnt vmcnt(20)
v_dot2_f32_bf16 v16, v80, v12, 0
v_dot2_f32_bf16 v17, v84, v12, 0
v_dot2_f32_bf16 v18, v88, v12, 0
v_dot2_f32_bf16 v19, v92, v12, 0
v_dot2_f32_bf16 v16, v81, v13, v16
v_dot2_f32_bf16 v17, v85, v13, v17
v_dot2_f32_bf16 v18, v89, v13, v18
v_dot2_f32_bf16 v19, v93, v13, v19
v_dot2_f32_bf16 v16, v82, v14, v16
v_dot2_f32_bf16 v17, v86, v14, v17
v_dot2_f32_bf16 v18, v90, v14, v18
v_dot2_f32_bf16 v19, v94, v14, v19
v_dot2_f32_bf16 v16, v83, v15, v16
v_dot2_f32_bf16 v17, v87, v15, v17
v_dot2_f32_bf16 v18, v91, v15, v18
v_dot2_f32_bf16 v19, v95, v15, v19
s_add_u32 s57, s77, 2031616
buffer_load_dwordx4 v[80:83], v1, s[8:11], s57 offen offset:0 nt
buffer_load_dwordx4 v[84:87], v1, s[8:11], s57 offen offset:1024 nt
buffer_load_dwordx4 v[88:91], v1, s[8:11], s57 offen offset:2048 nt
buffer_load_dwordx4 v[92:95], v1, s[8:11], s57 offen offset:3072 nt
s_add_u32 s57, s63, 327680
buffer_load_dwordx4 v[112:115], v1, s[12:15], s57 offen offset:0 nt
buffer_load_dwordx4 v[116:119], v1, s[12:15], s57 offen offset:1024 nt
buffer_load_dwordx4 v[120:123], v1, s[12:15], s57 offen offset:2048 nt
buffer_load_dwordx4 v[124:127], v1, s[12:15], s57 offen offset:3072 nt
v_add_f32_dpp v20, v16, v16 row_ror:8 row_mask:0xf bank_mask:0x3
v_add_f32_dpp v21, v17, v17 row_ror:8 row_mask:0xf bank_mask:0x3
s_nop 0
v_add_f32_dpp v20, v18, v18 row_ror:8 row_mask:0xf bank_mask:0xc
v_add_f32_dpp v21, v19, v19 row_ror:8 row_mask:0xf bank_mask:0xc
s_nop 0
v_add_f32_dpp v26, v20, v20 row_half_mirror row_mask:0xf bank_mask:0x5
s_nop 1
v_add_f32_dpp v26, v21, v21 row_half_mirror row_mask:0xf bank_mask:0xa
s_waitcnt vmcnt(24)
v_dot2_f32_bf16 v16, v96, v12, 0
v_dot2_f32_bf16 v17, v100, v12, 0
v_dot2_f32_bf16 v18, v104, v12, 0
v_dot2_f32_bf16 v19, v108, v12, 0
v_dot2_f32_bf16 v16, v97, v13, v16
v_dot2_f32_bf16 v17, v101, v13, v17
v_dot2_f32_bf16 v18, v105, v13, v18
v_dot2_f32_bf16 v19, v109, v13, v19
v_dot2_f32_bf16 v16, v98, v14, v16
v_dot2_f32_bf16 v17, v102, v14, v17
v_dot2_f32_bf16 v18, v106, v14, v18
v_dot2_f32_bf16 v19, v110, v14, v19
v_dot2_f32_bf16 v16, v99, v15, v16
v_dot2_f32_bf16 v17, v103, v15, v17
v_dot2_f32_bf16 v18, v107, v15, v18
v_dot2_f32_bf16 v19, v111, v15, v19
s_add_u32 s57, s77, 2064384
buffer_load_dwordx4 v[96:99], v1, s[8:11], s57 offen offset:0 nt
buffer_load_dwordx4 v[100:103], v1, s[8:11], s57 offen offset:1024 nt
buffer_load_dwordx4 v[104:107], v1, s[8:11], s57 offen offset:2048 nt
buffer_load_dwordx4 v[108:111], v1, s[8:11], s57 offen offset:3072 nt
s_add_u32 s57, s63, 360448
buffer_load_dwordx4 v[128:131], v1, s[12:15], s57 offen offset:0 nt
buffer_load_dwordx4 v[132:135], v1, s[12:15], s57 offen offset:1024 nt
buffer_load_dwordx4 v[136:139], v1, s[12:15], s57 offen offset:2048 nt
buffer_load_dwordx4 v[140:143], v1, s[12:15], s57 offen offset:3072 nt
v_add_f32_dpp v20, v16, v16 row_ror:8 row_mask:0xf bank_mask:0x3
v_add_f32_dpp v21, v17, v17 row_ror:8 row_mask:0xf bank_mask:0x3
s_nop 0
v_add_f32_dpp v20, v18, v18 row_ror:8 row_mask:0xf bank_mask:0xc
v_add_f32_dpp v21, v19, v19 row_ror:8 row_mask:0xf bank_mask:0xc
s_nop 0
v_add_f32_dpp v27, v20, v20 row_half_mirror row_mask:0xf bank_mask:0x5
s_nop 1
v_add_f32_dpp v27, v21, v21 row_half_mirror row_mask:0xf bank_mask:0xa
v_add_f32_dpp v24, v24, v24 quad_perm:[2,3,0,1] row_mask:0xf bank_mask:0xf
v_add_f32_dpp v25, v25, v25 quad_perm:[2,3,0,1] row_mask:0xf bank_mask:0xf
v_add_f32_dpp v26, v26, v26 quad_perm:[2,3,0,1] row_mask:0xf bank_mask:0xf
v_add_f32_dpp v27, v27, v27 quad_perm:[2,3,0,1] row_mask:0xf bank_mask:0xf
v_cndmask_b32 v24, v24, v26, s[66:67]
v_cndmask_b32 v25, v25, v27, s[66:67]
s_nop 0
v_add_f32_dpp v24, v24, v24 quad_perm:[1,0,3,2] row_mask:0xf bank_mask:0xf
v_add_f32_dpp v25, v25, v25 quad_perm:[1,0,3,2] row_mask:0xf bank_mask:0xf
v_cndmask_b32 v45, v24, v25, s[68:69]
s_waitcnt lgkmcnt(0)
s_cmp_lt_i32 s20, 1
s_cbranch_scc1 LV_17_SLOW
LV_17_OK:
s_waitcnt vmcnt(28)
v_dot2_f32_bf16 v16, v48, v12, 0
v_dot2_f32_bf16 v17, v52, v12, 0
v_dot2_f32_bf16 v18, v56, v12, 0
v_dot2_f32_bf16 v19, v60, v12, 0
v_dot2_f32_bf16 v16, v49, v13, v16
v_dot2_f32_bf16 v17, v53, v13, v17
v_dot2_f32_bf16 v18, v57, v13, v18
v_dot2_f32_bf16 v19, v61, v13, v19
v_dot2_f32_bf16 v16, v50, v14, v16
v_dot2_f32_bf16 v17, v54, v14, v17
v_dot2_f32_bf16 v18, v58, v14, v18
v_dot2_f32_bf16 v19, v62, v14, v19
v_dot2_f32_bf16 v16, v51, v15, v16
v_dot2_f32_bf16 v17, v55, v15, v17
v_dot2_f32_bf16 v18, v59, v15, v18
v_dot2_f32_bf16 v19, v63, v15, v19
s_add_u32 s57, s63, 655360
buffer_load_dwordx4 a[0:3], v1, s[12:15], s57 offen offset:0 nt
buffer_load_dwordx4 a[4:7], v1, s[12:15], s57 offen offset:1024 nt
buffer_load_dwordx4 a[8:11], v1, s[12:15], s57 offen offset:2048 nt
buffer_load_dwordx4 a[12:15], v1, s[12:15], s57 offen offset:3072 nt
v_add_f32_dpp v20, v16, v16 row_ror:8 row_mask:0xf bank_mask:0x3
v_add_f32_dpp v21, v17, v17 row_ror:8 row_mask:0xf bank_mask:0x3
s_nop 0
v_add_f32_dpp v20, v18, v18 row_ror:8 row_mask:0xf bank_mask:0xc
v_add_f32_dpp v21, v19, v19 row_ror:8 row_mask:0xf bank_mask:0xc
s_nop 0
v_add_f32_dpp v24, v20, v20 row_half_mirror row_mask:0xf bank_mask:0x5
s_nop 1
v_add_f32_dpp v24, v21, v21 row_half_mirror row_mask:0xf bank_mask:0xa
s_waitcnt vmcnt(24)
v_dot2_f32_bf16 v16, v64, v12, 0
v_dot2_f32_bf16 v17, v68, v12, 0
v_dot2_f32_bf16 v18, v72, v12, 0
v_dot2_f32_bf16 v19, v76, v12, 0
v_dot2_f32_bf16 v16, v65, v13, v16
v_dot2_f32_bf16 v17, v69, v13, v17
v_dot2_f32_bf16 v18, v73, v13, v18
v_dot2_f32_bf16 v19, v77, v13, v19
v_dot2_f32_bf16 v16, v66, v14, v16
v_dot2_f32_bf16 v17, v70, v14, v17
v_dot2_f32_bf16 v18, v74, v14, v18
v_dot2_f32_bf16 v19, v78, v14, v19
v_dot2_f32_bf16 v16, v67, v15, v16
v_dot2_f32_bf16 v17, v71, v15, v17
v_dot2_f32_bf16 v18, v75, v15, v18
v_dot2_f32_bf16 v19, v79, v15, v19
s_add_u32 s57, s63, 688128
buffer_load_dwordx4 a[16:19], v1, s[12:15], s57 offen offset:0 nt
buffer_load_dwordx4 a[20:23], v1, s[12:15], s57 offen offset:1024 nt
buffer_load_dwordx4 a[24:27], v1, s[12:15], s57 offen offset:2048 nt
buffer_load_dwordx4 a[28:31], v1, s[12:15], s57 offen offset:3072 nt
v_add_f32_dpp v20, v16, v16 row_ror:8 row_mask:0xf bank_mask:0x3
v_add_f32_dpp v21, v17, v17 row_ror:8 row_mask:0xf bank_mask:0x3
s_nop 0
v_add_f32_dpp v20, v18, v18 row_ror:8 row_mask:0xf bank_mask:0xc
v_add_f32_dpp v21, v19, v19 row_ror:8 row_mask:0xf bank_mask:0xc
s_nop 0
v_add_f32_dpp v25, v20, v20 row_half_mirror row_mask:0xf bank_mask:0x5
s_nop 1
v_add_f32_dpp v25, v21, v21 row_half_mirror row_mask:0xf bank_mask:0xa
s_waitcnt vmcnt(20)
v_dot2_f32_bf16 v16, v80, v12, 0
v_dot2_f32_bf16 v17, v84, v12, 0
v_dot2_f32_bf16 v18, v88, v12, 0
v_dot2_f32_bf16 v19, v92, v12, 0
v_dot2_f32_bf16 v16, v81, v13, v16
v_dot2_f32_bf16 v17, v85, v13, v17
v_dot2_f32_bf16 v18, v89, v13, v18
v_dot2_f32_bf16 v19, v93, v13, v19
v_dot2_f32_bf16 v16, v82, v14, v16
v_dot2_f32_bf16 v17, v86, v14, v17
v_dot2_f32_bf16 v18, v90, v14, v18
v_dot2_f32_bf16 v19, v94, v14, v19
v_dot2_f32_bf16 v16, v83, v15, v16
v_dot2_f32_bf16 v17, v87, v15, v17
v_dot2_f32_bf16 v18, v91, v15, v18
v_dot2_f32_bf16 v19, v95, v15, v19
s_add_u32 s57, s63, 720896
buffer_load_dwordx4 a[32:35], v1, s[12:15], s57 offen offset:0 nt
buffer_load_dwordx4 a[36:39], v1, s[12:15], s57 offen offset:1024 nt
buffer_load_dwordx4 a[40:43], v1, s[12:15], s57 offen offset:2048 nt
buffer_load_dwordx4 a[44:47], v1, s[12:15], s57 offen offset:3072 nt
v_add_f32_dpp v20, v16, v16 row_ror:8 row_mask:0xf bank_mask:0x3
v_add_f32_dpp v21, v17, v17 row_ror:8 row_mask:0xf bank_mask:0x3
s_nop 0
v_add_f32_dpp v20, v18, v18 row_ror:8 row_mask:0xf bank_mask:0xc
v_add_f32_dpp v21, v19, v19 row_ror:8 row_mask:0xf bank_mask:0xc
s_nop 0
v_add_f32_dpp v26, v20, v20 row_half_mirror row_mask:0xf bank_mask:0x5
s_nop 1
v_add_f32_dpp v26, v21, v21 row_half_mirror row_mask:0xf bank_mask:0xa
s_waitcnt vmcnt(16)
v_dot2_f32_bf16 v16, v96, v12, 0
v_dot2_f32_bf16 v17, v100, v12, 0
v_dot2_f32_bf16 v18, v104, v12, 0
v_dot2_f32_bf16 v19, v108, v12, 0
v_dot2_f32_bf16 v16, v97, v13, v16
v_dot2_f32_bf16 v17, v101, v13, v17
v_dot2_f32_bf16 v18, v105, v13, v18
v_dot2_f32_bf16 v19, v109, v13, v19
v_dot2_f32_bf16 v16, v98, v14, v16
v_dot2_f32_bf16 v17, v102, v14, v17
v_dot2_f32_bf16 v18, v106, v14, v18
v_dot2_f32_bf16 v19, v110, v14, v19
v_dot2_f32_bf16 v16, v99, v15, v16
v_dot2_f32_bf16 v17, v103, v15, v17
v_dot2_f32_bf16 v18, v107, v15, v18
v_dot2_f32_bf16 v19, v111, v15, v19
s_add_u32 s57, s63, 753664
buffer_load_dwordx4 a[48:51], v1, s[12:15], s57 offen offset:0 nt
buffer_load_dwordx4 a[52:55], v1, s[12:15], s57 offen offset:1024 nt
buffer_load_dwordx4 a[56:59], v1, s[12:15], s57 offen offset:2048 nt
buffer_load_dwordx4 a[60:63], v1, s[12:15], s57 offen offset:3072 nt
v_add_f32_dpp v20, v16, v16 row_ror:8 row_mask:0xf bank_mask:0x3
v_add_f32_dpp v21, v17, v17 row_ror:8 row_mask:0xf bank_mask:0x3
s_nop 0
v_add_f32_dpp v20, v18, v18 row_ror:8 row_mask:0xf bank_mask:0xc
v_add_f32_dpp v21, v19, v19 row_ror:8 row_mask:0xf bank_mask:0xc
s_nop 0
v_add_f32_dpp v27, v20, v20 row_half_mirror row_mask:0xf bank_mask:0x5
s_nop 1
v_add_f32_dpp v27, v21, v21 row_half_mirror row_mask:0xf bank_mask:0xa
v_add_f32_dpp v24, v24, v24 quad_perm:[2,3,0,1] row_mask:0xf bank_mask:0xf
v_add_f32_dpp v25, v25, v25 quad_perm:[2,3,0,1] row_mask:0xf bank_mask:0xf
v_add_f32_dpp v26, v26, v26 quad_perm:[2,3,0,1] row_mask:0xf bank_mask:0xf
v_add_f32_dpp v27, v27, v27 quad_perm:[2,3,0,1] row_mask:0xf bank_mask:0xf
v_cndmask_b32 v24, v24, v26, s[66:67]
v_cndmask_b32 v25, v25, v27, s[66:67]
s_nop 0
v_add_f32_dpp v24, v24, v24 quad_perm:[1,0,3,2] row_mask:0xf bank_mask:0xf
v_add_f32_dpp v25, v25, v25 quad_perm:[1,0,3,2] row_mask:0xf bank_mask:0xf
v_cndmask_b32 v23, v24, v25, s[68:69]
v_mov_b32 v28, v29
v_mov_b32 v29, v30
v_mov_b32 v30, v31
v_cvt_pk_bf16_f32 v31, v45, v23
buffer_store_dwordx4 v[28:31], v1, s[16:19], s72 offen offset:1024 sc1
buffer_load_dwordx4 v[12:15], v1, s[16:19], s73 offen sc1
s_add_u32 s57, s63, 524288
buffer_load_dwordx4 v[176:179], v1, s[12:15], s57 offen offset:0 nt
buffer_load_dwordx4 v[180:183], v1, s[12:15], s57 offen offset:1024 nt
buffer_load_dwordx4 v[184:187], v1, s[12:15], s57 offen offset:2048 nt
buffer_load_dwordx4 v[188:191], v1, s[12:15], s57 offen offset:3072 nt
s_add_u32 s57, s63, 557056
buffer_load_dwordx4 v[192:195], v1, s[12:15], s57 offen offset:0 nt
buffer_load_dwordx4 v[196:199], v1, s[12:15], s57 offen offset:1024 nt
buffer_load_dwordx4 v[200:203], v1, s[12:15], s57 offen offset:2048 nt
buffer_load_dwordx4 v[204:207], v1, s[12:15], s57 offen offset:3072 nt
s_add_u32 s57, s63, 589824
buffer_load_dwordx4 v[208:211], v1, s[12:15], s57 offen offset:0 nt
buffer_load_dwordx4 v[212:215], v1, s[12:15], s57 offen offset:1024 nt
buffer_load_dwordx4 v[216:219], v1, s[12:15], s57 offen offset:2048 nt
buffer_load_dwordx4 v[220:223], v1, s[12:15], s57 offen offset:3072 nt
s_add_u32 s57, s63, 622592
buffer_load_dwordx4 v[224:227], v1, s[12:15], s57 offen offset:0 nt
buffer_load_dwordx4 v[228:231], v1, s[12:15], s57 offen offset:1024 nt
buffer_load_dwordx4 v[232:235], v1, s[12:15], s57 offen offset:2048 nt
buffer_load_dwordx4 v[236:239], v1, s[12:15], s57 offen offset:3072 nt
s_add_u32 s57, s63, 458752
buffer_load_dwordx4 v[144:147], v1, s[12:15], s57 offen offset:0 nt
buffer_load_dwordx4 v[148:151], v1, s[12:15], s57 offen offset:1024 nt
buffer_load_dwordx4 v[152:155], v1, s[12:15], s57 offen offset:2048 nt
buffer_load_dwordx4 v[156:159], v1, s[12:15], s57 offen offset:3072 nt
s_add_u32 s57, s63, 491520
buffer_load_dwordx4 v[160:163], v1, s[12:15], s57 offen offset:0 nt
buffer_load_dwordx4 v[164:167], v1, s[12:15], s57 offen offset:1024 nt
buffer_load_dwordx4 v[168:171], v1, s[12:15], s57 offen offset:2048 nt
buffer_load_dwordx4 v[172:175], v1, s[12:15], s57 offen offset:3072 nt
v_lshlrev_b32 v22, 16, v47
v_fmamk_f32 v23, v22, 0x3e0293ee, v6
v_cmp_lt_f32 vcc, 0, v23
s_cbranch_vccnz RS_18
RB_19:
v_exp_f32 v23, v23
s_nop 0
v_add_f32 v7, v7, v23
v_cvt_pk_bf16_f32 v23, v23, v23
s_nop 1
v_and_b32_dpp v24, v23, v2 row_newbcast:0 row_mask:0xf bank_mask:0xf
v_and_b32_dpp v25, v23, v3 row_newbcast:0 row_mask:0xf bank_mask:0xf
v_and_b32_dpp v26, v23, v4 row_newbcast:0 row_mask:0xf bank_mask:0xf
v_and_b32_dpp v27, v23, v5 row_newbcast:0 row_mask:0xf bank_mask:0xf
v_and_b32_dpp v28, v23, v2 row_newbcast:4 row_mask:0xf bank_mask:0xf
v_and_b32_dpp v29, v23, v3 row_newbcast:4 row_mask:0xf bank_mask:0xf
v_and_b32_dpp v30, v23, v4 row_newbcast:4 row_mask:0xf bank_mask:0xf
v_and_b32_dpp v31, v23, v5 row_newbcast:4 row_mask:0xf bank_mask:0xf
v_mfma_f32_16x16x32_bf16 v[8:11], a[64:67], v[24:27], v[8:11]
v_and_b32_dpp v24, v23, v2 row_newbcast:8 row_mask:0xf bank_mask:0xf
v_and_b32_dpp v25, v23, v3 row_newbcast:8 row_mask:0xf bank_mask:0xf
v_and_b32_dpp v26, v23, v4 row_newbcast:8 row_mask:0xf bank_mask:0xf
v_and_b32_dpp v27, v23, v5 row_newbcast:8 row_mask:0xf bank_mask:0xf
v_mfma_f32_16x16x32_bf16 v[8:11], a[68:71], v[28:31], v[8:11]
v_and_b32_dpp v28, v23, v2 row_newbcast:12 row_mask:0xf bank_mask:0xf
v_and_b32_dpp v29, v23, v3 row_newbcast:12 row_mask:0xf bank_mask:0xf
v_and_b32_dpp v30, v23, v4 row_newbcast:12 row_mask:0xf bank_mask:0xf
v_and_b32_dpp v31, v23, v5 row_newbcast:12 row_mask:0xf bank_mask:0xf
v_mfma_f32_16x16x32_bf16 v[8:11], a[72:75], v[24:27], v[8:11]
s_nop 0
v_mfma_f32_16x16x32_bf16 v[8:11], a[76:79], v[28:31], v[8:11]
v_and_b32_dpp v24, v23, v2 row_newbcast:1 row_mask:0xf bank_mask:0xf
v_and_b32_dpp v25, v23, v3 row_newbcast:1 row_mask:0xf bank_mask:0xf
v_and_b32_dpp v26, v23, v4 row_newbcast:1 row_mask:0xf bank_mask:0xf
v_and_b32_dpp v27, v23, v5 row_newbcast:1 row_mask:0xf bank_mask:0xf
v_and_b32_dpp v28, v23, v2 row_newbcast:5 row_mask:0xf bank_mask:0xf
v_and_b32_dpp v29, v23, v3 row_newbcast:5 row_mask:0xf bank_mask:0xf
v_and_b32_dpp v30, v23, v4 row_newbcast:5 row_mask:0xf bank_mask:0xf
v_and_b32_dpp v31, v23, v5 row_newbcast:5 row_mask:0xf bank_mask:0xf
v_mfma_f32_16x16x32_bf16 v[8:11], a[80:83], v[24:27], v[8:11]
v_and_b32_dpp v24, v23, v2 row_newbcast:9 row_mask:0xf bank_mask:0xf
v_and_b32_dpp v25, v23, v3 row_newbcast:9 row_mask:0xf bank_mask:0xf
v_and_b32_dpp v26, v23, v4 row_newbcast:9 row_mask:0xf bank_mask:0xf
v_and_b32_dpp v27, v23, v5 row_newbcast:9 row_mask:0xf bank_mask:0xf
v_mfma_f32_16x16x32_bf16 v[8:11], a[84:87], v[28:31], v[8:11]
v_and_b32_dpp v28, v23, v2 row_newbcast:13 row_mask:0xf bank_mask:0xf
v_and_b32_dpp v29, v23, v3 row_newbcast:13 row_mask:0xf bank_mask:0xf
v_and_b32_dpp v30, v23, v4 row_newbcast:13 row_mask:0xf bank_mask:0xf
v_and_b32_dpp v31, v23, v5 row_newbcast:13 row_mask:0xf bank_mask:0xf
v_mfma_f32_16x16x32_bf16 v[8:11], a[88:91], v[24:27], v[8:11]
s_nop 0
v_mfma_f32_16x16x32_bf16 v[8:11], a[92:95], v[28:31], v[8:11]
v_and_b32_dpp v24, v23, v2 row_newbcast:2 row_mask:0xf bank_mask:0xf
v_and_b32_dpp v25, v23, v3 row_newbcast:2 row_mask:0xf bank_mask:0xf
v_and_b32_dpp v26, v23, v4 row_newbcast:2 row_mask:0xf bank_mask:0xf
v_and_b32_dpp v27, v23, v5 row_newbcast:2 row_mask:0xf bank_mask:0xf
v_and_b32_dpp v28, v23, v2 row_newbcast:6 row_mask:0xf bank_mask:0xf
v_and_b32_dpp v29, v23, v3 row_newbcast:6 row_mask:0xf bank_mask:0xf
v_and_b32_dpp v30, v23, v4 row_newbcast:6 row_mask:0xf bank_mask:0xf
v_and_b32_dpp v31, v23, v5 row_newbcast:6 row_mask:0xf bank_mask:0xf
v_mfma_f32_16x16x32_bf16 v[8:11], a[96:99], v[24:27], v[8:11]
v_and_b32_dpp v24, v23, v2 row_newbcast:10 row_mask:0xf bank_mask:0xf
v_and_b32_dpp v25, v23, v3 row_newbcast:10 row_mask:0xf bank_mask:0xf
v_and_b32_dpp v26, v23, v4 row_newbcast:10 row_mask:0xf bank_mask:0xf
v_and_b32_dpp v27, v23, v5 row_newbcast:10 row_mask:0xf bank_mask:0xf
v_mfma_f32_16x16x32_bf16 v[8:11], a[100:103], v[28:31], v[8:11]
v_and_b32_dpp v28, v23, v2 row_newbcast:14 row_mask:0xf bank_mask:0xf
v_and_b32_dpp v29, v23, v3 row_newbcast:14 row_mask:0xf bank_mask:0xf
v_and_b32_dpp v30, v23, v4 row_newbcast:14 row_mask:0xf bank_mask:0xf
v_and_b32_dpp v31, v23, v5 row_newbcast:14 row_mask:0xf bank_mask:0xf
v_mfma_f32_16x16x32_bf16 v[8:11], a[104:107], v[24:27], v[8:11]
s_nop 0
v_mfma_f32_16x16x32_bf16 v[8:11], a[108:111], v[28:31], v[8:11]
v_and_b32_dpp v24, v23, v2 row_newbcast:3 row_mask:0xf bank_mask:0xf
v_and_b32_dpp v25, v23, v3 row_newbcast:3 row_mask:0xf bank_mask:0xf
v_and_b32_dpp v26, v23, v4 row_newbcast:3 row_mask:0xf bank_mask:0xf
v_and_b32_dpp v27, v23, v5 row_newbcast:3 row_mask:0xf bank_mask:0xf
v_and_b32_dpp v28, v23, v2 row_newbcast:7 row_mask:0xf bank_mask:0xf
v_and_b32_dpp v29, v23, v3 row_newbcast:7 row_mask:0xf bank_mask:0xf
v_and_b32_dpp v30, v23, v4 row_newbcast:7 row_mask:0xf bank_mask:0xf
v_and_b32_dpp v31, v23, v5 row_newbcast:7 row_mask:0xf bank_mask:0xf
v_mfma_f32_16x16x32_bf16 v[8:11], a[112:115], v[24:27], v[8:11]
v_and_b32_dpp v24, v23, v2 row_newbcast:11 row_mask:0xf bank_mask:0xf
v_and_b32_dpp v25, v23, v3 row_newbcast:11 row_mask:0xf bank_mask:0xf
v_and_b32_dpp v26, v23, v4 row_newbcast:11 row_mask:0xf bank_mask:0xf
v_and_b32_dpp v27, v23, v5 row_newbcast:11 row_mask:0xf bank_mask:0xf
v_mfma_f32_16x16x32_bf16 v[8:11], a[116:119], v[28:31], v[8:11]
v_and_b32_dpp v28, v23, v2 row_newbcast:15 row_mask:0xf bank_mask:0xf
v_and_b32_dpp v29, v23, v3 row_newbcast:15 row_mask:0xf bank_mask:0xf
v_and_b32_dpp v30, v23, v4 row_newbcast:15 row_mask:0xf bank_mask:0xf
v_and_b32_dpp v31, v23, v5 row_newbcast:15 row_mask:0xf bank_mask:0xf
v_mfma_f32_16x16x32_bf16 v[8:11], a[120:123], v[24:27], v[8:11]
s_nop 0
v_mfma_f32_16x16x32_bf16 v[8:11], a[124:127], v[28:31], v[8:11]
v_and_b32 v22, 0xffff0000, v47
v_fmamk_f32 v23, v22, 0x3e0293ee, v6
v_cmp_lt_f32 vcc, 0, v23
s_cbranch_vccnz RS_20
RB_21:
v_exp_f32 v23, v23
s_nop 0
v_add_f32 v7, v7, v23
v_cvt_pk_bf16_f32 v23, v23, v23
s_nop 1
v_and_b32_dpp v24, v23, v2 row_newbcast:0 row_mask:0xf bank_mask:0xf
v_and_b32_dpp v25, v23, v3 row_newbcast:0 row_mask:0xf bank_mask:0xf
v_and_b32_dpp v26, v23, v4 row_newbcast:0 row_mask:0xf bank_mask:0xf
v_and_b32_dpp v27, v23, v5 row_newbcast:0 row_mask:0xf bank_mask:0xf
v_and_b32_dpp v28, v23, v2 row_newbcast:4 row_mask:0xf bank_mask:0xf
v_and_b32_dpp v29, v23, v3 row_newbcast:4 row_mask:0xf bank_mask:0xf
v_and_b32_dpp v30, v23, v4 row_newbcast:4 row_mask:0xf bank_mask:0xf
v_and_b32_dpp v31, v23, v5 row_newbcast:4 row_mask:0xf bank_mask:0xf
v_mfma_f32_16x16x32_bf16 v[8:11], a[128:131], v[24:27], v[8:11]
v_and_b32_dpp v24, v23, v2 row_newbcast:8 row_mask:0xf bank_mask:0xf
v_and_b32_dpp v25, v23, v3 row_newbcast:8 row_mask:0xf bank_mask:0xf
v_and_b32_dpp v26, v23, v4 row_newbcast:8 row_mask:0xf bank_mask:0xf
v_and_b32_dpp v27, v23, v5 row_newbcast:8 row_mask:0xf bank_mask:0xf
v_mfma_f32_16x16x32_bf16 v[8:11], a[132:135], v[28:31], v[8:11]
v_and_b32_dpp v28, v23, v2 row_newbcast:12 row_mask:0xf bank_mask:0xf
v_and_b32_dpp v29, v23, v3 row_newbcast:12 row_mask:0xf bank_mask:0xf
v_and_b32_dpp v30, v23, v4 row_newbcast:12 row_mask:0xf bank_mask:0xf
v_and_b32_dpp v31, v23, v5 row_newbcast:12 row_mask:0xf bank_mask:0xf
v_mfma_f32_16x16x32_bf16 v[8:11], a[136:139], v[24:27], v[8:11]
s_nop 0
v_mfma_f32_16x16x32_bf16 v[8:11], a[140:143], v[28:31], v[8:11]
v_and_b32_dpp v24, v23, v2 row_newbcast:1 row_mask:0xf bank_mask:0xf
v_and_b32_dpp v25, v23, v3 row_newbcast:1 row_mask:0xf bank_mask:0xf
v_and_b32_dpp v26, v23, v4 row_newbcast:1 row_mask:0xf bank_mask:0xf
v_and_b32_dpp v27, v23, v5 row_newbcast:1 row_mask:0xf bank_mask:0xf
v_and_b32_dpp v28, v23, v2 row_newbcast:5 row_mask:0xf bank_mask:0xf
v_and_b32_dpp v29, v23, v3 row_newbcast:5 row_mask:0xf bank_mask:0xf
v_and_b32_dpp v30, v23, v4 row_newbcast:5 row_mask:0xf bank_mask:0xf
v_and_b32_dpp v31, v23, v5 row_newbcast:5 row_mask:0xf bank_mask:0xf
v_mfma_f32_16x16x32_bf16 v[8:11], a[144:147], v[24:27], v[8:11]
v_and_b32_dpp v24, v23, v2 row_newbcast:9 row_mask:0xf bank_mask:0xf
v_and_b32_dpp v25, v23, v3 row_newbcast:9 row_mask:0xf bank_mask:0xf
v_and_b32_dpp v26, v23, v4 row_newbcast:9 row_mask:0xf bank_mask:0xf
v_and_b32_dpp v27, v23, v5 row_newbcast:9 row_mask:0xf bank_mask:0xf
v_mfma_f32_16x16x32_bf16 v[8:11], a[148:151], v[28:31], v[8:11]
v_and_b32_dpp v28, v23, v2 row_newbcast:13 row_mask:0xf bank_mask:0xf
v_and_b32_dpp v29, v23, v3 row_newbcast:13 row_mask:0xf bank_mask:0xf
v_and_b32_dpp v30, v23, v4 row_newbcast:13 row_mask:0xf bank_mask:0xf
v_and_b32_dpp v31, v23, v5 row_newbcast:13 row_mask:0xf bank_mask:0xf
v_mfma_f32_16x16x32_bf16 v[8:11], a[152:155], v[24:27], v[8:11]
s_nop 0
v_mfma_f32_16x16x32_bf16 v[8:11], a[156:159], v[28:31], v[8:11]
v_and_b32_dpp v24, v23, v2 row_newbcast:2 row_mask:0xf bank_mask:0xf
v_and_b32_dpp v25, v23, v3 row_newbcast:2 row_mask:0xf bank_mask:0xf
v_and_b32_dpp v26, v23, v4 row_newbcast:2 row_mask:0xf bank_mask:0xf
v_and_b32_dpp v27, v23, v5 row_newbcast:2 row_mask:0xf bank_mask:0xf
v_and_b32_dpp v28, v23, v2 row_newbcast:6 row_mask:0xf bank_mask:0xf
v_and_b32_dpp v29, v23, v3 row_newbcast:6 row_mask:0xf bank_mask:0xf
v_and_b32_dpp v30, v23, v4 row_newbcast:6 row_mask:0xf bank_mask:0xf
v_and_b32_dpp v31, v23, v5 row_newbcast:6 row_mask:0xf bank_mask:0xf
v_mfma_f32_16x16x32_bf16 v[8:11], a[160:163], v[24:27], v[8:11]
v_and_b32_dpp v24, v23, v2 row_newbcast:10 row_mask:0xf bank_mask:0xf
v_and_b32_dpp v25, v23, v3 row_newbcast:10 row_mask:0xf bank_mask:0xf
v_and_b32_dpp v26, v23, v4 row_newbcast:10 row_mask:0xf bank_mask:0xf
v_and_b32_dpp v27, v23, v5 row_newbcast:10 row_mask:0xf bank_mask:0xf
v_mfma_f32_16x16x32_bf16 v[8:11], a[164:167], v[28:31], v[8:11]
v_and_b32_dpp v28, v23, v2 row_newbcast:14 row_mask:0xf bank_mask:0xf
v_and_b32_dpp v29, v23, v3 row_newbcast:14 row_mask:0xf bank_mask:0xf
v_and_b32_dpp v30, v23, v4 row_newbcast:14 row_mask:0xf bank_mask:0xf
v_and_b32_dpp v31, v23, v5 row_newbcast:14 row_mask:0xf bank_mask:0xf
v_mfma_f32_16x16x32_bf16 v[8:11], a[168:171], v[24:27], v[8:11]
s_nop 0
v_mfma_f32_16x16x32_bf16 v[8:11], a[172:175], v[28:31], v[8:11]
v_and_b32_dpp v24, v23, v2 row_newbcast:3 row_mask:0xf bank_mask:0xf
v_and_b32_dpp v25, v23, v3 row_newbcast:3 row_mask:0xf bank_mask:0xf
v_and_b32_dpp v26, v23, v4 row_newbcast:3 row_mask:0xf bank_mask:0xf
v_and_b32_dpp v27, v23, v5 row_newbcast:3 row_mask:0xf bank_mask:0xf
v_and_b32_dpp v28, v23, v2 row_newbcast:7 row_mask:0xf bank_mask:0xf
v_and_b32_dpp v29, v23, v3 row_newbcast:7 row_mask:0xf bank_mask:0xf
v_and_b32_dpp v30, v23, v4 row_newbcast:7 row_mask:0xf bank_mask:0xf
v_and_b32_dpp v31, v23, v5 row_newbcast:7 row_mask:0xf bank_mask:0xf
v_mfma_f32_16x16x32_bf16 v[8:11], a[176:179], v[24:27], v[8:11]
v_and_b32_dpp v24, v23, v2 row_newbcast:11 row_mask:0xf bank_mask:0xf
v_and_b32_dpp v25, v23, v3 row_newbcast:11 row_mask:0xf bank_mask:0xf
v_and_b32_dpp v26, v23, v4 row_newbcast:11 row_mask:0xf bank_mask:0xf
v_and_b32_dpp v27, v23, v5 row_newbcast:11 row_mask:0xf bank_mask:0xf
v_mfma_f32_16x16x32_bf16 v[8:11], a[180:183], v[28:31], v[8:11]
v_and_b32_dpp v28, v23, v2 row_newbcast:15 row_mask:0xf bank_mask:0xf
v_and_b32_dpp v29, v23, v3 row_newbcast:15 row_mask:0xf bank_mask:0xf
v_and_b32_dpp v30, v23, v4 row_newbcast:15 row_mask:0xf bank_mask:0xf
v_and_b32_dpp v31, v23, v5 row_newbcast:15 row_mask:0xf bank_mask:0xf
v_mfma_f32_16x16x32_bf16 v[8:11], a[184:187], v[24:27], v[8:11]
s_nop 0
v_mfma_f32_16x16x32_bf16 v[8:11], a[188:191], v[28:31], v[8:11]
v_mov_b32 v16, 0
s_lshl_b32 s76, s48, 9
s_lshr_b32 s57, s49, 2
s_lshl_b32 s57, s57, 7
s_add_u32 s76, s76, s57
s_add_u32 s76, s76, 2162688
s_waitcnt vmcnt(24)
v_lshlrev_b32 v22, 16, v13
v_fmamk_f32 v23, v22, 0x3e0293ee, v6
v_cmp_lt_f32 vcc, 0, v23
s_cbranch_vccnz RS_22
RB_23:
v_exp_f32 v23, v23
s_nop 0
v_add_f32 v7, v7, v23
v_cvt_pk_bf16_f32 v23, v23, v23
s_nop 1
v_and_b32_dpp v24, v23, v2 row_newbcast:0 row_mask:0xf bank_mask:0xf
v_and_b32_dpp v25, v23, v3 row_newbcast:0 row_mask:0xf bank_mask:0xf
v_and_b32_dpp v26, v23, v4 row_newbcast:0 row_mask:0xf bank_mask:0xf
v_and_b32_dpp v27, v23, v5 row_newbcast:0 row_mask:0xf bank_mask:0xf
v_and_b32_dpp v28, v23, v2 row_newbcast:4 row_mask:0xf bank_mask:0xf
v_and_b32_dpp v29, v23, v3 row_newbcast:4 row_mask:0xf bank_mask:0xf
v_and_b32_dpp v30, v23, v4 row_newbcast:4 row_mask:0xf bank_mask:0xf
v_and_b32_dpp v31, v23, v5 row_newbcast:4 row_mask:0xf bank_mask:0xf
v_mfma_f32_16x16x32_bf16 v[8:11], a[192:195], v[24:27], v[8:11]
v_and_b32_dpp v24, v23, v2 row_newbcast:8 row_mask:0xf bank_mask:0xf
v_and_b32_dpp v25, v23, v3 row_newbcast:8 row_mask:0xf bank_mask:0xf
v_and_b32_dpp v26, v23, v4 row_newbcast:8 row_mask:0xf bank_mask:0xf
v_and_b32_dpp v27, v23, v5 row_newbcast:8 row_mask:0xf bank_mask:0xf
v_mfma_f32_16x16x32_bf16 v[8:11], a[196:199], v[28:31], v[8:11]
v_and_b32_dpp v28, v23, v2 row_newbcast:12 row_mask:0xf bank_mask:0xf
v_and_b32_dpp v29, v23, v3 row_newbcast:12 row_mask:0xf bank_mask:0xf
v_and_b32_dpp v30, v23, v4 row_newbcast:12 row_mask:0xf bank_mask:0xf
v_and_b32_dpp v31, v23, v5 row_newbcast:12 row_mask:0xf bank_mask:0xf
v_mfma_f32_16x16x32_bf16 v[8:11], a[200:203], v[24:27], v[8:11]
s_nop 0
v_mfma_f32_16x16x32_bf16 v[8:11], a[204:207], v[28:31], v[8:11]
v_and_b32_dpp v24, v23, v2 row_newbcast:1 row_mask:0xf bank_mask:0xf
v_and_b32_dpp v25, v23, v3 row_newbcast:1 row_mask:0xf bank_mask:0xf
v_and_b32_dpp v26, v23, v4 row_newbcast:1 row_mask:0xf bank_mask:0xf
v_and_b32_dpp v27, v23, v5 row_newbcast:1 row_mask:0xf bank_mask:0xf
v_and_b32_dpp v28, v23, v2 row_newbcast:5 row_mask:0xf bank_mask:0xf
v_and_b32_dpp v29, v23, v3 row_newbcast:5 row_mask:0xf bank_mask:0xf
v_and_b32_dpp v30, v23, v4 row_newbcast:5 row_mask:0xf bank_mask:0xf
v_and_b32_dpp v31, v23, v5 row_newbcast:5 row_mask:0xf bank_mask:0xf
v_mfma_f32_16x16x32_bf16 v[8:11], v[240:243], v[24:27], v[8:11]
v_and_b32_dpp v24, v23, v2 row_newbcast:9 row_mask:0xf bank_mask:0xf
v_and_b32_dpp v25, v23, v3 row_newbcast:9 row_mask:0xf bank_mask:0xf
v_and_b32_dpp v26, v23, v4 row_newbcast:9 row_mask:0xf bank_mask:0xf
v_and_b32_dpp v27, v23, v5 row_newbcast:9 row_mask:0xf bank_mask:0xf
v_mfma_f32_16x16x32_bf16 v[8:11], v[244:247], v[28:31], v[8:11]
v_and_b32_dpp v28, v23, v2 row_newbcast:13 row_mask:0xf bank_mask:0xf
v_and_b32_dpp v29, v23, v3 row_newbcast:13 row_mask:0xf bank_mask:0xf
v_and_b32_dpp v30, v23, v4 row_newbcast:13 row_mask:0xf bank_mask:0xf
v_and_b32_dpp v31, v23, v5 row_newbcast:13 row_mask:0xf bank_mask:0xf
v_mfma_f32_16x16x32_bf16 v[8:11], v[248:251], v[24:27], v[8:11]
s_nop 0
v_mfma_f32_16x16x32_bf16 v[8:11], v[252:255], v[28:31], v[8:11]
v_and_b32_dpp v24, v23, v2 row_newbcast:2 row_mask:0xf bank_mask:0xf
v_and_b32_dpp v25, v23, v3 row_newbcast:2 row_mask:0xf bank_mask:0xf
v_and_b32_dpp v26, v23, v4 row_newbcast:2 row_mask:0xf bank_mask:0xf
v_and_b32_dpp v27, v23, v5 row_newbcast:2 row_mask:0xf bank_mask:0xf
v_and_b32_dpp v28, v23, v2 row_newbcast:6 row_mask:0xf bank_mask:0xf
v_and_b32_dpp v29, v23, v3 row_newbcast:6 row_mask:0xf bank_mask:0xf
v_and_b32_dpp v30, v23, v4 row_newbcast:6 row_mask:0xf bank_mask:0xf
v_and_b32_dpp v31, v23, v5 row_newbcast:6 row_mask:0xf bank_mask:0xf
ds_write_b128 v44, v[112:115] offset:32768
ds_write_b128 v44, v[116:119] offset:33792
ds_write_b128 v44, v[120:123] offset:34816
ds_write_b128 v44, v[124:127] offset:35840
v_mfma_f32_16x16x32_bf16 v[8:11], v[112:115], v[24:27], v[8:11]
v_and_b32_dpp v24, v23, v2 row_newbcast:10 row_mask:0xf bank_mask:0xf
v_and_b32_dpp v25, v23, v3 row_newbcast:10 row_mask:0xf bank_mask:0xf
v_and_b32_dpp v26, v23, v4 row_newbcast:10 row_mask:0xf bank_mask:0xf
v_and_b32_dpp v27, v23, v5 row_newbcast:10 row_mask:0xf bank_mask:0xf
v_mfma_f32_16x16x32_bf16 v[8:11], v[116:119], v[28:31], v[8:11]
v_and_b32_dpp v28, v23, v2 row_newbcast:14 row_mask:0xf bank_mask:0xf
v_and_b32_dpp v29, v23, v3 row_newbcast:14 row_mask:0xf bank_mask:0xf
v_and_b32_dpp v30, v23, v4 row_newbcast:14 row_mask:0xf bank_mask:0xf
v_and_b32_dpp v31, v23, v5 row_newbcast:14 row_mask:0xf bank_mask:0xf
v_mfma_f32_16x16x32_bf16 v[8:11], v[120:123], v[24:27], v[8:11]
s_nop 0
v_mfma_f32_16x16x32_bf16 v[8:11], v[124:127], v[28:31], v[8:11]
s_waitcnt lgkmcnt(0)
s_add_u32 s57, s63, 393216
buffer_load_dwordx4 v[112:115], v1, s[12:15], s57 offen offset:0 nt
buffer_load_dwordx4 v[116:119], v1, s[12:15], s57 offen offset:1024 nt
buffer_load_dwordx4 v[120:123], v1, s[12:15], s57 offen offset:2048 nt
buffer_load_dwordx4 v[124:127], v1, s[12:15], s57 offen offset:3072 nt
v_and_b32_dpp v24, v23, v2 row_newbcast:3 row_mask:0xf bank_mask:0xf
v_and_b32_dpp v25, v23, v3 row_newbcast:3 row_mask:0xf bank_mask:0xf
v_and_b32_dpp v26, v23, v4 row_newbcast:3 row_mask:0xf bank_mask:0xf
v_and_b32_dpp v27, v23, v5 row_newbcast:3 row_mask:0xf bank_mask:0xf
v_and_b32_dpp v28, v23, v2 row_newbcast:7 row_mask:0xf bank_mask:0xf
v_and_b32_dpp v29, v23, v3 row_newbcast:7 row_mask:0xf bank_mask:0xf
v_and_b32_dpp v30, v23, v4 row_newbcast:7 row_mask:0xf bank_mask:0xf
v_and_b32_dpp v31, v23, v5 row_newbcast:7 row_mask:0xf bank_mask:0xf
s_cmp_ge_u32 s3, 2
s_cbranch_scc1 SK_25
ds_write_b128 v44, v[128:131] offset:36864
ds_write_b128 v44, v[132:135] offset:37888
ds_write_b128 v44, v[136:139] offset:38912
ds_write_b128 v44, v[140:143] offset:39936
SK_25:
v_mfma_f32_16x16x32_bf16 v[8:11], v[128:131], v[24:27], v[8:11]
v_and_b32_dpp v24, v23, v2 row_newbcast:11 row_mask:0xf bank_mask:0xf
v_and_b32_dpp v25, v23, v3 row_newbcast:11 row_mask:0xf bank_mask:0xf
v_and_b32_dpp v26, v23, v4 row_newbcast:11 row_mask:0xf bank_mask:0xf
v_and_b32_dpp v27, v23, v5 row_newbcast:11 row_mask:0xf bank_mask:0xf
v_mfma_f32_16x16x32_bf16 v[8:11], v[132:135], v[28:31], v[8:11]
v_and_b32_dpp v28, v23, v2 row_newbcast:15 row_mask:0xf bank_mask:0xf
v_and_b32_dpp v29, v23, v3 row_newbcast:15 row_mask:0xf bank_mask:0xf
v_and_b32_dpp v30, v23, v4 row_newbcast:15 row_mask:0xf bank_mask:0xf
v_and_b32_dpp v31, v23, v5 row_newbcast:15 row_mask:0xf bank_mask:0xf
v_mfma_f32_16x16x32_bf16 v[8:11], v[136:139], v[24:27], v[8:11]
s_nop 0
v_mfma_f32_16x16x32_bf16 v[8:11], v[140:143], v[28:31], v[8:11]
s_waitcnt lgkmcnt(0)
s_add_u32 s57, s63, 425984
buffer_load_dwordx4 v[128:131], v1, s[12:15], s57 offen offset:0 nt
buffer_load_dwordx4 v[132:135], v1, s[12:15], s57 offen offset:1024 nt
buffer_load_dwordx4 v[136:139], v1, s[12:15], s57 offen offset:2048 nt
buffer_load_dwordx4 v[140:143], v1, s[12:15], s57 offen offset:3072 nt
s_barrier
s_cmp_lg_u32 s3, 3
s_cbranch_scc1 SK_26
v_mov_b32 v24, 2
v_mov_b32 v25, 2
v_mov_b32 v26, 2
v_mov_b32 v27, 2
s_lshl_b32 s57, s2, 7
s_add_u32 s57, s57, 2097152
s_mov_b64 exec, 0xff
buffer_store_dwordx4 v[24:27], v1, s[16:19], s57 offen sc1
s_mov_b64 exec, -1
SK_26:
v_and_b32 v22, 0xffff0000, v14
v_fmamk_f32 v23, v22, 0x3e0293ee, v6
v_cmp_lt_f32 vcc, 0, v23
s_cbranch_vccnz RS_27
RB_28:
v_exp_f32 v23, v23
s_nop 0
v_add_f32 v7, v7, v23
v_cvt_pk_bf16_f32 v23, v23, v23
s_nop 1
v_and_b32_dpp v24, v23, v2 row_newbcast:0 row_mask:0xf bank_mask:0xf
v_and_b32_dpp v25, v23, v3 row_newbcast:0 row_mask:0xf bank_mask:0xf
v_and_b32_dpp v26, v23, v4 row_newbcast:0 row_mask:0xf bank_mask:0xf
v_and_b32_dpp v27, v23, v5 row_newbcast:0 row_mask:0xf bank_mask:0xf
v_and_b32_dpp v28, v23, v2 row_newbcast:4 row_mask:0xf bank_mask:0xf
v_and_b32_dpp v29, v23, v3 row_newbcast:4 row_mask:0xf bank_mask:0xf
v_and_b32_dpp v30, v23, v4 row_newbcast:4 row_mask:0xf bank_mask:0xf
v_and_b32_dpp v31, v23, v5 row_newbcast:4 row_mask:0xf bank_mask:0xf
ds_write_b128 v44, a[0:3] offset:0
ds_write_b128 v44, a[4:7] offset:1024
ds_write_b128 v44, a[8:11] offset:2048
ds_write_b128 v44, a[12:15] offset:3072
v_mfma_f32_16x16x32_bf16 v[8:11], a[0:3], v[24:27], v[8:11]
v_and_b32_dpp v24, v23, v2 row_newbcast:8 row_mask:0xf bank_mask:0xf
v_and_b32_dpp v25, v23, v3 row_newbcast:8 row_mask:0xf bank_mask:0xf
v_and_b32_dpp v26, v23, v4 row_newbcast:8 row_mask:0xf bank_mask:0xf
v_and_b32_dpp v27, v23, v5 row_newbcast:8 row_mask:0xf bank_mask:0xf
v_mfma_f32_16x16x32_bf16 v[8:11], a[4:7], v[28:31], v[8:11]
v_and_b32_dpp v28, v23, v2 row_newbcast:12 row_mask:0xf bank_mask:0xf
v_and_b32_dpp v29, v23, v3 row_newbcast:12 row_mask:0xf bank_mask:0xf
v_and_b32_dpp v30, v23, v4 row_newbcast:12 row_mask:0xf bank_mask:0xf
v_and_b32_dpp v31, v23, v5 row_newbcast:12 row_mask:0xf bank_mask:0xf
v_mfma_f32_16x16x32_bf16 v[8:11], a[8:11], v[24:27], v[8:11]
s_nop 0
v_mfma_f32_16x16x32_bf16 v[8:11], a[12:15], v[28:31], v[8:11]
s_waitcnt lgkmcnt(0)
s_add_u32 s57, s63, 786432
buffer_load_dwordx4 a[0:3], v1, s[12:15], s57 offen offset:0 nt
buffer_load_dwordx4 a[4:7], v1, s[12:15], s57 offen offset:1024 nt
buffer_load_dwordx4 a[8:11], v1, s[12:15], s57 offen offset:2048 nt
buffer_load_dwordx4 a[12:15], v1, s[12:15], s57 offen offset:3072 nt
v_and_b32_dpp v24, v23, v2 row_newbcast:1 row_mask:0xf bank_mask:0xf
v_and_b32_dpp v25, v23, v3 row_newbcast:1 row_mask:0xf bank_mask:0xf
v_and_b32_dpp v26, v23, v4 row_newbcast:1 row_mask:0xf bank_mask:0xf
v_and_b32_dpp v27, v23, v5 row_newbcast:1 row_mask:0xf bank_mask:0xf
v_and_b32_dpp v28, v23, v2 row_newbcast:5 row_mask:0xf bank_mask:0xf
v_and_b32_dpp v29, v23, v3 row_newbcast:5 row_mask:0xf bank_mask:0xf
v_and_b32_dpp v30, v23, v4 row_newbcast:5 row_mask:0xf bank_mask:0xf
v_and_b32_dpp v31, v23, v5 row_newbcast:5 row_mask:0xf bank_mask:0xf
ds_write_b128 v44, a[16:19] offset:4096
ds_write_b128 v44, a[20:23] offset:5120
ds_write_b128 v44, a[24:27] offset:6144
ds_write_b128 v44, a[28:31] offset:7168
v_mfma_f32_16x16x32_bf16 v[8:11], a[16:19], v[24:27], v[8:11]
v_and_b32_dpp v24, v23, v2 row_newbcast:9 row_mask:0xf bank_mask:0xf
v_and_b32_dpp v25, v23, v3 row_newbcast:9 row_mask:0xf bank_mask:0xf
v_and_b32_dpp v26, v23, v4 row_newbcast:9 row_mask:0xf bank_mask:0xf
v_and_b32_dpp v27, v23, v5 row_newbcast:9 row_mask:0xf bank_mask:0xf
v_mfma_f32_16x16x32_bf16 v[8:11], a[20:23], v[28:31], v[8:11]
v_and_b32_dpp v28, v23, v2 row_newbcast:13 row_mask:0xf bank_mask:0xf
v_and_b32_dpp v29, v23, v3 row_newbcast:13 row_mask:0xf bank_mask:0xf
v_and_b32_dpp v30, v23, v4 row_newbcast:13 row_mask:0xf bank_mask:0xf
v_and_b32_dpp v31, v23, v5 row_newbcast:13 row_mask:0xf bank_mask:0xf
v_mfma_f32_16x16x32_bf16 v[8:11], a[24:27], v[24:27], v[8:11]
s_nop 0
v_mfma_f32_16x16x32_bf16 v[8:11], a[28:31], v[28:31], v[8:11]
s_waitcnt lgkmcnt(0)
s_add_u32 s57, s63, 819200
buffer_load_dwordx4 a[16:19], v1, s[12:15], s57 offen offset:0 nt
buffer_load_dwordx4 a[20:23], v1, s[12:15], s57 offen offset:1024 nt
buffer_load_dwordx4 a[24:27], v1, s[12:15], s57 offen offset:2048 nt
buffer_load_dwordx4 a[28:31], v1, s[12:15], s57 offen offset:3072 nt
v_and_b32_dpp v24, v23, v2 row_newbcast:2 row_mask:0xf bank_mask:0xf
v_and_b32_dpp v25, v23, v3 row_newbcast:2 row_mask:0xf bank_mask:0xf
v_and_b32_dpp v26, v23, v4 row_newbcast:2 row_mask:0xf bank_mask:0xf
v_and_b32_dpp v27, v23, v5 row_newbcast:2 row_mask:0xf bank_mask:0xf
v_and_b32_dpp v28, v23, v2 row_newbcast:6 row_mask:0xf bank_mask:0xf
v_and_b32_dpp v29, v23, v3 row_newbcast:6 row_mask:0xf bank_mask:0xf
v_and_b32_dpp v30, v23, v4 row_newbcast:6 row_mask:0xf bank_mask:0xf
v_and_b32_dpp v31, v23, v5 row_newbcast:6 row_mask:0xf bank_mask:0xf
ds_write_b128 v44, a[32:35] offset:8192
ds_write_b128 v44, a[36:39] offset:9216
ds_write_b128 v44, a[40:43] offset:10240
ds_write_b128 v44, a[44:47] offset:11264
v_mfma_f32_16x16x32_bf16 v[8:11], a[32:35], v[24:27], v[8:11]
v_and_b32_dpp v24, v23, v2 row_newbcast:10 row_mask:0xf bank_mask:0xf
v_and_b32_dpp v25, v23, v3 row_newbcast:10 row_mask:0xf bank_mask:0xf
v_and_b32_dpp v26, v23, v4 row_newbcast:10 row_mask:0xf bank_mask:0xf
v_and_b32_dpp v27, v23, v5 row_newbcast:10 row_mask:0xf bank_mask:0xf
v_mfma_f32_16x16x32_bf16 v[8:11], a[36:39], v[28:31], v[8:11]
v_and_b32_dpp v28, v23, v2 row_newbcast:14 row_mask:0xf bank_mask:0xf
v_and_b32_dpp v29, v23, v3 row_newbcast:14 row_mask:0xf bank_mask:0xf
v_and_b32_dpp v30, v23, v4 row_newbcast:14 row_mask:0xf bank_mask:0xf
v_and_b32_dpp v31, v23, v5 row_newbcast:14 row_mask:0xf bank_mask:0xf
v_mfma_f32_16x16x32_bf16 v[8:11], a[40:43], v[24:27], v[8:11]
s_nop 0
v_mfma_f32_16x16x32_bf16 v[8:11], a[44:47], v[28:31], v[8:11]
s_waitcnt lgkmcnt(0)
s_add_u32 s57, s63, 851968
buffer_load_dwordx4 a[32:35], v1, s[12:15], s57 offen offset:0 nt
buffer_load_dwordx4 a[36:39], v1, s[12:15], s57 offen offset:1024 nt
buffer_load_dwordx4 a[40:43], v1, s[12:15], s57 offen offset:2048 nt
buffer_load_dwordx4 a[44:47], v1, s[12:15], s57 offen offset:3072 nt
v_and_b32_dpp v24, v23, v2 row_newbcast:3 row_mask:0xf bank_mask:0xf
v_and_b32_dpp v25, v23, v3 row_newbcast:3 row_mask:0xf bank_mask:0xf
v_and_b32_dpp v26, v23, v4 row_newbcast:3 row_mask:0xf bank_mask:0xf
v_and_b32_dpp v27, v23, v5 row_newbcast:3 row_mask:0xf bank_mask:0xf
v_and_b32_dpp v28, v23, v2 row_newbcast:7 row_mask:0xf bank_mask:0xf
v_and_b32_dpp v29, v23, v3 row_newbcast:7 row_mask:0xf bank_mask:0xf
v_and_b32_dpp v30, v23, v4 row_newbcast:7 row_mask:0xf bank_mask:0xf
v_and_b32_dpp v31, v23, v5 row_newbcast:7 row_mask:0xf bank_mask:0xf
ds_write_b128 v44, a[48:51] offset:12288
ds_write_b128 v44, a[52:55] offset:13312
ds_write_b128 v44, a[56:59] offset:14336
ds_write_b128 v44, a[60:63] offset:15360
v_mfma_f32_16x16x32_bf16 v[8:11], a[48:51], v[24:27], v[8:11]
v_and_b32_dpp v24, v23, v2 row_newbcast:11 row_mask:0xf bank_mask:0xf
v_and_b32_dpp v25, v23, v3 row_newbcast:11 row_mask:0xf bank_mask:0xf
v_and_b32_dpp v26, v23, v4 row_newbcast:11 row_mask:0xf bank_mask:0xf
v_and_b32_dpp v27, v23, v5 row_newbcast:11 row_mask:0xf bank_mask:0xf
v_mfma_f32_16x16x32_bf16 v[8:11], a[52:55], v[28:31], v[8:11]
v_and_b32_dpp v28, v23, v2 row_newbcast:15 row_mask:0xf bank_mask:0xf
v_and_b32_dpp v29, v23, v3 row_newbcast:15 row_mask:0xf bank_mask:0xf
v_and_b32_dpp v30, v23, v4 row_newbcast:15 row_mask:0xf bank_mask:0xf
v_and_b32_dpp v31, v23, v5 row_newbcast:15 row_mask:0xf bank_mask:0xf
v_mfma_f32_16x16x32_bf16 v[8:11], a[56:59], v[24:27], v[8:11]
s_nop 0
v_mfma_f32_16x16x32_bf16 v[8:11], a[60:63], v[28:31], v[8:11]
s_waitcnt lgkmcnt(0)
s_add_u32 s57, s63, 884736
buffer_load_dwordx4 a[48:51], v1, s[12:15], s57 offen offset:0 nt
buffer_load_dwordx4 a[52:55], v1, s[12:15], s57 offen offset:1024 nt
buffer_load_dwordx4 a[56:59], v1, s[12:15], s57 offen offset:2048 nt
buffer_load_dwordx4 a[60:63], v1, s[12:15], s57 offen offset:3072 nt
v_lshlrev_b32 v22, 16, v14
v_fmamk_f32 v23, v22, 0x3e0293ee, v6
v_cmp_lt_f32 vcc, 0, v23
s_cbranch_vccnz RS_33
RB_34:
v_exp_f32 v23, v23
s_nop 0
v_add_f32 v7, v7, v23
v_cvt_pk_bf16_f32 v23, v23, v23
s_nop 1
v_and_b32_dpp v24, v23, v2 row_newbcast:0 row_mask:0xf bank_mask:0xf
v_and_b32_dpp v25, v23, v3 row_newbcast:0 row_mask:0xf bank_mask:0xf
v_and_b32_dpp v26, v23, v4 row_newbcast:0 row_mask:0xf bank_mask:0xf
v_and_b32_dpp v27, v23, v5 row_newbcast:0 row_mask:0xf bank_mask:0xf
v_and_b32_dpp v28, v23, v2 row_newbcast:4 row_mask:0xf bank_mask:0xf
v_and_b32_dpp v29, v23, v3 row_newbcast:4 row_mask:0xf bank_mask:0xf
v_and_b32_dpp v30, v23, v4 row_newbcast:4 row_mask:0xf bank_mask:0xf
v_and_b32_dpp v31, v23, v5 row_newbcast:4 row_mask:0xf bank_mask:0xf
s_waitcnt vmcnt(44)
v_mfma_f32_16x16x32_bf16 v[8:11], v[176:179], v[24:27], v[8:11]
v_and_b32_dpp v24, v23, v2 row_newbcast:8 row_mask:0xf bank_mask:0xf
v_and_b32_dpp v25, v23, v3 row_newbcast:8 row_mask:0xf bank_mask:0xf
v_and_b32_dpp v26, v23, v4 row_newbcast:8 row_mask:0xf bank_mask:0xf
v_and_b32_dpp v27, v23, v5 row_newbcast:8 row_mask:0xf bank_mask:0xf
v_mfma_f32_16x16x32_bf16 v[8:11], v[180:183], v[28:31], v[8:11]
v_and_b32_dpp v28, v23, v2 row_newbcast:12 row_mask:0xf bank_mask:0xf
v_and_b32_dpp v29, v23, v3 row_newbcast:12 row_mask:0xf bank_mask:0xf
v_and_b32_dpp v30, v23, v4 row_newbcast:12 row_mask:0xf bank_mask:0xf
v_and_b32_dpp v31, v23, v5 row_newbcast:12 row_mask:0xf bank_mask:0xf
v_mfma_f32_16x16x32_bf16 v[8:11], v[184:187], v[24:27], v[8:11]
s_nop 0
v_mfma_f32_16x16x32_bf16 v[8:11], v[188:191], v[28:31], v[8:11]
v_and_b32_dpp v24, v23, v2 row_newbcast:1 row_mask:0xf bank_mask:0xf
v_and_b32_dpp v25, v23, v3 row_newbcast:1 row_mask:0xf bank_mask:0xf
v_and_b32_dpp v26, v23, v4 row_newbcast:1 row_mask:0xf bank_mask:0xf
v_and_b32_dpp v27, v23, v5 row_newbcast:1 row_mask:0xf bank_mask:0xf
v_and_b32_dpp v28, v23, v2 row_newbcast:5 row_mask:0xf bank_mask:0xf
v_and_b32_dpp v29, v23, v3 row_newbcast:5 row_mask:0xf bank_mask:0xf
v_and_b32_dpp v30, v23, v4 row_newbcast:5 row_mask:0xf bank_mask:0xf
v_and_b32_dpp v31, v23, v5 row_newbcast:5 row_mask:0xf bank_mask:0xf
s_waitcnt vmcnt(40)
v_mfma_f32_16x16x32_bf16 v[8:11], v[192:195], v[24:27], v[8:11]
v_and_b32_dpp v24, v23, v2 row_newbcast:9 row_mask:0xf bank_mask:0xf
v_and_b32_dpp v25, v23, v3 row_newbcast:9 row_mask:0xf bank_mask:0xf
v_and_b32_dpp v26, v23, v4 row_newbcast:9 row_mask:0xf bank_mask:0xf
v_and_b32_dpp v27, v23, v5 row_newbcast:9 row_mask:0xf bank_mask:0xf
v_mfma_f32_16x16x32_bf16 v[8:11], v[196:199], v[28:31], v[8:11]
v_and_b32_dpp v28, v23, v2 row_newbcast:13 row_mask:0xf bank_mask:0xf
v_and_b32_dpp v29, v23, v3 row_newbcast:13 row_mask:0xf bank_mask:0xf
v_and_b32_dpp v30, v23, v4 row_newbcast:13 row_mask:0xf bank_mask:0xf
v_and_b32_dpp v31, v23, v5 row_newbcast:13 row_mask:0xf bank_mask:0xf
v_mfma_f32_16x16x32_bf16 v[8:11], v[200:203], v[24:27], v[8:11]
s_nop 0
v_mfma_f32_16x16x32_bf16 v[8:11], v[204:207], v[28:31], v[8:11]
v_and_b32_dpp v24, v23, v2 row_newbcast:2 row_mask:0xf bank_mask:0xf
v_and_b32_dpp v25, v23, v3 row_newbcast:2 row_mask:0xf bank_mask:0xf
v_and_b32_dpp v26, v23, v4 row_newbcast:2 row_mask:0xf bank_mask:0xf
v_and_b32_dpp v27, v23, v5 row_newbcast:2 row_mask:0xf bank_mask:0xf
v_and_b32_dpp v28, v23, v2 row_newbcast:6 row_mask:0xf bank_mask:0xf
v_and_b32_dpp v29, v23, v3 row_newbcast:6 row_mask:0xf bank_mask:0xf
v_and_b32_dpp v30, v23, v4 row_newbcast:6 row_mask:0xf bank_mask:0xf
v_and_b32_dpp v31, v23, v5 row_newbcast:6 row_mask:0xf bank_mask:0xf
s_waitcnt vmcnt(36)
v_mfma_f32_16x16x32_bf16 v[8:11], v[208:211], v[24:27], v[8:11]
v_and_b32_dpp v24, v23, v2 row_newbcast:10 row_mask:0xf bank_mask:0xf
v_and_b32_dpp v25, v23, v3 row_newbcast:10 row_mask:0xf bank_mask:0xf
v_and_b32_dpp v26, v23, v4 row_newbcast:10 row_mask:0xf bank_mask:0xf
v_and_b32_dpp v27, v23, v5 row_newbcast:10 row_mask:0xf bank_mask:0xf
v_mfma_f32_16x16x32_bf16 v[8:11], v[212:215], v[28:31], v[8:11]
v_and_b32_dpp v28, v23, v2 row_newbcast:14 row_mask:0xf bank_mask:0xf
v_and_b32_dpp v29, v23, v3 row_newbcast:14 row_mask:0xf bank_mask:0xf
v_and_b32_dpp v30, v23, v4 row_newbcast:14 row_mask:0xf bank_mask:0xf
v_and_b32_dpp v31, v23, v5 row_newbcast:14 row_mask:0xf bank_mask:0xf
v_mfma_f32_16x16x32_bf16 v[8:11], v[216:219], v[24:27], v[8:11]
s_nop 0
v_mfma_f32_16x16x32_bf16 v[8:11], v[220:223], v[28:31], v[8:11]
v_and_b32_dpp v24, v23, v2 row_newbcast:3 row_mask:0xf bank_mask:0xf
v_and_b32_dpp v25, v23, v3 row_newbcast:3 row_mask:0xf bank_mask:0xf
v_and_b32_dpp v26, v23, v4 row_newbcast:3 row_mask:0xf bank_mask:0xf
v_and_b32_dpp v27, v23, v5 row_newbcast:3 row_mask:0xf bank_mask:0xf
v_and_b32_dpp v28, v23, v2 row_newbcast:7 row_mask:0xf bank_mask:0xf
v_and_b32_dpp v29, v23, v3 row_newbcast:7 row_mask:0xf bank_mask:0xf
v_and_b32_dpp v30, v23, v4 row_newbcast:7 row_mask:0xf bank_mask:0xf
v_and_b32_dpp v31, v23, v5 row_newbcast:7 row_mask:0xf bank_mask:0xf
s_waitcnt vmcnt(32)
v_mfma_f32_16x16x32_bf16 v[8:11], v[224:227], v[24:27], v[8:11]
v_and_b32_dpp v24, v23, v2 row_newbcast:11 row_mask:0xf bank_mask:0xf
v_and_b32_dpp v25, v23, v3 row_newbcast:11 row_mask:0xf bank_mask:0xf
v_and_b32_dpp v26, v23, v4 row_newbcast:11 row_mask:0xf bank_mask:0xf
v_and_b32_dpp v27, v23, v5 row_newbcast:11 row_mask:0xf bank_mask:0xf
v_mfma_f32_16x16x32_bf16 v[8:11], v[228:231], v[28:31], v[8:11]
v_and_b32_dpp v28, v23, v2 row_newbcast:15 row_mask:0xf bank_mask:0xf
v_and_b32_dpp v29, v23, v3 row_newbcast:15 row_mask:0xf bank_mask:0xf
v_and_b32_dpp v30, v23, v4 row_newbcast:15 row_mask:0xf bank_mask:0xf
v_and_b32_dpp v31, v23, v5 row_newbcast:15 row_mask:0xf bank_mask:0xf
v_mfma_f32_16x16x32_bf16 v[8:11], v[232:235], v[24:27], v[8:11]
s_nop 0
v_mfma_f32_16x16x32_bf16 v[8:11], v[236:239], v[28:31], v[8:11]
s_xor_b32 s57, s2, 4
s_lshl_b32 s57, s57, 7
s_add_u32 s57, s57, 2097152
s_add_u32 s0, s46, s57
s_addc_u32 s1, s47, 0
s_load_dword s20, s[0:1], 0 glc
v_and_b32 v22, 0xffff0000, v13
v_fmamk_f32 v23, v22, 0x3e0293ee, v6
v_cmp_lt_f32 vcc, 0, v23
s_cbranch_vccnz RS_35
RB_36:
v_exp_f32 v23, v23
s_nop 0
v_add_f32 v7, v7, v23
v_cvt_pk_bf16_f32 v23, v23, v23
s_nop 1
v_and_b32_dpp v24, v23, v2 row_newbcast:0 row_mask:0xf bank_mask:0xf
v_and_b32_dpp v25, v23, v3 row_newbcast:0 row_mask:0xf bank_mask:0xf
v_and_b32_dpp v26, v23, v4 row_newbcast:0 row_mask:0xf bank_mask:0xf
v_and_b32_dpp v27, v23, v5 row_newbcast:0 row_mask:0xf bank_mask:0xf
v_and_b32_dpp v28, v23, v2 row_newbcast:4 row_mask:0xf bank_mask:0xf
v_and_b32_dpp v29, v23, v3 row_newbcast:4 row_mask:0xf bank_mask:0xf
v_and_b32_dpp v30, v23, v4 row_newbcast:4 row_mask:0xf bank_mask:0xf
v_and_b32_dpp v31, v23, v5 row_newbcast:4 row_mask:0xf bank_mask:0xf
s_waitcnt vmcnt(20)
v_mfma_f32_16x16x32_bf16 v[8:11], v[112:115], v[24:27], v[8:11]
v_and_b32_dpp v24, v23, v2 row_newbcast:8 row_mask:0xf bank_mask:0xf
v_and_b32_dpp v25, v23, v3 row_newbcast:8 row_mask:0xf bank_mask:0xf
v_and_b32_dpp v26, v23, v4 row_newbcast:8 row_mask:0xf bank_mask:0xf
v_and_b32_dpp v27, v23, v5 row_newbcast:8 row_mask:0xf bank_mask:0xf
v_mfma_f32_16x16x32_bf16 v[8:11], v[116:119], v[28:31], v[8:11]
v_and_b32_dpp v28, v23, v2 row_newbcast:12 row_mask:0xf bank_mask:0xf
v_and_b32_dpp v29, v23, v3 row_newbcast:12 row_mask:0xf bank_mask:0xf
v_and_b32_dpp v30, v23, v4 row_newbcast:12 row_mask:0xf bank_mask:0xf
v_and_b32_dpp v31, v23, v5 row_newbcast:12 row_mask:0xf bank_mask:0xf
v_mfma_f32_16x16x32_bf16 v[8:11], v[120:123], v[24:27], v[8:11]
s_nop 0
v_mfma_f32_16x16x32_bf16 v[8:11], v[124:127], v[28:31], v[8:11]
v_and_b32_dpp v24, v23, v2 row_newbcast:1 row_mask:0xf bank_mask:0xf
v_and_b32_dpp v25, v23, v3 row_newbcast:1 row_mask:0xf bank_mask:0xf
v_and_b32_dpp v26, v23, v4 row_newbcast:1 row_mask:0xf bank_mask:0xf
v_and_b32_dpp v27, v23, v5 row_newbcast:1 row_mask:0xf bank_mask:0xf
v_and_b32_dpp v28, v23, v2 row_newbcast:5 row_mask:0xf bank_mask:0xf
v_and_b32_dpp v29, v23, v3 row_newbcast:5 row_mask:0xf bank_mask:0xf
v_and_b32_dpp v30, v23, v4 row_newbcast:5 row_mask:0xf bank_mask:0xf
v_and_b32_dpp v31, v23, v5 row_newbcast:5 row_mask:0xf bank_mask:0xf
s_waitcnt vmcnt(16)
v_mfma_f32_16x16x32_bf16 v[8:11], v[128:131], v[24:27], v[8:11]
v_and_b32_dpp v24, v23, v2 row_newbcast:9 row_mask:0xf bank_mask:0xf
v_and_b32_dpp v25, v23, v3 row_newbcast:9 row_mask:0xf bank_mask:0xf
v_and_b32_dpp v26, v23, v4 row_newbcast:9 row_mask:0xf bank_mask:0xf
v_and_b32_dpp v27, v23, v5 row_newbcast:9 row_mask:0xf bank_mask:0xf
v_mfma_f32_16x16x32_bf16 v[8:11], v[132:135], v[28:31], v[8:11]
v_and_b32_dpp v28, v23, v2 row_newbcast:13 row_mask:0xf bank_mask:0xf
v_and_b32_dpp v29, v23, v3 row_newbcast:13 row_mask:0xf bank_mask:0xf
v_and_b32_dpp v30, v23, v4 row_newbcast:13 row_mask:0xf bank_mask:0xf
v_and_b32_dpp v31, v23, v5 row_newbcast:13 row_mask:0xf bank_mask:0xf
v_mfma_f32_16x16x32_bf16 v[8:11], v[136:139], v[24:27], v[8:11]
s_nop 0
v_mfma_f32_16x16x32_bf16 v[8:11], v[140:143], v[28:31], v[8:11]
v_and_b32_dpp v24, v23, v2 row_newbcast:2 row_mask:0xf bank_mask:0xf
v_and_b32_dpp v25, v23, v3 row_newbcast:2 row_mask:0xf bank_mask:0xf
v_and_b32_dpp v26, v23, v4 row_newbcast:2 row_mask:0xf bank_mask:0xf
v_and_b32_dpp v27, v23, v5 row_newbcast:2 row_mask:0xf bank_mask:0xf
v_and_b32_dpp v28, v23, v2 row_newbcast:6 row_mask:0xf bank_mask:0xf
v_and_b32_dpp v29, v23, v3 row_newbcast:6 row_mask:0xf bank_mask:0xf
v_and_b32_dpp v30, v23, v4 row_newbcast:6 row_mask:0xf bank_mask:0xf
v_and_b32_dpp v31, v23, v5 row_newbcast:6 row_mask:0xf bank_mask:0xf
v_mfma_f32_16x16x32_bf16 v[8:11], v[144:147], v[24:27], v[8:11]
v_and_b32_dpp v24, v23, v2 row_newbcast:10 row_mask:0xf bank_mask:0xf
v_and_b32_dpp v25, v23, v3 row_newbcast:10 row_mask:0xf bank_mask:0xf
v_and_b32_dpp v26, v23, v4 row_newbcast:10 row_mask:0xf bank_mask:0xf
v_and_b32_dpp v27, v23, v5 row_newbcast:10 row_mask:0xf bank_mask:0xf
v_mfma_f32_16x16x32_bf16 v[8:11], v[148:151], v[28:31], v[8:11]
v_and_b32_dpp v28, v23, v2 row_newbcast:14 row_mask:0xf bank_mask:0xf
v_and_b32_dpp v29, v23, v3 row_newbcast:14 row_mask:0xf bank_mask:0xf
v_and_b32_dpp v30, v23, v4 row_newbcast:14 row_mask:0xf bank_mask:0xf
v_and_b32_dpp v31, v23, v5 row_newbcast:14 row_mask:0xf bank_mask:0xf
v_mfma_f32_16x16x32_bf16 v[8:11], v[152:155], v[24:27], v[8:11]
s_nop 0
v_mfma_f32_16x16x32_bf16 v[8:11], v[156:159], v[28:31], v[8:11]
v_and_b32_dpp v24, v23, v2 row_newbcast:3 row_mask:0xf bank_mask:0xf
v_and_b32_dpp v25, v23, v3 row_newbcast:3 row_mask:0xf bank_mask:0xf
v_and_b32_dpp v26, v23, v4 row_newbcast:3 row_mask:0xf bank_mask:0xf
v_and_b32_dpp v27, v23, v5 row_newbcast:3 row_mask:0xf bank_mask:0xf
v_and_b32_dpp v28, v23, v2 row_newbcast:7 row_mask:0xf bank_mask:0xf
v_and_b32_dpp v29, v23, v3 row_newbcast:7 row_mask:0xf bank_mask:0xf
v_and_b32_dpp v30, v23, v4 row_newbcast:7 row_mask:0xf bank_mask:0xf
v_and_b32_dpp v31, v23, v5 row_newbcast:7 row_mask:0xf bank_mask:0xf
v_mfma_f32_16x16x32_bf16 v[8:11], v[160:163], v[24:27], v[8:11]
v_and_b32_dpp v24, v23, v2 row_newbcast:11 row_mask:0xf bank_mask:0xf
v_and_b32_dpp v25, v23, v3 row_newbcast:11 row_mask:0xf bank_mask:0xf
v_and_b32_dpp v26, v23, v4 row_newbcast:11 row_mask:0xf bank_mask:0xf
v_and_b32_dpp v27, v23, v5 row_newbcast:11 row_mask:0xf bank_mask:0xf
v_mfma_f32_16x16x32_bf16 v[8:11], v[164:167], v[28:31], v[8:11]
v_and_b32_dpp v28, v23, v2 row_newbcast:15 row_mask:0xf bank_mask:0xf
v_and_b32_dpp v29, v23, v3 row_newbcast:15 row_mask:0xf bank_mask:0xf
v_and_b32_dpp v30, v23, v4 row_newbcast:15 row_mask:0xf bank_mask:0xf
v_and_b32_dpp v31, v23, v5 row_newbcast:15 row_mask:0xf bank_mask:0xf
v_mfma_f32_16x16x32_bf16 v[8:11], v[168:171], v[24:27], v[8:11]
s_nop 0
v_mfma_f32_16x16x32_bf16 v[8:11], v[172:175], v[28:31], v[8:11]
s_waitcnt vmcnt(12)
v_lshlrev_b32 v22, 16, v15
s_waitcnt lgkmcnt(0)
s_cmp_lt_i32 s20, 2
s_cbranch_scc1 LV_37_SLOW
LV_37_OK:
v_mov_b32 v47, 1
s_mov_b64 exec, 1
buffer_atomic_add v47, v16, s[16:19], s76 offen sc0 sc1
s_mov_b64 exec, -1
s_add_u32 s75, s73, 1024
buffer_load_dword v46, v1, s[16:19], s75 offen sc1
s_lshl_b32 s57, s3, 6
v_add_u32 v18, s57, v0
v_lshlrev_b32 v18, 7, v18
v_add_u32 v18, 2097152, v18
buffer_load_dword v19, v18, s[16:19], 0 offen sc1
v_fmamk_f32 v23, v22, 0x3e0293ee, v6
v_cmp_lt_f32 vcc, 0, v23
s_cbranch_vccnz RS_38
RB_39:
v_exp_f32 v23, v23
s_nop 0
v_add_f32 v7, v7, v23
v_cvt_pk_bf16_f32 v23, v23, v23
s_nop 1
v_and_b32_dpp v24, v23, v2 row_newbcast:0 row_mask:0xf bank_mask:0xf
v_and_b32_dpp v25, v23, v3 row_newbcast:0 row_mask:0xf bank_mask:0xf
v_and_b32_dpp v26, v23, v4 row_newbcast:0 row_mask:0xf bank_mask:0xf
v_and_b32_dpp v27, v23, v5 row_newbcast:0 row_mask:0xf bank_mask:0xf
v_and_b32_dpp v28, v23, v2 row_newbcast:4 row_mask:0xf bank_mask:0xf
v_and_b32_dpp v29, v23, v3 row_newbcast:4 row_mask:0xf bank_mask:0xf
v_and_b32_dpp v30, v23, v4 row_newbcast:4 row_mask:0xf bank_mask:0xf
v_and_b32_dpp v31, v23, v5 row_newbcast:4 row_mask:0xf bank_mask:0xf
ds_write_b128 v44, a[0:3] offset:16384
ds_write_b128 v44, a[4:7] offset:17408
ds_write_b128 v44, a[8:11] offset:18432
ds_write_b128 v44, a[12:15] offset:19456
v_mfma_f32_16x16x32_bf16 v[8:11], a[0:3], v[24:27], v[8:11]
v_and_b32_dpp v24, v23, v2 row_newbcast:8 row_mask:0xf bank_mask:0xf
v_and_b32_dpp v25, v23, v3 row_newbcast:8 row_mask:0xf bank_mask:0xf
v_and_b32_dpp v26, v23, v4 row_newbcast:8 row_mask:0xf bank_mask:0xf
v_and_b32_dpp v27, v23, v5 row_newbcast:8 row_mask:0xf bank_mask:0xf
v_mfma_f32_16x16x32_bf16 v[8:11], a[4:7], v[28:31], v[8:11]
v_and_b32_dpp v28, v23, v2 row_newbcast:12 row_mask:0xf bank_mask:0xf
v_and_b32_dpp v29, v23, v3 row_newbcast:12 row_mask:0xf bank_mask:0xf
v_and_b32_dpp v30, v23, v4 row_newbcast:12 row_mask:0xf bank_mask:0xf
v_and_b32_dpp v31, v23, v5 row_newbcast:12 row_mask:0xf bank_mask:0xf
v_mfma_f32_16x16x32_bf16 v[8:11], a[8:11], v[24:27], v[8:11]
s_nop 0
v_mfma_f32_16x16x32_bf16 v[8:11], a[12:15], v[28:31], v[8:11]
s_waitcnt lgkmcnt(0)
s_add_u32 s57, s63, 1048576
buffer_load_dwordx4 a[0:3], v1, s[12:15], s57 offen offset:0
buffer_load_dwordx4 a[4:7], v1, s[12:15], s57 offen offset:1024
buffer_load_dwordx4 a[8:11], v1, s[12:15], s57 offen offset:2048
buffer_load_dwordx4 a[12:15], v1, s[12:15], s57 offen offset:3072
v_and_b32_dpp v24, v23, v2 row_newbcast:1 row_mask:0xf bank_mask:0xf
v_and_b32_dpp v25, v23, v3 row_newbcast:1 row_mask:0xf bank_mask:0xf
v_and_b32_dpp v26, v23, v4 row_newbcast:1 row_mask:0xf bank_mask:0xf
v_and_b32_dpp v27, v23, v5 row_newbcast:1 row_mask:0xf bank_mask:0xf
v_and_b32_dpp v28, v23, v2 row_newbcast:5 row_mask:0xf bank_mask:0xf
v_and_b32_dpp v29, v23, v3 row_newbcast:5 row_mask:0xf bank_mask:0xf
v_and_b32_dpp v30, v23, v4 row_newbcast:5 row_mask:0xf bank_mask:0xf
v_and_b32_dpp v31, v23, v5 row_newbcast:5 row_mask:0xf bank_mask:0xf
s_waitcnt vmcnt(15)
ds_write_b128 v44, a[16:19] offset:20480
ds_write_b128 v44, a[20:23] offset:21504
ds_write_b128 v44, a[24:27] offset:22528
ds_write_b128 v44, a[28:31] offset:23552
v_mfma_f32_16x16x32_bf16 v[8:11], a[16:19], v[24:27], v[8:11]
v_and_b32_dpp v24, v23, v2 row_newbcast:9 row_mask:0xf bank_mask:0xf
v_and_b32_dpp v25, v23, v3 row_newbcast:9 row_mask:0xf bank_mask:0xf
v_and_b32_dpp v26, v23, v4 row_newbcast:9 row_mask:0xf bank_mask:0xf
v_and_b32_dpp v27, v23, v5 row_newbcast:9 row_mask:0xf bank_mask:0xf
v_mfma_f32_16x16x32_bf16 v[8:11], a[20:23], v[28:31], v[8:11]
v_and_b32_dpp v28, v23, v2 row_newbcast:13 row_mask:0xf bank_mask:0xf
v_and_b32_dpp v29, v23, v3 row_newbcast:13 row_mask:0xf bank_mask:0xf
v_and_b32_dpp v30, v23, v4 row_newbcast:13 row_mask:0xf bank_mask:0xf
v_and_b32_dpp v31, v23, v5 row_newbcast:13 row_mask:0xf bank_mask:0xf
v_mfma_f32_16x16x32_bf16 v[8:11], a[24:27], v[24:27], v[8:11]
s_nop 0
v_mfma_f32_16x16x32_bf16 v[8:11], a[28:31], v[28:31], v[8:11]
s_waitcnt lgkmcnt(0)
s_add_u32 s57, s63, 1081344
buffer_load_dwordx4 a[16:19], v1, s[12:15], s57 offen offset:0 nt
buffer_load_dwordx4 a[20:23], v1, s[12:15], s57 offen offset:1024 nt
buffer_load_dwordx4 a[24:27], v1, s[12:15], s57 offen offset:2048 nt
buffer_load_dwordx4 a[28:31], v1, s[12:15], s57 offen offset:3072 nt
v_and_b32_dpp v24, v23, v2 row_newbcast:2 row_mask:0xf bank_mask:0xf
v_and_b32_dpp v25, v23, v3 row_newbcast:2 row_mask:0xf bank_mask:0xf
v_and_b32_dpp v26, v23, v4 row_newbcast:2 row_mask:0xf bank_mask:0xf
v_and_b32_dpp v27, v23, v5 row_newbcast:2 row_mask:0xf bank_mask:0xf
v_and_b32_dpp v28, v23, v2 row_newbcast:6 row_mask:0xf bank_mask:0xf
v_and_b32_dpp v29, v23, v3 row_newbcast:6 row_mask:0xf bank_mask:0xf
v_and_b32_dpp v30, v23, v4 row_newbcast:6 row_mask:0xf bank_mask:0xf
v_and_b32_dpp v31, v23, v5 row_newbcast:6 row_mask:0xf bank_mask:0xf
s_waitcnt vmcnt(15)
ds_write_b128 v44, a[32:35] offset:24576
ds_write_b128 v44, a[36:39] offset:25600
ds_write_b128 v44, a[40:43] offset:26624
ds_write_b128 v44, a[44:47] offset:27648
v_mfma_f32_16x16x32_bf16 v[8:11], a[32:35], v[24:27], v[8:11]
v_and_b32_dpp v24, v23, v2 row_newbcast:10 row_mask:0xf bank_mask:0xf
v_and_b32_dpp v25, v23, v3 row_newbcast:10 row_mask:0xf bank_mask:0xf
v_and_b32_dpp v26, v23, v4 row_newbcast:10 row_mask:0xf bank_mask:0xf
v_and_b32_dpp v27, v23, v5 row_newbcast:10 row_mask:0xf bank_mask:0xf
v_mfma_f32_16x16x32_bf16 v[8:11], a[36:39], v[28:31], v[8:11]
v_and_b32_dpp v28, v23, v2 row_newbcast:14 row_mask:0xf bank_mask:0xf
v_and_b32_dpp v29, v23, v3 row_newbcast:14 row_mask:0xf bank_mask:0xf
v_and_b32_dpp v30, v23, v4 row_newbcast:14 row_mask:0xf bank_mask:0xf
v_and_b32_dpp v31, v23, v5 row_newbcast:14 row_mask:0xf bank_mask:0xf
v_mfma_f32_16x16x32_bf16 v[8:11], a[40:43], v[24:27], v[8:11]
s_nop 0
v_mfma_f32_16x16x32_bf16 v[8:11], a[44:47], v[28:31], v[8:11]
s_waitcnt lgkmcnt(0)
s_add_u32 s57, s63, 1114112
buffer_load_dwordx4 a[32:35], v1, s[12:15], s57 offen offset:0
buffer_load_dwordx4 a[36:39], v1, s[12:15], s57 offen offset:1024
buffer_load_dwordx4 a[40:43], v1, s[12:15], s57 offen offset:2048
buffer_load_dwordx4 a[44:47], v1, s[12:15], s57 offen offset:3072
v_and_b32_dpp v24, v23, v2 row_newbcast:3 row_mask:0xf bank_mask:0xf
v_and_b32_dpp v25, v23, v3 row_newbcast:3 row_mask:0xf bank_mask:0xf
v_and_b32_dpp v26, v23, v4 row_newbcast:3 row_mask:0xf bank_mask:0xf
v_and_b32_dpp v27, v23, v5 row_newbcast:3 row_mask:0xf bank_mask:0xf
v_and_b32_dpp v28, v23, v2 row_newbcast:7 row_mask:0xf bank_mask:0xf
v_and_b32_dpp v29, v23, v3 row_newbcast:7 row_mask:0xf bank_mask:0xf
v_and_b32_dpp v30, v23, v4 row_newbcast:7 row_mask:0xf bank_mask:0xf
v_and_b32_dpp v31, v23, v5 row_newbcast:7 row_mask:0xf bank_mask:0xf
s_waitcnt vmcnt(15)
ds_write_b128 v44, a[48:51] offset:28672
ds_write_b128 v44, a[52:55] offset:29696
ds_write_b128 v44, a[56:59] offset:30720
ds_write_b128 v44, a[60:63] offset:31744
v_mfma_f32_16x16x32_bf16 v[8:11], a[48:51], v[24:27], v[8:11]
v_and_b32_dpp v24, v23, v2 row_newbcast:11 row_mask:0xf bank_mask:0xf
v_and_b32_dpp v25, v23, v3 row_newbcast:11 row_mask:0xf bank_mask:0xf
v_and_b32_dpp v26, v23, v4 row_newbcast:11 row_mask:0xf bank_mask:0xf
v_and_b32_dpp v27, v23, v5 row_newbcast:11 row_mask:0xf bank_mask:0xf
v_mfma_f32_16x16x32_bf16 v[8:11], a[52:55], v[28:31], v[8:11]
v_and_b32_dpp v28, v23, v2 row_newbcast:15 row_mask:0xf bank_mask:0xf
v_and_b32_dpp v29, v23, v3 row_newbcast:15 row_mask:0xf bank_mask:0xf
v_and_b32_dpp v30, v23, v4 row_newbcast:15 row_mask:0xf bank_mask:0xf
v_and_b32_dpp v31, v23, v5 row_newbcast:15 row_mask:0xf bank_mask:0xf
v_mfma_f32_16x16x32_bf16 v[8:11], a[56:59], v[24:27], v[8:11]
s_nop 0
v_mfma_f32_16x16x32_bf16 v[8:11], a[60:63], v[28:31], v[8:11]
s_waitcnt lgkmcnt(0)
s_add_u32 s57, s63, 1146880
buffer_load_dwordx4 a[48:51], v1, s[12:15], s57 offen offset:0 nt
buffer_load_dwordx4 a[52:55], v1, s[12:15], s57 offen offset:1024 nt
buffer_load_dwordx4 a[56:59], v1, s[12:15], s57 offen offset:2048 nt
buffer_load_dwordx4 a[60:63], v1, s[12:15], s57 offen offset:3072 nt
s_mov_b32 s78, 16
s_add_u32 s56, s63, 1179648
s_mov_b32 s55, 4
LOOP_44:
s_waitcnt vmcnt(16)
v_lshlrev_b32 v22, s78, v46
v_and_b32 v22, 0xffff0000, v22
s_xor_b32 s78, s78, 16
s_lshr_b32 s57, s78, 2
s_add_u32 s75, s75, s57
buffer_load_dword v46, v1, s[16:19], s75 offen sc1
v_fmamk_f32 v23, v22, 0x3e0293ee, v6
v_cmp_lt_f32 vcc, 0, v23
s_cbranch_vccnz RS_45
RB_46:
v_exp_f32 v23, v23
s_nop 0
v_add_f32 v7, v7, v23
v_cvt_pk_bf16_f32 v23, v23, v23
s_nop 1
v_and_b32_dpp v24, v23, v2 row_newbcast:0 row_mask:0xf bank_mask:0xf
v_and_b32_dpp v25, v23, v3 row_newbcast:0 row_mask:0xf bank_mask:0xf
v_and_b32_dpp v26, v23, v4 row_newbcast:0 row_mask:0xf bank_mask:0xf
v_and_b32_dpp v27, v23, v5 row_newbcast:0 row_mask:0xf bank_mask:0xf
v_and_b32_dpp v28, v23, v2 row_newbcast:4 row_mask:0xf bank_mask:0xf
v_and_b32_dpp v29, v23, v3 row_newbcast:4 row_mask:0xf bank_mask:0xf
v_and_b32_dpp v30, v23, v4 row_newbcast:4 row_mask:0xf bank_mask:0xf
v_and_b32_dpp v31, v23, v5 row_newbcast:4 row_mask:0xf bank_mask:0xf
s_waitcnt vmcnt(13)
v_mfma_f32_16x16x32_bf16 v[8:11], a[0:3], v[24:27], v[8:11]
v_and_b32_dpp v24, v23, v2 row_newbcast:8 row_mask:0xf bank_mask:0xf
v_and_b32_dpp v25, v23, v3 row_newbcast:8 row_mask:0xf bank_mask:0xf
v_and_b32_dpp v26, v23, v4 row_newbcast:8 row_mask:0xf bank_mask:0xf
v_and_b32_dpp v27, v23, v5 row_newbcast:8 row_mask:0xf bank_mask:0xf
v_mfma_f32_16x16x32_bf16 v[8:11], a[4:7], v[28:31], v[8:11]
v_and_b32_dpp v28, v23, v2 row_newbcast:12 row_mask:0xf bank_mask:0xf
v_and_b32_dpp v29, v23, v3 row_newbcast:12 row_mask:0xf bank_mask:0xf
v_and_b32_dpp v30, v23, v4 row_newbcast:12 row_mask:0xf bank_mask:0xf
v_and_b32_dpp v31, v23, v5 row_newbcast:12 row_mask:0xf bank_mask:0xf
v_mfma_f32_16x16x32_bf16 v[8:11], a[8:11], v[24:27], v[8:11]
s_nop 0
v_mfma_f32_16x16x32_bf16 v[8:11], a[12:15], v[28:31], v[8:11]
buffer_load_dwordx4 a[0:3], v1, s[12:15], s56 offen offset:0
buffer_load_dwordx4 a[4:7], v1, s[12:15], s56 offen offset:1024
buffer_load_dwordx4 a[8:11], v1, s[12:15], s56 offen offset:2048
buffer_load_dwordx4 a[12:15], v1, s[12:15], s56 offen offset:3072
s_add_u32 s56, s56, 32768
v_and_b32_dpp v24, v23, v2 row_newbcast:1 row_mask:0xf bank_mask:0xf
v_and_b32_dpp v25, v23, v3 row_newbcast:1 row_mask:0xf bank_mask:0xf
v_and_b32_dpp v26, v23, v4 row_newbcast:1 row_mask:0xf bank_mask:0xf
v_and_b32_dpp v27, v23, v5 row_newbcast:1 row_mask:0xf bank_mask:0xf
v_and_b32_dpp v28, v23, v2 row_newbcast:5 row_mask:0xf bank_mask:0xf
v_and_b32_dpp v29, v23, v3 row_newbcast:5 row_mask:0xf bank_mask:0xf
v_and_b32_dpp v30, v23, v4 row_newbcast:5 row_mask:0xf bank_mask:0xf
v_and_b32_dpp v31, v23, v5 row_newbcast:5 row_mask:0xf bank_mask:0xf
s_waitcnt vmcnt(13)
v_mfma_f32_16x16x32_bf16 v[8:11], a[16:19], v[24:27], v[8:11]
v_and_b32_dpp v24, v23, v2 row_newbcast:9 row_mask:0xf bank_mask:0xf
v_and_b32_dpp v25, v23, v3 row_newbcast:9 row_mask:0xf bank_mask:0xf
v_and_b32_dpp v26, v23, v4 row_newbcast:9 row_mask:0xf bank_mask:0xf
v_and_b32_dpp v27, v23, v5 row_newbcast:9 row_mask:0xf bank_mask:0xf
v_mfma_f32_16x16x32_bf16 v[8:11], a[20:23], v[28:31], v[8:11]
v_and_b32_dpp v28, v23, v2 row_newbcast:13 row_mask:0xf bank_mask:0xf
v_and_b32_dpp v29, v23, v3 row_newbcast:13 row_mask:0xf bank_mask:0xf
v_and_b32_dpp v30, v23, v4 row_newbcast:13 row_mask:0xf bank_mask:0xf
v_and_b32_dpp v31, v23, v5 row_newbcast:13 row_mask:0xf bank_mask:0xf
v_mfma_f32_16x16x32_bf16 v[8:11], a[24:27], v[24:27], v[8:11]
s_nop 0
v_mfma_f32_16x16x32_bf16 v[8:11], a[28:31], v[28:31], v[8:11]
buffer_load_dwordx4 a[16:19], v1, s[12:15], s56 offen offset:0 nt
buffer_load_dwordx4 a[20:23], v1, s[12:15], s56 offen offset:1024 nt
buffer_load_dwordx4 a[24:27], v1, s[12:15], s56 offen offset:2048 nt
buffer_load_dwordx4 a[28:31], v1, s[12:15], s56 offen offset:3072 nt
s_add_u32 s56, s56, 32768
v_and_b32_dpp v24, v23, v2 row_newbcast:2 row_mask:0xf bank_mask:0xf
v_and_b32_dpp v25, v23, v3 row_newbcast:2 row_mask:0xf bank_mask:0xf
v_and_b32_dpp v26, v23, v4 row_newbcast:2 row_mask:0xf bank_mask:0xf
v_and_b32_dpp v27, v23, v5 row_newbcast:2 row_mask:0xf bank_mask:0xf
v_and_b32_dpp v28, v23, v2 row_newbcast:6 row_mask:0xf bank_mask:0xf
v_and_b32_dpp v29, v23, v3 row_newbcast:6 row_mask:0xf bank_mask:0xf
v_and_b32_dpp v30, v23, v4 row_newbcast:6 row_mask:0xf bank_mask:0xf
v_and_b32_dpp v31, v23, v5 row_newbcast:6 row_mask:0xf bank_mask:0xf
s_waitcnt vmcnt(13)
v_mfma_f32_16x16x32_bf16 v[8:11], a[32:35], v[24:27], v[8:11]
v_and_b32_dpp v24, v23, v2 row_newbcast:10 row_mask:0xf bank_mask:0xf
v_and_b32_dpp v25, v23, v3 row_newbcast:10 row_mask:0xf bank_mask:0xf
v_and_b32_dpp v26, v23, v4 row_newbcast:10 row_mask:0xf bank_mask:0xf
v_and_b32_dpp v27, v23, v5 row_newbcast:10 row_mask:0xf bank_mask:0xf
v_mfma_f32_16x16x32_bf16 v[8:11], a[36:39], v[28:31], v[8:11]
v_and_b32_dpp v28, v23, v2 row_newbcast:14 row_mask:0xf bank_mask:0xf
v_and_b32_dpp v29, v23, v3 row_newbcast:14 row_mask:0xf bank_mask:0xf
v_and_b32_dpp v30, v23, v4 row_newbcast:14 row_mask:0xf bank_mask:0xf
v_and_b32_dpp v31, v23, v5 row_newbcast:14 row_mask:0xf bank_mask:0xf
v_mfma_f32_16x16x32_bf16 v[8:11], a[40:43], v[24:27], v[8:11]
s_nop 0
v_mfma_f32_16x16x32_bf16 v[8:11], a[44:47], v[28:31], v[8:11]
buffer_load_dwordx4 a[32:35], v1, s[12:15], s56 offen offset:0
buffer_load_dwordx4 a[36:39], v1, s[12:15], s56 offen offset:1024
buffer_load_dwordx4 a[40:43], v1, s[12:15], s56 offen offset:2048
buffer_load_dwordx4 a[44:47], v1, s[12:15], s56 offen offset:3072
s_add_u32 s56, s56, 32768
v_and_b32_dpp v24, v23, v2 row_newbcast:3 row_mask:0xf bank_mask:0xf
v_and_b32_dpp v25, v23, v3 row_newbcast:3 row_mask:0xf bank_mask:0xf
v_and_b32_dpp v26, v23, v4 row_newbcast:3 row_mask:0xf bank_mask:0xf
v_and_b32_dpp v27, v23, v5 row_newbcast:3 row_mask:0xf bank_mask:0xf
v_and_b32_dpp v28, v23, v2 row_newbcast:7 row_mask:0xf bank_mask:0xf
v_and_b32_dpp v29, v23, v3 row_newbcast:7 row_mask:0xf bank_mask:0xf
v_and_b32_dpp v30, v23, v4 row_newbcast:7 row_mask:0xf bank_mask:0xf
v_and_b32_dpp v31, v23, v5 row_newbcast:7 row_mask:0xf bank_mask:0xf
s_waitcnt vmcnt(13)
v_mfma_f32_16x16x32_bf16 v[8:11], a[48:51], v[24:27], v[8:11]
v_and_b32_dpp v24, v23, v2 row_newbcast:11 row_mask:0xf bank_mask:0xf
v_and_b32_dpp v25, v23, v3 row_newbcast:11 row_mask:0xf bank_mask:0xf
v_and_b32_dpp v26, v23, v4 row_newbcast:11 row_mask:0xf bank_mask:0xf
v_and_b32_dpp v27, v23, v5 row_newbcast:11 row_mask:0xf bank_mask:0xf
v_mfma_f32_16x16x32_bf16 v[8:11], a[52:55], v[28:31], v[8:11]
v_and_b32_dpp v28, v23, v2 row_newbcast:15 row_mask:0xf bank_mask:0xf
v_and_b32_dpp v29, v23, v3 row_newbcast:15 row_mask:0xf bank_mask:0xf
v_and_b32_dpp v30, v23, v4 row_newbcast:15 row_mask:0xf bank_mask:0xf
v_and_b32_dpp v31, v23, v5 row_newbcast:15 row_mask:0xf bank_mask:0xf
v_mfma_f32_16x16x32_bf16 v[8:11], a[56:59], v[24:27], v[8:11]
s_nop 0
v_mfma_f32_16x16x32_bf16 v[8:11], a[60:63], v[28:31], v[8:11]
buffer_load_dwordx4 a[48:51], v1, s[12:15], s56 offen offset:0 nt
buffer_load_dwordx4 a[52:55], v1, s[12:15], s56 offen offset:1024 nt
buffer_load_dwordx4 a[56:59], v1, s[12:15], s56 offen offset:2048 nt
buffer_load_dwordx4 a[60:63], v1, s[12:15], s56 offen offset:3072 nt
s_add_u32 s56, s56, 32768
s_sub_u32 s55, s55, 1
s_cmp_lg_u32 s55, 0
s_cbranch_scc1 LOOP_44
s_and_b32 s57, s2, 0xf8
s_lshl_b32 s57, s57, 7
s_add_u32 s57, s57, 2097152
s_add_u32 s0, s46, s57
s_addc_u32 s1, s47, 0
s_load_dword s20, s[0:1], 0 glc
s_load_dword s21, s[0:1], 128 glc
s_load_dword s22, s[0:1], 256 glc
s_load_dword s23, s[0:1], 384 glc
s_load_dword s34, s[0:1], 512 glc
s_load_dword s35, s[0:1], 640 glc
s_load_dword s72, s[0:1], 768 glc
s_load_dword s74, s[0:1], 896 glc
v_cmp_eq_u32 vcc, -1, v19
s_cbranch_vccnz ALL2_SLOW
ALL2_OK:
s_waitcnt lgkmcnt(0)
s_min_i32 s20, s20, s21
s_min_i32 s20, s20, s22
s_min_i32 s20, s20, s23
s_min_i32 s20, s20, s34
s_min_i32 s20, s20, s35
s_min_i32 s20, s20, s72
s_min_i32 s20, s20, s74
s_cmp_lt_i32 s20, 2
s_cbranch_scc1 LV_47_SLOW
LV_47_OK:
POOL_48:
s_waitcnt vmcnt(16)
v_readfirstlane_b32 s79, v47
s_nop 0
s_cmp_ge_u32 s79, 48
s_cbranch_scc1 POOLEND_49
v_lshlrev_b32 v22, s78, v46
v_and_b32 v22, 0xffff0000, v22
v_mov_b32 v47, 1
s_mov_b64 exec, 1
buffer_atomic_add v47, v16, s[16:19], s76 offen sc0 sc1
s_mov_b64 exec, -1
s_bfe_u32 s58, s79, 0x20002
s_and_b32 s59, s79, 3
s_lshl_b32 s56, s58, 21
s_xor_b32 s60, s58, s52
s_and_b32 s60, s60, 1
s_lshl_b32 s60, s60, 13
s_add_u32 s56, s56, s60
s_lshr_b32 s60, s59, 1
s_lshl_b32 s60, s60, 14
s_add_u32 s56, s56, s60
s_and_b32 s60, s59, 1
s_lshl_b32 s60, s60, 12
s_add_u32 s56, s56, s60
s_lshl_b32 s75, s58, 2
s_add_u32 s75, s75, s59
s_lshl_b32 s75, s75, 1
s_bfe_u32 s60, s56, 0x1000d
s_add_u32 s75, s75, s60
s_lshl_b32 s60, s48, 5
s_add_u32 s75, s75, s60
s_lshl_b32 s75, s75, 11
s_add_u32 s75, s75, 4194304
s_lshr_b32 s57, s79, 4
s_add_u32 s57, s57, 13
s_lshr_b32 s58, s57, 1
s_lshl_b32 s58, s58, 2
s_add_u32 s75, s75, s58
s_add_u32 s75, s75, 1008
s_andn2_b32 s78, 1, s57
s_lshl_b32 s78, s78, 4
s_lshl_b32 s57, s57, 17
s_add_u32 s56, s56, s57
buffer_load_dword v46, v1, s[16:19], s75 offen sc1
v_fmamk_f32 v23, v22, 0x3e0293ee, v6
v_cmp_lt_f32 vcc, 0, v23
s_cbranch_vccnz RS_50
RB_51:
v_exp_f32 v23, v23
s_nop 0
v_add_f32 v7, v7, v23
v_cvt_pk_bf16_f32 v23, v23, v23
s_nop 1
v_and_b32_dpp v24, v23, v2 row_newbcast:0 row_mask:0xf bank_mask:0xf
v_and_b32_dpp v25, v23, v3 row_newbcast:0 row_mask:0xf bank_mask:0xf
v_and_b32_dpp v26, v23, v4 row_newbcast:0 row_mask:0xf bank_mask:0xf
v_and_b32_dpp v27, v23, v5 row_newbcast:0 row_mask:0xf bank_mask:0xf
v_and_b32_dpp v28, v23, v2 row_newbcast:4 row_mask:0xf bank_mask:0xf
v_and_b32_dpp v29, v23, v3 row_newbcast:4 row_mask:0xf bank_mask:0xf
v_and_b32_dpp v30, v23, v4 row_newbcast:4 row_mask:0xf bank_mask:0xf
v_and_b32_dpp v31, v23, v5 row_newbcast:4 row_mask:0xf bank_mask:0xf
s_waitcnt vmcnt(14)
v_mfma_f32_16x16x32_bf16 v[8:11], a[0:3], v[24:27], v[8:11]
v_and_b32_dpp v24, v23, v2 row_newbcast:8 row_mask:0xf bank_mask:0xf
v_and_b32_dpp v25, v23, v3 row_newbcast:8 row_mask:0xf bank_mask:0xf
v_and_b32_dpp v26, v23, v4 row_newbcast:8 row_mask:0xf bank_mask:0xf
v_and_b32_dpp v27, v23, v5 row_newbcast:8 row_mask:0xf bank_mask:0xf
v_mfma_f32_16x16x32_bf16 v[8:11], a[4:7], v[28:31], v[8:11]
v_and_b32_dpp v28, v23, v2 row_newbcast:12 row_mask:0xf bank_mask:0xf
v_and_b32_dpp v29, v23, v3 row_newbcast:12 row_mask:0xf bank_mask:0xf
v_and_b32_dpp v30, v23, v4 row_newbcast:12 row_mask:0xf bank_mask:0xf
v_and_b32_dpp v31, v23, v5 row_newbcast:12 row_mask:0xf bank_mask:0xf
v_mfma_f32_16x16x32_bf16 v[8:11], a[8:11], v[24:27], v[8:11]
s_nop 0
v_mfma_f32_16x16x32_bf16 v[8:11], a[12:15], v[28:31], v[8:11]
buffer_load_dwordx4 a[0:3], v1, s[12:15], s56 offen offset:0
buffer_load_dwordx4 a[4:7], v1, s[12:15], s56 offen offset:1024
buffer_load_dwordx4 a[8:11], v1, s[12:15], s56 offen offset:2048
buffer_load_dwordx4 a[12:15], v1, s[12:15], s56 offen offset:3072
s_add_u32 s56, s56, 32768
v_and_b32_dpp v24, v23, v2 row_newbcast:1 row_mask:0xf bank_mask:0xf
v_and_b32_dpp v25, v23, v3 row_newbcast:1 row_mask:0xf bank_mask:0xf
v_and_b32_dpp v26, v23, v4 row_newbcast:1 row_mask:0xf bank_mask:0xf
v_and_b32_dpp v27, v23, v5 row_newbcast:1 row_mask:0xf bank_mask:0xf
v_and_b32_dpp v28, v23, v2 row_newbcast:5 row_mask:0xf bank_mask:0xf
v_and_b32_dpp v29, v23, v3 row_newbcast:5 row_mask:0xf bank_mask:0xf
v_and_b32_dpp v30, v23, v4 row_newbcast:5 row_mask:0xf bank_mask:0xf
v_and_b32_dpp v31, v23, v5 row_newbcast:5 row_mask:0xf bank_mask:0xf
s_waitcnt vmcnt(14)
v_mfma_f32_16x16x32_bf16 v[8:11], a[16:19], v[24:27], v[8:11]
v_and_b32_dpp v24, v23, v2 row_newbcast:9 row_mask:0xf bank_mask:0xf
v_and_b32_dpp v25, v23, v3 row_newbcast:9 row_mask:0xf bank_mask:0xf
v_and_b32_dpp v26, v23, v4 row_newbcast:9 row_mask:0xf bank_mask:0xf
v_and_b32_dpp v27, v23, v5 row_newbcast:9 row_mask:0xf bank_mask:0xf
v_mfma_f32_16x16x32_bf16 v[8:11], a[20:23], v[28:31], v[8:11]
v_and_b32_dpp v28, v23, v2 row_newbcast:13 row_mask:0xf bank_mask:0xf
v_and_b32_dpp v29, v23, v3 row_newbcast:13 row_mask:0xf bank_mask:0xf
v_and_b32_dpp v30, v23, v4 row_newbcast:13 row_mask:0xf bank_mask:0xf
v_and_b32_dpp v31, v23, v5 row_newbcast:13 row_mask:0xf bank_mask:0xf
v_mfma_f32_16x16x32_bf16 v[8:11], a[24:27], v[24:27], v[8:11]
s_nop 0
v_mfma_f32_16x16x32_bf16 v[8:11], a[28:31], v[28:31], v[8:11]
buffer_load_dwordx4 a[16:19], v1, s[12:15], s56 offen offset:0 nt
buffer_load_dwordx4 a[20:23], v1, s[12:15], s56 offen offset:1024 nt
buffer_load_dwordx4 a[24:27], v1, s[12:15], s56 offen offset:2048 nt
buffer_load_dwordx4 a[28:31], v1, s[12:15], s56 offen offset:3072 nt
s_add_u32 s56, s56, 32768
v_and_b32_dpp v24, v23, v2 row_newbcast:2 row_mask:0xf bank_mask:0xf
v_and_b32_dpp v25, v23, v3 row_newbcast:2 row_mask:0xf bank_mask:0xf
v_and_b32_dpp v26, v23, v4 row_newbcast:2 row_mask:0xf bank_mask:0xf
v_and_b32_dpp v27, v23, v5 row_newbcast:2 row_mask:0xf bank_mask:0xf
v_and_b32_dpp v28, v23, v2 row_newbcast:6 row_mask:0xf bank_mask:0xf
v_and_b32_dpp v29, v23, v3 row_newbcast:6 row_mask:0xf bank_mask:0xf
v_and_b32_dpp v30, v23, v4 row_newbcast:6 row_mask:0xf bank_mask:0xf
v_and_b32_dpp v31, v23, v5 row_newbcast:6 row_mask:0xf bank_mask:0xf
s_waitcnt vmcnt(14)
v_mfma_f32_16x16x32_bf16 v[8:11], a[32:35], v[24:27], v[8:11]
v_and_b32_dpp v24, v23, v2 row_newbcast:10 row_mask:0xf bank_mask:0xf
v_and_b32_dpp v25, v23, v3 row_newbcast:10 row_mask:0xf bank_mask:0xf
v_and_b32_dpp v26, v23, v4 row_newbcast:10 row_mask:0xf bank_mask:0xf
v_and_b32_dpp v27, v23, v5 row_newbcast:10 row_mask:0xf bank_mask:0xf
v_mfma_f32_16x16x32_bf16 v[8:11], a[36:39], v[28:31], v[8:11]
v_and_b32_dpp v28, v23, v2 row_newbcast:14 row_mask:0xf bank_mask:0xf
v_and_b32_dpp v29, v23, v3 row_newbcast:14 row_mask:0xf bank_mask:0xf
v_and_b32_dpp v30, v23, v4 row_newbcast:14 row_mask:0xf bank_mask:0xf
v_and_b32_dpp v31, v23, v5 row_newbcast:14 row_mask:0xf bank_mask:0xf
v_mfma_f32_16x16x32_bf16 v[8:11], a[40:43], v[24:27], v[8:11]
s_nop 0
v_mfma_f32_16x16x32_bf16 v[8:11], a[44:47], v[28:31], v[8:11]
buffer_load_dwordx4 a[32:35], v1, s[12:15], s56 offen offset:0
buffer_load_dwordx4 a[36:39], v1, s[12:15], s56 offen offset:1024
buffer_load_dwordx4 a[40:43], v1, s[12:15], s56 offen offset:2048
buffer_load_dwordx4 a[44:47], v1, s[12:15], s56 offen offset:3072
s_add_u32 s56, s56, 32768
v_and_b32_dpp v24, v23, v2 row_newbcast:3 row_mask:0xf bank_mask:0xf
v_and_b32_dpp v25, v23, v3 row_newbcast:3 row_mask:0xf bank_mask:0xf
v_and_b32_dpp v26, v23, v4 row_newbcast:3 row_mask:0xf bank_mask:0xf
v_and_b32_dpp v27, v23, v5 row_newbcast:3 row_mask:0xf bank_mask:0xf
v_and_b32_dpp v28, v23, v2 row_newbcast:7 row_mask:0xf bank_mask:0xf
v_and_b32_dpp v29, v23, v3 row_newbcast:7 row_mask:0xf bank_mask:0xf
v_and_b32_dpp v30, v23, v4 row_newbcast:7 row_mask:0xf bank_mask:0xf
v_and_b32_dpp v31, v23, v5 row_newbcast:7 row_mask:0xf bank_mask:0xf
s_waitcnt vmcnt(14)
v_mfma_f32_16x16x32_bf16 v[8:11], a[48:51], v[24:27], v[8:11]
v_and_b32_dpp v24, v23, v2 row_newbcast:11 row_mask:0xf bank_mask:0xf
v_and_b32_dpp v25, v23, v3 row_newbcast:11 row_mask:0xf bank_mask:0xf
v_and_b32_dpp v26, v23, v4 row_newbcast:11 row_mask:0xf bank_mask:0xf
v_and_b32_dpp v27, v23, v5 row_newbcast:11 row_mask:0xf bank_mask:0xf
v_mfma_f32_16x16x32_bf16 v[8:11], a[52:55], v[28:31], v[8:11]
v_and_b32_dpp v28, v23, v2 row_newbcast:15 row_mask:0xf bank_mask:0xf
v_and_b32_dpp v29, v23, v3 row_newbcast:15 row_mask:0xf bank_mask:0xf
v_and_b32_dpp v30, v23, v4 row_newbcast:15 row_mask:0xf bank_mask:0xf
v_and_b32_dpp v31, v23, v5 row_newbcast:15 row_mask:0xf bank_mask:0xf
v_mfma_f32_16x16x32_bf16 v[8:11], a[56:59], v[24:27], v[8:11]
s_nop 0
v_mfma_f32_16x16x32_bf16 v[8:11], a[60:63], v[28:31], v[8:11]
buffer_load_dwordx4 a[48:51], v1, s[12:15], s56 offen offset:0 nt
buffer_load_dwordx4 a[52:55], v1, s[12:15], s56 offen offset:1024 nt
buffer_load_dwordx4 a[56:59], v1, s[12:15], s56 offen offset:2048 nt
buffer_load_dwordx4 a[60:63], v1, s[12:15], s56 offen offset:3072 nt
s_add_u32 s56, s56, 32768
s_branch POOL_48
POOLEND_49:
s_cmp_lg_u32 s3, 1
s_cbranch_scc1 SK_52
s_getpc_b64 s[58:59]
PC_53:
s_add_u32 s58, s58, CHAIN-PC_53
s_addc_u32 s59, s59, 0
s_lshl_b32 s57, s48, 4
v_add_u32 v18, s57, v0
v_lshlrev_b32 v18, 7, v18
v_min_u32 v18, CODE_END-CHAIN-4, v18
s_mov_b64 exec, 0xffff
global_load_dword v47, v18, s[58:59]
s_mov_b64 exec, -1
SK_52:
v_lshlrev_b32 v22, s78, v46
v_and_b32 v22, 0xffff0000, v22
v_fmamk_f32 v23, v22, 0x3e0293ee, v6
v_cmp_lt_f32 vcc, 0, v23
s_cbranch_vccnz RS_54
RB_55:
v_exp_f32 v23, v23
s_nop 0
v_add_f32 v7, v7, v23
v_cvt_pk_bf16_f32 v23, v23, v23
s_nop 1
v_and_b32_dpp v24, v23, v2 row_newbcast:0 row_mask:0xf bank_mask:0xf
v_and_b32_dpp v25, v23, v3 row_newbcast:0 row_mask:0xf bank_mask:0xf
v_and_b32_dpp v26, v23, v4 row_newbcast:0 row_mask:0xf bank_mask:0xf
v_and_b32_dpp v27, v23, v5 row_newbcast:0 row_mask:0xf bank_mask:0xf
v_and_b32_dpp v28, v23, v2 row_newbcast:4 row_mask:0xf bank_mask:0xf
v_and_b32_dpp v29, v23, v3 row_newbcast:4 row_mask:0xf bank_mask:0xf
v_and_b32_dpp v30, v23, v4 row_newbcast:4 row_mask:0xf bank_mask:0xf
v_and_b32_dpp v31, v23, v5 row_newbcast:4 row_mask:0xf bank_mask:0xf
s_waitcnt vmcnt(12)
v_mfma_f32_16x16x32_bf16 v[8:11], a[0:3], v[24:27], v[8:11]
v_and_b32_dpp v24, v23, v2 row_newbcast:8 row_mask:0xf bank_mask:0xf
v_and_b32_dpp v25, v23, v3 row_newbcast:8 row_mask:0xf bank_mask:0xf
v_and_b32_dpp v26, v23, v4 row_newbcast:8 row_mask:0xf bank_mask:0xf
v_and_b32_dpp v27, v23, v5 row_newbcast:8 row_mask:0xf bank_mask:0xf
v_mfma_f32_16x16x32_bf16 v[8:11], a[4:7], v[28:31], v[8:11]
v_and_b32_dpp v28, v23, v2 row_newbcast:12 row_mask:0xf bank_mask:0xf
v_and_b32_dpp v29, v23, v3 row_newbcast:12 row_mask:0xf bank_mask:0xf
v_and_b32_dpp v30, v23, v4 row_newbcast:12 row_mask:0xf bank_mask:0xf
v_and_b32_dpp v31, v23, v5 row_newbcast:12 row_mask:0xf bank_mask:0xf
v_mfma_f32_16x16x32_bf16 v[8:11], a[8:11], v[24:27], v[8:11]
s_nop 0
v_mfma_f32_16x16x32_bf16 v[8:11], a[12:15], v[28:31], v[8:11]
s_add_u32 s57, s63, 917504
buffer_load_dwordx4 a[0:3], v1, s[12:15], s57 offen offset:0 nt
buffer_load_dwordx4 a[4:7], v1, s[12:15], s57 offen offset:1024 nt
buffer_load_dwordx4 a[8:11], v1, s[12:15], s57 offen offset:2048 nt
buffer_load_dwordx4 a[12:15], v1, s[12:15], s57 offen offset:3072 nt
v_and_b32_dpp v24, v23, v2 row_newbcast:1 row_mask:0xf bank_mask:0xf
v_and_b32_dpp v25, v23, v3 row_newbcast:1 row_mask:0xf bank_mask:0xf
v_and_b32_dpp v26, v23, v4 row_newbcast:1 row_mask:0xf bank_mask:0xf
v_and_b32_dpp v27, v23, v5 row_newbcast:1 row_mask:0xf bank_mask:0xf
v_and_b32_dpp v28, v23, v2 row_newbcast:5 row_mask:0xf bank_mask:0xf
v_and_b32_dpp v29, v23, v3 row_newbcast:5 row_mask:0xf bank_mask:0xf
v_and_b32_dpp v30, v23, v4 row_newbcast:5 row_mask:0xf bank_mask:0xf
v_and_b32_dpp v31, v23, v5 row_newbcast:5 row_mask:0xf bank_mask:0xf
s_waitcnt vmcnt(12)
v_mfma_f32_16x16x32_bf16 v[8:11], a[16:19], v[24:27], v[8:11]
v_and_b32_dpp v24, v23, v2 row_newbcast:9 row_mask:0xf bank_mask:0xf
v_and_b32_dpp v25, v23, v3 row_newbcast:9 row_mask:0xf bank_mask:0xf
v_and_b32_dpp v26, v23, v4 row_newbcast:9 row_mask:0xf bank_mask:0xf
v_and_b32_dpp v27, v23, v5 row_newbcast:9 row_mask:0xf bank_mask:0xf
v_mfma_f32_16x16x32_bf16 v[8:11], a[20:23], v[28:31], v[8:11]
v_and_b32_dpp v28, v23, v2 row_newbcast:13 row_mask:0xf bank_mask:0xf
v_and_b32_dpp v29, v23, v3 row_newbcast:13 row_mask:0xf bank_mask:0xf
v_and_b32_dpp v30, v23, v4 row_newbcast:13 row_mask:0xf bank_mask:0xf
v_and_b32_dpp v31, v23, v5 row_newbcast:13 row_mask:0xf bank_mask:0xf
v_mfma_f32_16x16x32_bf16 v[8:11], a[24:27], v[24:27], v[8:11]
s_nop 0
v_mfma_f32_16x16x32_bf16 v[8:11], a[28:31], v[28:31], v[8:11]
s_add_u32 s57, s63, 950272
buffer_load_dwordx4 a[16:19], v1, s[12:15], s57 offen offset:0 nt
buffer_load_dwordx4 a[20:23], v1, s[12:15], s57 offen offset:1024 nt
buffer_load_dwordx4 a[24:27], v1, s[12:15], s57 offen offset:2048 nt
buffer_load_dwordx4 a[28:31], v1, s[12:15], s57 offen offset:3072 nt
v_and_b32_dpp v24, v23, v2 row_newbcast:2 row_mask:0xf bank_mask:0xf
v_and_b32_dpp v25, v23, v3 row_newbcast:2 row_mask:0xf bank_mask:0xf
v_and_b32_dpp v26, v23, v4 row_newbcast:2 row_mask:0xf bank_mask:0xf
v_and_b32_dpp v27, v23, v5 row_newbcast:2 row_mask:0xf bank_mask:0xf
v_and_b32_dpp v28, v23, v2 row_newbcast:6 row_mask:0xf bank_mask:0xf
v_and_b32_dpp v29, v23, v3 row_newbcast:6 row_mask:0xf bank_mask:0xf
v_and_b32_dpp v30, v23, v4 row_newbcast:6 row_mask:0xf bank_mask:0xf
v_and_b32_dpp v31, v23, v5 row_newbcast:6 row_mask:0xf bank_mask:0xf
s_waitcnt vmcnt(12)
v_mfma_f32_16x16x32_bf16 v[8:11], a[32:35], v[24:27], v[8:11]
v_and_b32_dpp v24, v23, v2 row_newbcast:10 row_mask:0xf bank_mask:0xf
v_and_b32_dpp v25, v23, v3 row_newbcast:10 row_mask:0xf bank_mask:0xf
v_and_b32_dpp v26, v23, v4 row_newbcast:10 row_mask:0xf bank_mask:0xf
v_and_b32_dpp v27, v23, v5 row_newbcast:10 row_mask:0xf bank_mask:0xf
v_mfma_f32_16x16x32_bf16 v[8:11], a[36:39], v[28:31], v[8:11]
v_and_b32_dpp v28, v23, v2 row_newbcast:14 row_mask:0xf bank_mask:0xf
v_and_b32_dpp v29, v23, v3 row_newbcast:14 row_mask:0xf bank_mask:0xf
v_and_b32_dpp v30, v23, v4 row_newbcast:14 row_mask:0xf bank_mask:0xf
v_and_b32_dpp v31, v23, v5 row_newbcast:14 row_mask:0xf bank_mask:0xf
v_mfma_f32_16x16x32_bf16 v[8:11], a[40:43], v[24:27], v[8:11]
s_nop 0
v_mfma_f32_16x16x32_bf16 v[8:11], a[44:47], v[28:31], v[8:11]
s_add_u32 s57, s63, 983040
buffer_load_dwordx4 a[32:35], v1, s[12:15], s57 offen offset:0 nt
buffer_load_dwordx4 a[36:39], v1, s[12:15], s57 offen offset:1024 nt
buffer_load_dwordx4 a[40:43], v1, s[12:15], s57 offen offset:2048 nt
buffer_load_dwordx4 a[44:47], v1, s[12:15], s57 offen offset:3072 nt
v_and_b32_dpp v24, v23, v2 row_newbcast:3 row_mask:0xf bank_mask:0xf
v_and_b32_dpp v25, v23, v3 row_newbcast:3 row_mask:0xf bank_mask:0xf
v_and_b32_dpp v26, v23, v4 row_newbcast:3 row_mask:0xf bank_mask:0xf
v_and_b32_dpp v27, v23, v5 row_newbcast:3 row_mask:0xf bank_mask:0xf
v_and_b32_dpp v28, v23, v2 row_newbcast:7 row_mask:0xf bank_mask:0xf
v_and_b32_dpp v29, v23, v3 row_newbcast:7 row_mask:0xf bank_mask:0xf
v_and_b32_dpp v30, v23, v4 row_newbcast:7 row_mask:0xf bank_mask:0xf
v_and_b32_dpp v31, v23, v5 row_newbcast:7 row_mask:0xf bank_mask:0xf
s_waitcnt vmcnt(12)
v_mfma_f32_16x16x32_bf16 v[8:11], a[48:51], v[24:27], v[8:11]
v_and_b32_dpp v24, v23, v2 row_newbcast:11 row_mask:0xf bank_mask:0xf
v_and_b32_dpp v25, v23, v3 row_newbcast:11 row_mask:0xf bank_mask:0xf
v_and_b32_dpp v26, v23, v4 row_newbcast:11 row_mask:0xf bank_mask:0xf
v_and_b32_dpp v27, v23, v5 row_newbcast:11 row_mask:0xf bank_mask:0xf
v_mfma_f32_16x16x32_bf16 v[8:11], a[52:55], v[28:31], v[8:11]
v_and_b32_dpp v28, v23, v2 row_newbcast:15 row_mask:0xf bank_mask:0xf
v_and_b32_dpp v29, v23, v3 row_newbcast:15 row_mask:0xf bank_mask:0xf
v_and_b32_dpp v30, v23, v4 row_newbcast:15 row_mask:0xf bank_mask:0xf
v_and_b32_dpp v31, v23, v5 row_newbcast:15 row_mask:0xf bank_mask:0xf
v_mfma_f32_16x16x32_bf16 v[8:11], a[56:59], v[24:27], v[8:11]
s_nop 0
v_mfma_f32_16x16x32_bf16 v[8:11], a[60:63], v[28:31], v[8:11]
s_add_u32 s57, s63, 1015808
buffer_load_dwordx4 a[48:51], v1, s[12:15], s57 offen offset:0 nt
buffer_load_dwordx4 a[52:55], v1, s[12:15], s57 offen offset:1024 nt
buffer_load_dwordx4 a[56:59], v1, s[12:15], s57 offen offset:2048 nt
buffer_load_dwordx4 a[60:63], v1, s[12:15], s57 offen offset:3072 nt
v_and_b32 v22, 0xffff0000, v15
v_fmamk_f32 v23, v22, 0x3e0293ee, v6
v_cmp_lt_f32 vcc, 0, v23
s_cbranch_vccnz RS_56
RB_57:
v_exp_f32 v23, v23
s_nop 0
v_add_f32 v7, v7, v23
v_cvt_pk_bf16_f32 v23, v23, v23
s_nop 1
v_and_b32_dpp v24, v23, v2 row_newbcast:0 row_mask:0xf bank_mask:0xf
v_and_b32_dpp v25, v23, v3 row_newbcast:0 row_mask:0xf bank_mask:0xf
v_and_b32_dpp v26, v23, v4 row_newbcast:0 row_mask:0xf bank_mask:0xf
v_and_b32_dpp v27, v23, v5 row_newbcast:0 row_mask:0xf bank_mask:0xf
v_and_b32_dpp v28, v23, v2 row_newbcast:4 row_mask:0xf bank_mask:0xf
v_and_b32_dpp v29, v23, v3 row_newbcast:4 row_mask:0xf bank_mask:0xf
v_and_b32_dpp v30, v23, v4 row_newbcast:4 row_mask:0xf bank_mask:0xf
v_and_b32_dpp v31, v23, v5 row_newbcast:4 row_mask:0xf bank_mask:0xf
s_waitcnt vmcnt(12)
v_mfma_f32_16x16x32_bf16 v[8:11], a[0:3], v[24:27], v[8:11]
v_and_b32_dpp v24, v23, v2 row_newbcast:8 row_mask:0xf bank_mask:0xf
v_and_b32_dpp v25, v23, v3 row_newbcast:8 row_mask:0xf bank_mask:0xf
v_and_b32_dpp v26, v23, v4 row_newbcast:8 row_mask:0xf bank_mask:0xf
v_and_b32_dpp v27, v23, v5 row_newbcast:8 row_mask:0xf bank_mask:0xf
v_mfma_f32_16x16x32_bf16 v[8:11], a[4:7], v[28:31], v[8:11]
v_and_b32_dpp v28, v23, v2 row_newbcast:12 row_mask:0xf bank_mask:0xf
v_and_b32_dpp v29, v23, v3 row_newbcast:12 row_mask:0xf bank_mask:0xf
v_and_b32_dpp v30, v23, v4 row_newbcast:12 row_mask:0xf bank_mask:0xf
v_and_b32_dpp v31, v23, v5 row_newbcast:12 row_mask:0xf bank_mask:0xf
v_mfma_f32_16x16x32_bf16 v[8:11], a[8:11], v[24:27], v[8:11]
s_nop 0
v_mfma_f32_16x16x32_bf16 v[8:11], a[12:15], v[28:31], v[8:11]
v_and_b32_dpp v24, v23, v2 row_newbcast:1 row_mask:0xf bank_mask:0xf
v_and_b32_dpp v25, v23, v3 row_newbcast:1 row_mask:0xf bank_mask:0xf
v_and_b32_dpp v26, v23, v4 row_newbcast:1 row_mask:0xf bank_mask:0xf
v_and_b32_dpp v27, v23, v5 row_newbcast:1 row_mask:0xf bank_mask:0xf
v_and_b32_dpp v28, v23, v2 row_newbcast:5 row_mask:0xf bank_mask:0xf
v_and_b32_dpp v29, v23, v3 row_newbcast:5 row_mask:0xf bank_mask:0xf
v_and_b32_dpp v30, v23, v4 row_newbcast:5 row_mask:0xf bank_mask:0xf
v_and_b32_dpp v31, v23, v5 row_newbcast:5 row_mask:0xf bank_mask:0xf
s_waitcnt vmcnt(8)
v_mfma_f32_16x16x32_bf16 v[8:11], a[16:19], v[24:27], v[8:11]
v_and_b32_dpp v24, v23, v2 row_newbcast:9 row_mask:0xf bank_mask:0xf
v_and_b32_dpp v25, v23, v3 row_newbcast:9 row_mask:0xf bank_mask:0xf
v_and_b32_dpp v26, v23, v4 row_newbcast:9 row_mask:0xf bank_mask:0xf
v_and_b32_dpp v27, v23, v5 row_newbcast:9 row_mask:0xf bank_mask:0xf
v_mfma_f32_16x16x32_bf16 v[8:11], a[20:23], v[28:31], v[8:11]
v_and_b32_dpp v28, v23, v2 row_newbcast:13 row_mask:0xf bank_mask:0xf
v_and_b32_dpp v29, v23, v3 row_newbcast:13 row_mask:0xf bank_mask:0xf
v_and_b32_dpp v30, v23, v4 row_newbcast:13 row_mask:0xf bank_mask:0xf
v_and_b32_dpp v31, v23, v5 row_newbcast:13 row_mask:0xf bank_mask:0xf
v_mfma_f32_16x16x32_bf16 v[8:11], a[24:27], v[24:27], v[8:11]
s_nop 0
v_mfma_f32_16x16x32_bf16 v[8:11], a[28:31], v[28:31], v[8:11]
v_and_b32_dpp v24, v23, v2 row_newbcast:2 row_mask:0xf bank_mask:0xf
v_and_b32_dpp v25, v23, v3 row_newbcast:2 row_mask:0xf bank_mask:0xf
v_and_b32_dpp v26, v23, v4 row_newbcast:2 row_mask:0xf bank_mask:0xf
v_and_b32_dpp v27, v23, v5 row_newbcast:2 row_mask:0xf bank_mask:0xf
v_and_b32_dpp v28, v23, v2 row_newbcast:6 row_mask:0xf bank_mask:0xf
v_and_b32_dpp v29, v23, v3 row_newbcast:6 row_mask:0xf bank_mask:0xf
v_and_b32_dpp v30, v23, v4 row_newbcast:6 row_mask:0xf bank_mask:0xf
v_and_b32_dpp v31, v23, v5 row_newbcast:6 row_mask:0xf bank_mask:0xf
s_waitcnt vmcnt(4)
v_mfma_f32_16x16x32_bf16 v[8:11], a[32:35], v[24:27], v[8:11]
v_and_b32_dpp v24, v23, v2 row_newbcast:10 row_mask:0xf bank_mask:0xf
v_and_b32_dpp v25, v23, v3 row_newbcast:10 row_mask:0xf bank_mask:0xf
v_and_b32_dpp v26, v23, v4 row_newbcast:10 row_mask:0xf bank_mask:0xf
v_and_b32_dpp v27, v23, v5 row_newbcast:10 row_mask:0xf bank_mask:0xf
v_mfma_f32_16x16x32_bf16 v[8:11], a[36:39], v[28:31], v[8:11]
v_and_b32_dpp v28, v23, v2 row_newbcast:14 row_mask:0xf bank_mask:0xf
v_and_b32_dpp v29, v23, v3 row_newbcast:14 row_mask:0xf bank_mask:0xf
v_and_b32_dpp v30, v23, v4 row_newbcast:14 row_mask:0xf bank_mask:0xf
v_and_b32_dpp v31, v23, v5 row_newbcast:14 row_mask:0xf bank_mask:0xf
v_mfma_f32_16x16x32_bf16 v[8:11], a[40:43], v[24:27], v[8:11]
s_nop 0
v_mfma_f32_16x16x32_bf16 v[8:11], a[44:47], v[28:31], v[8:11]
v_and_b32_dpp v24, v23, v2 row_newbcast:3 row_mask:0xf bank_mask:0xf
v_and_b32_dpp v25, v23, v3 row_newbcast:3 row_mask:0xf bank_mask:0xf
v_and_b32_dpp v26, v23, v4 row_newbcast:3 row_mask:0xf bank_mask:0xf
v_and_b32_dpp v27, v23, v5 row_newbcast:3 row_mask:0xf bank_mask:0xf
v_and_b32_dpp v28, v23, v2 row_newbcast:7 row_mask:0xf bank_mask:0xf
v_and_b32_dpp v29, v23, v3 row_newbcast:7 row_mask:0xf bank_mask:0xf
v_and_b32_dpp v30, v23, v4 row_newbcast:7 row_mask:0xf bank_mask:0xf
v_and_b32_dpp v31, v23, v5 row_newbcast:7 row_mask:0xf bank_mask:0xf
s_waitcnt vmcnt(0)
v_mfma_f32_16x16x32_bf16 v[8:11], a[48:51], v[24:27], v[8:11]
v_and_b32_dpp v24, v23, v2 row_newbcast:11 row_mask:0xf bank_mask:0xf
v_and_b32_dpp v25, v23, v3 row_newbcast:11 row_mask:0xf bank_mask:0xf
v_and_b32_dpp v26, v23, v4 row_newbcast:11 row_mask:0xf bank_mask:0xf
v_and_b32_dpp v27, v23, v5 row_newbcast:11 row_mask:0xf bank_mask:0xf
v_mfma_f32_16x16x32_bf16 v[8:11], a[52:55], v[28:31], v[8:11]
v_and_b32_dpp v28, v23, v2 row_newbcast:15 row_mask:0xf bank_mask:0xf
v_and_b32_dpp v29, v23, v3 row_newbcast:15 row_mask:0xf bank_mask:0xf
v_and_b32_dpp v30, v23, v4 row_newbcast:15 row_mask:0xf bank_mask:0xf
v_and_b32_dpp v31, v23, v5 row_newbcast:15 row_mask:0xf bank_mask:0xf
v_mfma_f32_16x16x32_bf16 v[8:11], a[56:59], v[24:27], v[8:11]
s_nop 0
v_mfma_f32_16x16x32_bf16 v[8:11], a[60:63], v[28:31], v[8:11]
CHAIN:
v_lshrrev_b32 v16, 4, v0
v_and_b32 v17, 7, v0
v_lshl_add_u32 v16, v16, 3, v17
s_mul_i32 s58, s3, 544
s_add_u32 s58, s58, 157696
v_lshl_add_u32 v16, v16, 4, s58
v_add_f32_dpp v7, v7, v7 row_ror:8 row_mask:0xf bank_mask:0xf
s_nop 1
v_add_f32_dpp v7, v7, v7 row_ror:4 row_mask:0xf bank_mask:0xf
s_nop 1
v_add_f32_dpp v7, v7, v7 row_ror:2 row_mask:0xf bank_mask:0xf
s_nop 1
v_add_f32_dpp v7, v7, v7 row_ror:1 row_mask:0xf bank_mask:0xf
s_nop 1
v_add_f32_dpp v7, v7, v7 row_bcast:15 row_mask:0xa bank_mask:0xf
s_nop 1
v_add_f32_dpp v7, v7, v7 row_bcast:31 row_mask:0xc bank_mask:0xf
s_nop 0
v_readlane_b32 s57, v7, 63
v_mov_b32 v17, s58
v_xor_b32 v18, 0x80000000, v6
v_mov_b32 v19, s57
s_mov_b32 exec_lo, 0x00ff00ff
s_mov_b32 exec_hi, 0x00ff00ff
ds_write_b128 v16, v[8:11]
s_mov_b64 exec, 1
ds_write_b64 v17, v[18:19] offset:512
s_mov_b64 exec, -1
v_add_u32 v16, 157696, v1
v_mov_b32 v17, 157696
s_waitcnt lgkmcnt(0)
s_barrier
s_cmp_lg_u32 s3, 0
s_cbranch_scc1 SK_58
ds_read_b64 v[28:29], v17 offset:512
ds_read_b64 v[30:31], v17 offset:1056
ds_read_b64 v[44:45], v17 offset:1600
ds_read_b64 v[46:47], v17 offset:2144
s_mov_b32 exec_hi, 0
v_mov_b32 v18, v16
ds_read_b128 v[8:11], v18 offset:0
ds_read_b128 v[12:15], v18 offset:544
ds_read_b128 v[20:23], v18 offset:1088
ds_read_b128 v[24:27], v18 offset:1632
s_mov_b64 exec, -1
s_mul_i32 s57, s2, 640
s_add_u32 s57, s57, 131072
s_waitcnt lgkmcnt(4)
v_max_f32 v6, v28, v30
v_max3_f32 v6, v44, v46, v6
v_sub_f32 v28, v28, v6
v_sub_f32 v30, v30, v6
v_sub_f32 v44, v44, v6
v_sub_f32 v46, v46, v6
v_exp_f32 v28, v28
v_exp_f32 v30, v30
v_exp_f32 v44, v44
v_exp_f32 v46, v46
v_mul_f32 v7, v28, v29
v_fmac_f32 v7, v30, v31
v_fmac_f32 v7, v44, v45
v_fmac_f32 v7, v46, v47
s_waitcnt lgkmcnt(0)
v_mul_f32 v8, v28, v8
v_mul_f32 v9, v28, v9
v_mul_f32 v10, v28, v10
v_mul_f32 v11, v28, v11
v_fmac_f32 v8, v30, v12
v_fmac_f32 v9, v30, v13
v_fmac_f32 v10, v30, v14
v_fmac_f32 v11, v30, v15
v_fmac_f32 v8, v44, v20
v_fmac_f32 v9, v44, v21
v_fmac_f32 v10, v44, v22
v_fmac_f32 v11, v44, v23
v_fmac_f32 v8, v46, v24
v_fmac_f32 v9, v46, v25
v_fmac_f32 v10, v46, v26
v_fmac_f32 v11, v46, v27
s_mov_b32 exec_lo, 0
s_mov_b32 exec_hi, 1
v_mov_b32 v8, v6
v_mov_b32 v9, v7
v_mov_b32 v10, 0
v_mov_b32 v11, 0
s_mov_b32 exec_lo, -1
v_and_or_b32 v8, v8, -4, s70
v_and_or_b32 v9, v9, -4, s70
v_and_or_b32 v10, v10, -4, s70
v_and_or_b32 v11, v11, -4, s70
buffer_store_dwordx4 v[8:11], v1, s[16:19], s57 offen sc1
s_mov_b64 exec, -1
SK_58:
v_and_b32 v18, 7, v0
v_mul_u32_u24 v18, 640, v18
v_lshrrev_b32 v19, 3, v0
v_lshl_add_u32 v19, v19, 4, v18
s_mul_i32 s57, s48, 5120
s_add_u32 s57, s57, 131072
s_lshl_b32 s58, s3, 7
s_add_u32 s58, s58, s57
s_waitcnt vmcnt(0)
s_barrier
PL_59:
buffer_load_dwordx2 v[16:17], v18, s[16:19], s57 offen offset:512 sc1
buffer_load_dwordx4 v[12:15], v19, s[16:19], s58 offen sc1
s_waitcnt vmcnt(0)
v_or3_b32 v6, v12, v13, v14
v_or3_b32 v6, v15, v16, v6
v_or_b32 v6, v17, v6
v_and_b32 v6, s71, v6
v_cmp_ne_u32 vcc, 0, v6
s_cbranch_vccz PD_60
s_cmp_eq_u32 s54, 0
s_cbranch_scc1 PD_60
s_sub_u32 s54, s54, 1
s_sleep 2
s_branch PL_59
PD_60:
v_mov_b32 v6, v16
s_nop 1
v_max_f32_dpp v6, v6, v6 quad_perm:[1,0,3,2] row_mask:0xf bank_mask:0xf
s_nop 1
v_max_f32_dpp v6, v6, v6 quad_perm:[2,3,0,1] row_mask:0xf bank_mask:0xf
s_nop 1
v_max_f32_dpp v6, v6, v6 row_half_mirror row_mask:0xf bank_mask:0xf
v_sub_f32 v16, v16, v6
v_exp_f32 v16, v16
s_nop 0
v_mul_f32 v17, v16, v17
v_mul_f32 v12, v16, v12
v_mul_f32 v13, v16, v13
v_mul_f32 v14, v16, v14
v_mul_f32 v15, v16, v15
v_add_f32_dpp v17, v17, v17 quad_perm:[1,0,3,2] row_mask:0xf bank_mask:0xf
v_add_f32_dpp v12, v12, v12 quad_perm:[1,0,3,2] row_mask:0xf bank_mask:0xf
v_add_f32_dpp v13, v13, v13 quad_perm:[1,0,3,2] row_mask:0xf bank_mask:0xf
v_add_f32_dpp v14, v14, v14 quad_perm:[1,0,3,2] row_mask:0xf bank_mask:0xf
v_add_f32_dpp v15, v15, v15 quad_perm:[1,0,3,2] row_mask:0xf bank_mask:0xf
v_add_f32_dpp v17, v17, v17 quad_perm:[2,3,0,1] row_mask:0xf bank_mask:0xf
v_add_f32_dpp v12, v12, v12 quad_perm:[2,3,0,1] row_mask:0xf bank_mask:0xf
v_add_f32_dpp v13, v13, v13 quad_perm:[2,3,0,1] row_mask:0xf bank_mask:0xf
v_add_f32_dpp v14, v14, v14 quad_perm:[2,3,0,1] row_mask:0xf bank_mask:0xf
v_add_f32_dpp v15, v15, v15 quad_perm:[2,3,0,1] row_mask:0xf bank_mask:0xf
v_add_f32_dpp v17, v17, v17 row_half_mirror row_mask:0xf bank_mask:0xf
v_add_f32_dpp v12, v12, v12 row_half_mirror row_mask:0xf bank_mask:0xf
v_add_f32_dpp v13, v13, v13 row_half_mirror row_mask:0xf bank_mask:0xf
v_add_f32_dpp v14, v14, v14 row_half_mirror row_mask:0xf bank_mask:0xf
v_add_f32_dpp v15, v15, v15 row_half_mirror row_mask:0xf bank_mask:0xf
v_rcp_f32 v16, v17
s_nop 0
v_mul_f32 v6, v12, v16
v_fma_f32 v12, -v6, v17, v12
v_fma_f32 v12, v12, v16, v6
v_cvt_pk_bf16_f32 v12, v12, v12
v_mul_f32 v6, v13, v16
v_fma_f32 v13, -v6, v17, v13
v_fma_f32 v13, v13, v16, v6
v_cvt_pk_bf16_f32 v13, v13, v13
v_mul_f32 v6, v14, v16
v_fma_f32 v14, -v6, v17, v14
v_fma_f32 v14, v14, v16, v6
v_cvt_pk_bf16_f32 v14, v14, v14
v_mul_f32 v6, v15, v16
v_fma_f32 v15, -v6, v17, v15
v_fma_f32 v15, v15, v16, v6
v_cvt_pk_bf16_f32 v15, v15, v15
v_and_b32 v16, v12, v2
v_and_b32 v17, v12, v3
v_and_b32 v18, v12, v4
v_and_b32 v19, v12, v5
v_and_b32 v20, v13, v2
v_and_b32 v21, v13, v3
v_and_b32 v22, v13, v4
v_and_b32 v23, v13, v5
v_and_b32 v24, v14, v2
v_and_b32 v25, v14, v3
v_and_b32 v26, v14, v4
v_and_b32 v27, v14, v5
v_and_b32 v28, v15, v2
v_and_b32 v29, v15, v3
v_and_b32 v30, v15, v4
v_and_b32 v31, v15, v5
v_mfma_f32_16x16x32_bf16 v[8:11], a[248:251], v[16:19], 0
v_mfma_f32_16x16x32_bf16 v[8:11], a[252:255], v[20:23], v[8:11]
v_mfma_f32_16x16x32_bf16 v[8:11], v[32:35], v[24:27], v[8:11]
v_mfma_f32_16x16x32_bf16 v[8:11], v[36:39], v[28:31], v[8:11]
v_bfe_u32 v12, v0, 4, 1
v_and_b32 v13, 7, v0
v_lshl_add_u32 v12, v12, 3, v13
v_lshrrev_b32 v13, 5, v0
v_lshl_add_u32 v12, v13, 4, v12
s_lshl_b32 s57, s3, 9
s_add_u32 s57, s57, 160000
v_lshl_add_u32 v12, v12, 4, s57
v_add_u32 v13, 160000, v1
s_mov_b32 exec_lo, 0x00ff00ff
s_mov_b32 exec_hi, 0xff00ff00
ds_write_b128 v12, v[8:11]
s_mov_b64 exec, -1
s_waitcnt lgkmcnt(0)
s_barrier
s_cmp_lg_u32 s3, 0
s_cbranch_scc1 SK_61
ds_read_b128 v[8:11], v13
ds_read_b128 v[16:19], v13 offset:1024
s_lshl_b32 s57, s49, 13
s_lshl_b32 s58, s48, 8
s_add_u32 s57, s57, s58
s_add_u32 s57, s57, 294912
s_waitcnt lgkmcnt(0)
v_add_f32 v8, v8, v16
v_add_f32 v9, v9, v17
v_add_f32 v10, v10, v18
v_add_f32 v11, v11, v19
s_nop 0
v_permlane32_swap_b32 v8, v10
v_permlane32_swap_b32 v9, v11
v_add_f32 v8, v8, v10
v_add_f32 v9, v9, v11
s_nop 1
v_permlane16_swap_b32 v8, v9
v_add_f32 v8, v8, v9
v_and_b32 v12, 15, v0
v_lshrrev_b32 v13, 4, v0
v_lshlrev_b32 v12, 4, v12
v_lshl_add_u32 v12, v13, 2, v12
v_and_or_b32 v8, v8, -4, s70
buffer_store_dword v8, v12, s[16:19], s57 offen sc1
SK_61:
s_cmp_lt_u32 s51, 172
s_cbranch_scc1 FFN
s_cmp_eq_u32 s62, 24
s_cbranch_scc1 REDUCER
s_cmp_lg_u32 s53, 0
s_cbranch_scc1 SK_62
s_sub_u32 s57, s62, 22
s_cmp_gt_u32 s57, 8
s_cbranch_scc1 SK_62
s_cmp_gt_u32 s57, 2
s_subb_u32 s57, s57, 0
s_lshl_b32 s57, s57, 2
s_add_u32 s57, s57, s3
s_lshl_b32 s57, s57, 23
s_and_b32 s58, s77, 0x602000
s_add_u32 s57, s57, s58
s_add_u32 s57, s57, 262144
v_lshlrev_b32 v7, 7, v0
s_mov_b32 s4, s26
s_and_b32 s5, s27, 0xffff
s_mov_b32 s6, 0x10000000
s_mov_b32 s7, 0x20000
s_add_u32 s58, s57, 32768
buffer_load_dword v6, v7, s[4:7], s58 offen
s_add_u32 s58, s57, 49152
buffer_load_dword v6, v7, s[4:7], s58 offen
s_add_u32 s58, s57, 98304
buffer_load_dword v6, v7, s[4:7], s58 offen
s_add_u32 s58, s57, 114688
buffer_load_dword v6, v7, s[4:7], s58 offen
s_add_u32 s58, s57, 163840
buffer_load_dword v6, v7, s[4:7], s58 offen
s_add_u32 s58, s57, 180224
buffer_load_dword v6, v7, s[4:7], s58 offen
s_add_u32 s58, s57, 229376
buffer_load_dword v6, v7, s[4:7], s58 offen
s_add_u32 s58, s57, 245760
buffer_load_dword v6, v7, s[4:7], s58 offen
SK_62:
AFTER_FFN:
s_cmp_lg_u32 s53, 0
s_cbranch_scc1 FINISH
WAIT_X2:
s_lshl_b32 s59, s49, 11
s_add_u32 s59, s59, 376832
PL_63:
buffer_load_dwordx4 v[8:11], v1, s[16:19], s59 offen sc1
buffer_load_dwordx4 v[12:15], v1, s[16:19], s59 offen offset:1024 sc1
buffer_load_dword v22, v41, s[16:19], s59 offen sc1
s_waitcnt vmcnt(0)
v_or3_b32 v6, v8, v9, v10
v_or3_b32 v6, v11, v12, v6
v_or3_b32 v6, v13, v14, v6
v_or3_b32 v6, v15, v22, v6
v_and_b32 v6, s71, v6
v_cmp_ne_u32 vcc, 0, v6
s_cbranch_vccz PD_64
s_cmp_eq_u32 s54, 0
s_cbranch_scc1 PD_64
s_sub_u32 s54, s54, 1
s_sleep 2
s_branch PL_63
PD_64:
s_mov_b32 s70, 2
s_mov_b32 s71, 1
v_and_b32 v22, 0xffff0000, v22
v_readfirstlane_b32 s57, v8
s_nop 1
v_subrev_f32 v8, s57, v8
v_subrev_f32 v9, s57, v9
v_subrev_f32 v10, s57, v10
v_subrev_f32 v11, s57, v11
v_subrev_f32 v12, s57, v12
v_subrev_f32 v13, s57, v13
v_subrev_f32 v14, s57, v14
v_subrev_f32 v15, s57, v15
v_add_f32 v16, v8, v9
v_mul_f32 v17, v8, v8
v_add_f32 v18, v10, v11
v_mul_f32 v19, v9, v9
v_add_f32 v16, v16, v12
v_add_f32 v18, v18, v13
v_add_f32 v16, v16, v14
v_add_f32 v18, v18, v15
v_fmac_f32 v17, v10, v10
v_fmac_f32 v19, v11, v11
v_fmac_f32 v17, v12, v12
v_fmac_f32 v19, v13, v13
v_fmac_f32 v17, v14, v14
v_fmac_f32 v19, v15, v15
v_add_f32 v16, v16, v18
v_add_f32 v17, v17, v19
s_nop 0
v_add_f32_dpp v16, v16, v16 row_ror:8 row_mask:0xf bank_mask:0xf
v_add_f32_dpp v17, v17, v17 row_ror:8 row_mask:0xf bank_mask:0xf
s_nop 0
v_add_f32_dpp v16, v16, v16 row_ror:4 row_mask:0xf bank_mask:0xf
v_add_f32_dpp v17, v17, v17 row_ror:4 row_mask:0xf bank_mask:0xf
s_nop 0
v_add_f32_dpp v16, v16, v16 row_ror:2 row_mask:0xf bank_mask:0xf
v_add_f32_dpp v17, v17, v17 row_ror:2 row_mask:0xf bank_mask:0xf
s_nop 0
v_add_f32_dpp v16, v16, v16 row_ror:1 row_mask:0xf bank_mask:0xf
v_add_f32_dpp v17, v17, v17 row_ror:1 row_mask:0xf bank_mask:0xf
s_nop 0
v_add_f32_dpp v16, v16, v16 row_bcast:15 row_mask:0xa bank_mask:0xf
v_add_f32_dpp v17, v17, v17 row_bcast:15 row_mask:0xa bank_mask:0xf
s_nop 0
v_add_f32_dpp v16, v16, v16 row_bcast:31 row_mask:0xc bank_mask:0xf
v_add_f32_dpp v17, v17, v17 row_bcast:31 row_mask:0xc bank_mask:0xf
v_readlane_b32 s58, v16, 63
v_readlane_b32 s59, v17, 63
v_mov_b32 v18, 0x3b000000
v_mul_f32 v16, s58, v18
v_mul_f32 v17, s59, v18
v_fma_f32 v17, -v16, v16, v17
v_add_f32 v16, s57, v16
v_max_f32 v17, 0, v17
v_cvt_pk_bf16_f32 v16, v16, v16
v_and_b32 v16, 0xffff0000, v16
v_cvt_pk_bf16_f32 v17, v17, v17
v_and_b32 v17, 0xffff0000, v17
v_add_f32 v17, 0x3727c5ac, v17
v_cvt_pk_bf16_f32 v17, v17, v17
v_and_b32 v17, 0xffff0000, v17
v_sqrt_f32 v17, v17
v_sub_f32 v22, v22, v16
v_cvt_pk_bf16_f32 v17, v17, v17
v_and_b32 v17, 0xffff0000, v17
v_rcp_f32 v18, v17
v_cvt_pk_bf16_f32 v22, v22, v22
v_and_b32 v22, 0xffff0000, v22
v_mul_f32 v19, v22, v18
v_fma_f32 v22, -v19, v17, v22
v_fma_f32 v22, v22, v18, v19
v_cvt_pk_bf16_f32 v23, v22, v22
s_nop 1
v_and_b32_dpp v24, v23, v2 row_newbcast:0 row_mask:0xf bank_mask:0xf
v_and_b32_dpp v25, v23, v3 row_newbcast:0 row_mask:0xf bank_mask:0xf
v_and_b32_dpp v26, v23, v4 row_newbcast:0 row_mask:0xf bank_mask:0xf
v_and_b32_dpp v27, v23, v5 row_newbcast:0 row_mask:0xf bank_mask:0xf
v_and_b32_dpp v28, v23, v2 row_newbcast:4 row_mask:0xf bank_mask:0xf
v_and_b32_dpp v29, v23, v3 row_newbcast:4 row_mask:0xf bank_mask:0xf
v_and_b32_dpp v30, v23, v4 row_newbcast:4 row_mask:0xf bank_mask:0xf
v_and_b32_dpp v31, v23, v5 row_newbcast:4 row_mask:0xf bank_mask:0xf
v_mfma_f32_16x16x32_bf16 v[8:11], a[208:211], v[24:27], 0
v_and_b32_dpp v24, v23, v2 row_newbcast:8 row_mask:0xf bank_mask:0xf
v_and_b32_dpp v25, v23, v3 row_newbcast:8 row_mask:0xf bank_mask:0xf
v_and_b32_dpp v26, v23, v4 row_newbcast:8 row_mask:0xf bank_mask:0xf
v_and_b32_dpp v27, v23, v5 row_newbcast:8 row_mask:0xf bank_mask:0xf
v_mfma_f32_16x16x32_bf16 v[8:11], a[212:215], v[28:31], v[8:11]
v_and_b32_dpp v28, v23, v2 row_newbcast:12 row_mask:0xf bank_mask:0xf
v_and_b32_dpp v29, v23, v3 row_newbcast:12 row_mask:0xf bank_mask:0xf
v_and_b32_dpp v30, v23, v4 row_newbcast:12 row_mask:0xf bank_mask:0xf
v_and_b32_dpp v31, v23, v5 row_newbcast:12 row_mask:0xf bank_mask:0xf
v_lshrrev_b32 v16, 4, v0
v_and_b32 v17, 7, v0
v_mfma_f32_16x16x32_bf16 v[8:11], a[216:219], v[24:27], v[8:11]
v_mfma_f32_16x16x32_bf16 v[8:11], a[220:223], v[28:31], v[8:11]
v_lshlrev_b32 v16, 7, v16
v_lshl_add_u32 v16, v17, 2, v16
s_lshl_b32 s57, s3, 9
s_add_u32 s57, s57, 155648
v_add_u32 v16, s57, v16
v_add_u32 v17, 155648, v1
s_mov_b32 exec_lo, 0x00ff00ff
s_mov_b32 exec_hi, 0x00ff00ff
ds_write_b32 v16, v8 offset:0
ds_write_b32 v16, v9 offset:32
ds_write_b32 v16, v10 offset:64
ds_write_b32 v16, v11 offset:96
s_mov_b64 exec, -1
s_waitcnt lgkmcnt(0)
s_barrier
s_cmp_lg_u32 s3, 0
s_cbranch_scc1 SK_65
s_mov_b32 exec_hi, 0
ds_read_b128 v[8:11], v17 offset:0
ds_read_b128 v[20:23], v17 offset:512
ds_read_b128 v[24:27], v17 offset:1024
ds_read_b128 v[28:31], v17 offset:1536
s_waitcnt lgkmcnt(0)
v_add_f32 v8, v8, v20
v_add_f32 v24, v24, v28
v_add_f32 v9, v9, v21
v_add_f32 v25, v25, v29
v_add_f32 v10, v10, v22
v_add_f32 v26, v26, v30
v_add_f32 v11, v11, v23
v_add_f32 v27, v27, v31
v_add_f32 v8, v8, v24
v_add_f32 v9, v9, v25
v_add_f32 v10, v10, v26
v_add_f32 v11, v11, v27
v_and_or_b32 v8, v8, -4, s70
v_and_or_b32 v9, v9, -4, s70
v_and_or_b32 v10, v10, -4, s70
v_and_or_b32 v11, v11, -4, s70
s_lshl_b32 s57, s2, 9
buffer_store_dwordx4 v[8:11], v1, s[16:19], s57 offen sc1
s_mov_b64 exec, -1
SK_65:
v_lshrrev_b32 v6, 4, v0
v_and_b32 v7, 15, v0
v_lshlrev_b32 v6, 10, v6
v_lshl_add_u32 v6, v7, 5, v6
s_lshl_b32 s60, s48, 12
s_waitcnt vmcnt(0)
s_barrier
PL_66:
buffer_load_dwordx4 v[16:19], v6, s[16:19], s60 offen offset:0 sc1
buffer_load_dwordx4 v[20:23], v6, s[16:19], s60 offen offset:16 sc1
buffer_load_dwordx4 v[24:27], v6, s[16:19], s60 offen offset:512 sc1
buffer_load_dwordx4 v[28:31], v6, s[16:19], s60 offen offset:528 sc1
s_waitcnt vmcnt(0)
v_or3_b32 v7, v16, v17, v18
v_or3_b32 v7, v19, v20, v7
v_or3_b32 v7, v21, v22, v7
v_or3_b32 v7, v23, v24, v7
v_or3_b32 v7, v25, v26, v7
v_or3_b32 v7, v27, v28, v7
v_or3_b32 v7, v29, v30, v7
v_or_b32 v7, v31, v7
v_and_b32 v7, s71, v7
v_cmp_ne_u32 vcc, 0, v7
s_cbranch_vccz PD_67
s_cmp_eq_u32 s54, 0
s_cbranch_scc1 PD_67
s_sub_u32 s54, s54, 1
s_sleep 1
s_branch PL_66
PD_67:
v_add_f32 v16, v16, v24
v_add_f32 v17, v17, v25
v_add_f32 v18, v18, v26
v_add_f32 v19, v19, v27
v_add_f32 v20, v20, v28
v_add_f32 v21, v21, v29
v_add_f32 v22, v22, v30
v_add_f32 v23, v23, v31
v_permlane32_swap_b32 v16, v20
v_permlane32_swap_b32 v17, v21
v_permlane32_swap_b32 v18, v22
v_permlane32_swap_b32 v19, v23
v_add_f32 v16, v16, v20
v_add_f32 v17, v17, v21
v_add_f32 v18, v18, v22
v_add_f32 v19, v19, v23
s_nop 0
v_permlane16_swap_b32 v16, v18
v_permlane16_swap_b32 v17, v19
v_add_f32 v16, v16, v18
v_add_f32 v17, v17, v19
v_cvt_pk_bf16_f32 v12, v16, v17
v_mov_b32 v13, v12
s_nop 1
v_permlane16_swap_b32 v12, v13
v_mov_b32 v14, v12
v_mov_b32 v15, v13
s_nop 0
v_permlane32_swap_b32 v12, v14
v_permlane32_swap_b32 v13, v15
s_mov_b32 s53, 1
v_mov_b32 v6, 0x7149f2ca
v_mov_b32 v7, 0
v_mov_b32 v8, 0
v_mov_b32 v9, 0
v_mov_b32 v10, 0
v_mov_b32 v11, 0
s_mul_i32 s57, s3, 40960
s_min_u32 s57, s57, 118784
v_add_u32 v44, s57, v1
s_and_b32 s57, s2, 3
s_lshl_b32 s72, s57, 2
s_add_u32 s72, s72, s3
s_lshl_b32 s72, s72, 1
s_bfe_u32 s58, s77, 0x1000d
s_add_u32 s72, s72, s58
s_lshl_b32 s58, s48, 5
s_add_u32 s72, s72, s58
s_lshl_b32 s72, s72, 11
s_add_u32 s72, s72, 4194304
s_lshl_b32 s73, s57, 2
s_add_u32 s73, s73, s3
s_lshl_b32 s73, s73, 1
s_bfe_u32 s58, s63, 0x1000d
s_add_u32 s73, s73, s58
s_lshl_b32 s58, s48, 5
s_add_u32 s73, s73, s58
s_lshl_b32 s73, s73, 11
s_add_u32 s73, s73, 4194304
v_dot2_f32_bf16 v16, v48, v12, 0
v_dot2_f32_bf16 v17, v52, v12, 0
v_dot2_f32_bf16 v18, v56, v12, 0
v_dot2_f32_bf16 v19, v60, v12, 0
v_dot2_f32_bf16 v16, v49, v13, v16
v_dot2_f32_bf16 v17, v53, v13, v17
v_dot2_f32_bf16 v18, v57, v13, v18
v_dot2_f32_bf16 v19, v61, v13, v19
v_dot2_f32_bf16 v16, v50, v14, v16
v_dot2_f32_bf16 v17, v54, v14, v17
v_dot2_f32_bf16 v18, v58, v14, v18
v_dot2_f32_bf16 v19, v62, v14, v19
v_dot2_f32_bf16 v16, v51, v15, v16
v_dot2_f32_bf16 v17, v55, v15, v17
v_dot2_f32_bf16 v18, v59, v15, v18
v_dot2_f32_bf16 v19, v63, v15, v19
s_add_u32 s57, s77, 262144
buffer_load_dwordx4 v[48:51], v1, s[8:11], s57 offen offset:0 nt
buffer_load_dwordx4 v[52:55], v1, s[8:11], s57 offen offset:1024 nt
buffer_load_dwordx4 v[56:59], v1, s[8:11], s57 offen offset:2048 nt
buffer_load_dwordx4 v[60:63], v1, s[8:11], s57 offen offset:3072 nt
v_add_f32_dpp v20, v16, v16 row_ror:8 row_mask:0xf bank_mask:0x3
v_add_f32_dpp v21, v17, v17 row_ror:8 row_mask:0xf bank_mask:0x3
s_nop 0
v_add_f32_dpp v20, v18, v18 row_ror:8 row_mask:0xf bank_mask:0xc
v_add_f32_dpp v21, v19, v19 row_ror:8 row_mask:0xf bank_mask:0xc
s_nop 0
v_add_f32_dpp v24, v20, v20 row_half_mirror row_mask:0xf bank_mask:0x5
s_nop 1
v_add_f32_dpp v24, v21, v21 row_half_mirror row_mask:0xf bank_mask:0xa
v_dot2_f32_bf16 v16, v64, v12, 0
v_dot2_f32_bf16 v17, v68, v12, 0
v_dot2_f32_bf16 v18, v72, v12, 0
v_dot2_f32_bf16 v19, v76, v12, 0
v_dot2_f32_bf16 v16, v65, v13, v16
v_dot2_f32_bf16 v17, v69, v13, v17
v_dot2_f32_bf16 v18, v73, v13, v18
v_dot2_f32_bf16 v19, v77, v13, v19
v_dot2_f32_bf16 v16, v66, v14, v16
v_dot2_f32_bf16 v17, v70, v14, v17
v_dot2_f32_bf16 v18, v74, v14, v18
v_dot2_f32_bf16 v19, v78, v14, v19
v_dot2_f32_bf16 v16, v67, v15, v16
v_dot2_f32_bf16 v17, v71, v15, v17
v_dot2_f32_bf16 v18, v75, v15, v18
v_dot2_f32_bf16 v19, v79, v15, v19
s_add_u32 s57, s77, 294912
buffer_load_dwordx4 v[64:67], v1, s[8:11], s57 offen offset:0 nt
buffer_load_dwordx4 v[68:71], v1, s[8:11], s57 offen offset:1024 nt
buffer_load_dwordx4 v[72:75], v1, s[8:11], s57 offen offset:2048 nt
buffer_load_dwordx4 v[76:79], v1, s[8:11], s57 offen offset:3072 nt
v_add_f32_dpp v20, v16, v16 row_ror:8 row_mask:0xf bank_mask:0x3
v_add_f32_dpp v21, v17, v17 row_ror:8 row_mask:0xf bank_mask:0x3
s_nop 0
v_add_f32_dpp v20, v18, v18 row_ror:8 row_mask:0xf bank_mask:0xc
v_add_f32_dpp v21, v19, v19 row_ror:8 row_mask:0xf bank_mask:0xc
s_nop 0
v_add_f32_dpp v25, v20, v20 row_half_mirror row_mask:0xf bank_mask:0x5
s_nop 1
v_add_f32_dpp v25, v21, v21 row_half_mirror row_mask:0xf bank_mask:0xa
v_dot2_f32_bf16 v16, v80, v12, 0
v_dot2_f32_bf16 v17, v84, v12, 0
v_dot2_f32_bf16 v18, v88, v12, 0
v_dot2_f32_bf16 v19, v92, v12, 0
v_dot2_f32_bf16 v16, v81, v13, v16
v_dot2_f32_bf16 v17, v85, v13, v17
v_dot2_f32_bf16 v18, v89, v13, v18
v_dot2_f32_bf16 v19, v93, v13, v19
v_dot2_f32_bf16 v16, v82, v14, v16
v_dot2_f32_bf16 v17, v86, v14, v17
v_dot2_f32_bf16 v18, v90, v14, v18
v_dot2_f32_bf16 v19, v94, v14, v19
v_dot2_f32_bf16 v16, v83, v15, v16
v_dot2_f32_bf16 v17, v87, v15, v17
v_dot2_f32_bf16 v18, v91, v15, v18
v_dot2_f32_bf16 v19, v95, v15, v19
s_add_u32 s57, s77, 327680
buffer_load_dwordx4 v[80:83], v1, s[8:11], s57 offen offset:0 nt
buffer_load_dwordx4 v[84:87], v1, s[8:11], s57 offen offset:1024 nt
buffer_load_dwordx4 v[88:91], v1, s[8:11], s57 offen offset:2048 nt
buffer_load_dwordx4 v[92:95], v1, s[8:11], s57 offen offset:3072 nt
v_add_f32_dpp v20, v16, v16 row_ror:8 row_mask:0xf bank_mask:0x3
v_add_f32_dpp v21, v17, v17 row_ror:8 row_mask:0xf bank_mask:0x3
s_nop 0
v_add_f32_dpp v20, v18, v18 row_ror:8 row_mask:0xf bank_mask:0xc
v_add_f32_dpp v21, v19, v19 row_ror:8 row_mask:0xf bank_mask:0xc
s_nop 0
v_add_f32_dpp v26, v20, v20 row_half_mirror row_mask:0xf bank_mask:0x5
s_nop 1
v_add_f32_dpp v26, v21, v21 row_half_mirror row_mask:0xf bank_mask:0xa
v_dot2_f32_bf16 v16, v96, v12, 0
v_dot2_f32_bf16 v17, v100, v12, 0
v_dot2_f32_bf16 v18, v104, v12, 0
v_dot2_f32_bf16 v19, v108, v12, 0
v_dot2_f32_bf16 v16, v97, v13, v16
v_dot2_f32_bf16 v17, v101, v13, v17
v_dot2_f32_bf16 v18, v105, v13, v18
v_dot2_f32_bf16 v19, v109, v13, v19
v_dot2_f32_bf16 v16, v98, v14, v16
v_dot2_f32_bf16 v17, v102, v14, v17
v_dot2_f32_bf16 v18, v106, v14, v18
v_dot2_f32_bf16 v19, v110, v14, v19
v_dot2_f32_bf16 v16, v99, v15, v16
v_dot2_f32_bf16 v17, v103, v15, v17
v_dot2_f32_bf16 v18, v107, v15, v18
v_dot2_f32_bf16 v19, v111, v15, v19
s_add_u32 s57, s77, 360448
buffer_load_dwordx4 v[96:99], v1, s[8:11], s57 offen offset:0 nt
buffer_load_dwordx4 v[100:103], v1, s[8:11], s57 offen offset:1024 nt
buffer_load_dwordx4 v[104:107], v1, s[8:11], s57 offen offset:2048 nt
buffer_load_dwordx4 v[108:111], v1, s[8:11], s57 offen offset:3072 nt
v_add_f32_dpp v20, v16, v16 row_ror:8 row_mask:0xf bank_mask:0x3
v_add_f32_dpp v21, v17, v17 row_ror:8 row_mask:0xf bank_mask:0x3
s_nop 0
v_add_f32_dpp v20, v18, v18 row_ror:8 row_mask:0xf bank_mask:0xc
v_add_f32_dpp v21, v19, v19 row_ror:8 row_mask:0xf bank_mask:0xc
s_nop 0
v_add_f32_dpp v27, v20, v20 row_half_mirror row_mask:0xf bank_mask:0x5
s_nop 1
v_add_f32_dpp v27, v21, v21 row_half_mirror row_mask:0xf bank_mask:0xa
v_add_f32_dpp v24, v24, v24 quad_perm:[2,3,0,1] row_mask:0xf bank_mask:0xf
v_add_f32_dpp v25, v25, v25 quad_perm:[2,3,0,1] row_mask:0xf bank_mask:0xf
v_add_f32_dpp v26, v26, v26 quad_perm:[2,3,0,1] row_mask:0xf bank_mask:0xf
v_add_f32_dpp v27, v27, v27 quad_perm:[2,3,0,1] row_mask:0xf bank_mask:0xf
v_cndmask_b32 v24, v24, v26, s[66:67]
v_cndmask_b32 v25, v25, v27, s[66:67]
s_nop 0
v_add_f32_dpp v24, v24, v24 quad_perm:[1,0,3,2] row_mask:0xf bank_mask:0xf
v_add_f32_dpp v25, v25, v25 quad_perm:[1,0,3,2] row_mask:0xf bank_mask:0xf
v_cndmask_b32 v41, v24, v25, s[68:69]
s_add_u32 s56, s77, 393216
s_mov_b32 s55, 3
LOOP_68:
s_waitcnt vmcnt(12)
v_dot2_f32_bf16 v16, v48, v12, 0
v_dot2_f32_bf16 v17, v52, v12, 0
v_dot2_f32_bf16 v18, v56, v12, 0
v_dot2_f32_bf16 v19, v60, v12, 0
v_dot2_f32_bf16 v16, v49, v13, v16
v_dot2_f32_bf16 v17, v53, v13, v17
v_dot2_f32_bf16 v18, v57, v13, v18
v_dot2_f32_bf16 v19, v61, v13, v19
v_dot2_f32_bf16 v16, v50, v14, v16
v_dot2_f32_bf16 v17, v54, v14, v17
v_dot2_f32_bf16 v18, v58, v14, v18
v_dot2_f32_bf16 v19, v62, v14, v19
v_dot2_f32_bf16 v16, v51, v15, v16
v_dot2_f32_bf16 v17, v55, v15, v17
v_dot2_f32_bf16 v18, v59, v15, v18
v_dot2_f32_bf16 v19, v63, v15, v19
buffer_load_dwordx4 v[48:51], v1, s[8:11], s56 offen offset:0 nt
buffer_load_dwordx4 v[52:55], v1, s[8:11], s56 offen offset:1024 nt
buffer_load_dwordx4 v[56:59], v1, s[8:11], s56 offen offset:2048 nt
buffer_load_dwordx4 v[60:63], v1, s[8:11], s56 offen offset:3072 nt
s_add_u32 s56, s56, 32768
v_add_f32_dpp v20, v16, v16 row_ror:8 row_mask:0xf bank_mask:0x3
v_add_f32_dpp v21, v17, v17 row_ror:8 row_mask:0xf bank_mask:0x3
s_nop 0
v_add_f32_dpp v20, v18, v18 row_ror:8 row_mask:0xf bank_mask:0xc
v_add_f32_dpp v21, v19, v19 row_ror:8 row_mask:0xf bank_mask:0xc
s_nop 0
v_add_f32_dpp v24, v20, v20 row_half_mirror row_mask:0xf bank_mask:0x5
s_nop 1
v_add_f32_dpp v24, v21, v21 row_half_mirror row_mask:0xf bank_mask:0xa
s_waitcnt vmcnt(12)
v_dot2_f32_bf16 v16, v64, v12, 0
v_dot2_f32_bf16 v17, v68, v12, 0
v_dot2_f32_bf16 v18, v72, v12, 0
v_dot2_f32_bf16 v19, v76, v12, 0
v_dot2_f32_bf16 v16, v65, v13, v16
v_dot2_f32_bf16 v17, v69, v13, v17
v_dot2_f32_bf16 v18, v73, v13, v18
v_dot2_f32_bf16 v19, v77, v13, v19
v_dot2_f32_bf16 v16, v66, v14, v16
v_dot2_f32_bf16 v17, v70, v14, v17
v_dot2_f32_bf16 v18, v74, v14, v18
v_dot2_f32_bf16 v19, v78, v14, v19
v_dot2_f32_bf16 v16, v67, v15, v16
v_dot2_f32_bf16 v17, v71, v15, v17
v_dot2_f32_bf16 v18, v75, v15, v18
v_dot2_f32_bf16 v19, v79, v15, v19
buffer_load_dwordx4 v[64:67], v1, s[8:11], s56 offen offset:0 nt
buffer_load_dwordx4 v[68:71], v1, s[8:11], s56 offen offset:1024 nt
buffer_load_dwordx4 v[72:75], v1, s[8:11], s56 offen offset:2048 nt
buffer_load_dwordx4 v[76:79], v1, s[8:11], s56 offen offset:3072 nt
s_add_u32 s56, s56, 32768
v_add_f32_dpp v20, v16, v16 row_ror:8 row_mask:0xf bank_mask:0x3
v_add_f32_dpp v21, v17, v17 row_ror:8 row_mask:0xf bank_mask:0x3
s_nop 0
v_add_f32_dpp v20, v18, v18 row_ror:8 row_mask:0xf bank_mask:0xc
v_add_f32_dpp v21, v19, v19 row_ror:8 row_mask:0xf bank_mask:0xc
s_nop 0
v_add_f32_dpp v25, v20, v20 row_half_mirror row_mask:0xf bank_mask:0x5
s_nop 1
v_add_f32_dpp v25, v21, v21 row_half_mirror row_mask:0xf bank_mask:0xa
s_waitcnt vmcnt(12)
v_dot2_f32_bf16 v16, v80, v12, 0
v_dot2_f32_bf16 v17, v84, v12, 0
v_dot2_f32_bf16 v18, v88, v12, 0
v_dot2_f32_bf16 v19, v92, v12, 0
v_dot2_f32_bf16 v16, v81, v13, v16
v_dot2_f32_bf16 v17, v85, v13, v17
v_dot2_f32_bf16 v18, v89, v13, v18
v_dot2_f32_bf16 v19, v93, v13, v19
v_dot2_f32_bf16 v16, v82, v14, v16
v_dot2_f32_bf16 v17, v86, v14, v17
v_dot2_f32_bf16 v18, v90, v14, v18
v_dot2_f32_bf16 v19, v94, v14, v19
v_dot2_f32_bf16 v16, v83, v15, v16
v_dot2_f32_bf16 v17, v87, v15, v17
v_dot2_f32_bf16 v18, v91, v15, v18
v_dot2_f32_bf16 v19, v95, v15, v19
buffer_load_dwordx4 v[80:83], v1, s[8:11], s56 offen offset:0 nt
buffer_load_dwordx4 v[84:87], v1, s[8:11], s56 offen offset:1024 nt
buffer_load_dwordx4 v[88:91], v1, s[8:11], s56 offen offset:2048 nt
buffer_load_dwordx4 v[92:95], v1, s[8:11], s56 offen offset:3072 nt
s_add_u32 s56, s56, 32768
v_add_f32_dpp v20, v16, v16 row_ror:8 row_mask:0xf bank_mask:0x3
v_add_f32_dpp v21, v17, v17 row_ror:8 row_mask:0xf bank_mask:0x3
s_nop 0
v_add_f32_dpp v20, v18, v18 row_ror:8 row_mask:0xf bank_mask:0xc
v_add_f32_dpp v21, v19, v19 row_ror:8 row_mask:0xf bank_mask:0xc
s_nop 0
v_add_f32_dpp v26, v20, v20 row_half_mirror row_mask:0xf bank_mask:0x5
s_nop 1
v_add_f32_dpp v26, v21, v21 row_half_mirror row_mask:0xf bank_mask:0xa
s_waitcnt vmcnt(12)
v_dot2_f32_bf16 v16, v96, v12, 0
v_dot2_f32_bf16 v17, v100, v12, 0
v_dot2_f32_bf16 v18, v104, v12, 0
v_dot2_f32_bf16 v19, v108, v12, 0
v_dot2_f32_bf16 v16, v97, v13, v16
v_dot2_f32_bf16 v17, v101, v13, v17
v_dot2_f32_bf16 v18, v105, v13, v18
v_dot2_f32_bf16 v19, v109, v13, v19
v_dot2_f32_bf16 v16, v98, v14, v16
v_dot2_f32_bf16 v17, v102, v14, v17
v_dot2_f32_bf16 v18, v106, v14, v18
v_dot2_f32_bf16 v19, v110, v14, v19
v_dot2_f32_bf16 v16, v99, v15, v16
v_dot2_f32_bf16 v17, v103, v15, v17
v_dot2_f32_bf16 v18, v107, v15, v18
v_dot2_f32_bf16 v19, v111, v15, v19
buffer_load_dwordx4 v[96:99], v1, s[8:11], s56 offen offset:0 nt
buffer_load_dwordx4 v[100:103], v1, s[8:11], s56 offen offset:1024 nt
buffer_load_dwordx4 v[104:107], v1, s[8:11], s56 offen offset:2048 nt
buffer_load_dwordx4 v[108:111], v1, s[8:11], s56 offen offset:3072 nt
s_add_u32 s56, s56, 32768
v_add_f32_dpp v20, v16, v16 row_ror:8 row_mask:0xf bank_mask:0x3
v_add_f32_dpp v21, v17, v17 row_ror:8 row_mask:0xf bank_mask:0x3
s_nop 0
v_add_f32_dpp v20, v18, v18 row_ror:8 row_mask:0xf bank_mask:0xc
v_add_f32_dpp v21, v19, v19 row_ror:8 row_mask:0xf bank_mask:0xc
s_nop 0
v_add_f32_dpp v27, v20, v20 row_half_mirror row_mask:0xf bank_mask:0x5
s_nop 1
v_add_f32_dpp v27, v21, v21 row_half_mirror row_mask:0xf bank_mask:0xa
v_add_f32_dpp v24, v24, v24 quad_perm:[2,3,0,1] row_mask:0xf bank_mask:0xf
v_add_f32_dpp v25, v25, v25 quad_perm:[2,3,0,1] row_mask:0xf bank_mask:0xf
v_add_f32_dpp v26, v26, v26 quad_perm:[2,3,0,1] row_mask:0xf bank_mask:0xf
v_add_f32_dpp v27, v27, v27 quad_perm:[2,3,0,1] row_mask:0xf bank_mask:0xf
v_cndmask_b32 v24, v24, v26, s[66:67]
v_cndmask_b32 v25, v25, v27, s[66:67]
s_nop 0
v_add_f32_dpp v24, v24, v24 quad_perm:[1,0,3,2] row_mask:0xf bank_mask:0xf
v_add_f32_dpp v25, v25, v25 quad_perm:[1,0,3,2] row_mask:0xf bank_mask:0xf
v_cndmask_b32 v45, v24, v25, s[68:69]
s_waitcnt vmcnt(12)
v_dot2_f32_bf16 v16, v48, v12, 0
v_dot2_f32_bf16 v17, v52, v12, 0
v_dot2_f32_bf16 v18, v56, v12, 0
v_dot2_f32_bf16 v19, v60, v12, 0
v_dot2_f32_bf16 v16, v49, v13, v16
v_dot2_f32_bf16 v17, v53, v13, v17
v_dot2_f32_bf16 v18, v57, v13, v18
v_dot2_f32_bf16 v19, v61, v13, v19
v_dot2_f32_bf16 v16, v50, v14, v16
v_dot2_f32_bf16 v17, v54, v14, v17
v_dot2_f32_bf16 v18, v58, v14, v18
v_dot2_f32_bf16 v19, v62, v14, v19
v_dot2_f32_bf16 v16, v51, v15, v16
v_dot2_f32_bf16 v17, v55, v15, v17
v_dot2_f32_bf16 v18, v59, v15, v18
v_dot2_f32_bf16 v19, v63, v15, v19
buffer_load_dwordx4 v[48:51], v1, s[8:11], s56 offen offset:0 nt
buffer_load_dwordx4 v[52:55], v1, s[8:11], s56 offen offset:1024 nt
buffer_load_dwordx4 v[56:59], v1, s[8:11], s56 offen offset:2048 nt
buffer_load_dwordx4 v[60:63], v1, s[8:11], s56 offen offset:3072 nt
s_add_u32 s56, s56, 32768
v_add_f32_dpp v20, v16, v16 row_ror:8 row_mask:0xf bank_mask:0x3
v_add_f32_dpp v21, v17, v17 row_ror:8 row_mask:0xf bank_mask:0x3
s_nop 0
v_add_f32_dpp v20, v18, v18 row_ror:8 row_mask:0xf bank_mask:0xc
v_add_f32_dpp v21, v19, v19 row_ror:8 row_mask:0xf bank_mask:0xc
s_nop 0
v_add_f32_dpp v24, v20, v20 row_half_mirror row_mask:0xf bank_mask:0x5
s_nop 1
v_add_f32_dpp v24, v21, v21 row_half_mirror row_mask:0xf bank_mask:0xa
s_waitcnt vmcnt(12)
v_dot2_f32_bf16 v16, v64, v12, 0
v_dot2_f32_bf16 v17, v68, v12, 0
v_dot2_f32_bf16 v18, v72, v12, 0
v_dot2_f32_bf16 v19, v76, v12, 0
v_dot2_f32_bf16 v16, v65, v13, v16
v_dot2_f32_bf16 v17, v69, v13, v17
v_dot2_f32_bf16 v18, v73, v13, v18
v_dot2_f32_bf16 v19, v77, v13, v19
v_dot2_f32_bf16 v16, v66, v14, v16
v_dot2_f32_bf16 v17, v70, v14, v17
v_dot2_f32_bf16 v18, v74, v14, v18
v_dot2_f32_bf16 v19, v78, v14, v19
v_dot2_f32_bf16 v16, v67, v15, v16
v_dot2_f32_bf16 v17, v71, v15, v17
v_dot2_f32_bf16 v18, v75, v15, v18
v_dot2_f32_bf16 v19, v79, v15, v19
buffer_load_dwordx4 v[64:67], v1, s[8:11], s56 offen offset:0 nt
buffer_load_dwordx4 v[68:71], v1, s[8:11], s56 offen offset:1024 nt
buffer_load_dwordx4 v[72:75], v1, s[8:11], s56 offen offset:2048 nt
buffer_load_dwordx4 v[76:79], v1, s[8:11], s56 offen offset:3072 nt
s_add_u32 s56, s56, 32768
v_add_f32_dpp v20, v16, v16 row_ror:8 row_mask:0xf bank_mask:0x3
v_add_f32_dpp v21, v17, v17 row_ror:8 row_mask:0xf bank_mask:0x3
s_nop 0
v_add_f32_dpp v20, v18, v18 row_ror:8 row_mask:0xf bank_mask:0xc
v_add_f32_dpp v21, v19, v19 row_ror:8 row_mask:0xf bank_mask:0xc
s_nop 0
v_add_f32_dpp v25, v20, v20 row_half_mirror row_mask:0xf bank_mask:0x5
s_nop 1
v_add_f32_dpp v25, v21, v21 row_half_mirror row_mask:0xf bank_mask:0xa
s_waitcnt vmcnt(12)
v_dot2_f32_bf16 v16, v80, v12, 0
v_dot2_f32_bf16 v17, v84, v12, 0
v_dot2_f32_bf16 v18, v88, v12, 0
v_dot2_f32_bf16 v19, v92, v12, 0
v_dot2_f32_bf16 v16, v81, v13, v16
v_dot2_f32_bf16 v17, v85, v13, v17
v_dot2_f32_bf16 v18, v89, v13, v18
v_dot2_f32_bf16 v19, v93, v13, v19
v_dot2_f32_bf16 v16, v82, v14, v16
v_dot2_f32_bf16 v17, v86, v14, v17
v_dot2_f32_bf16 v18, v90, v14, v18
v_dot2_f32_bf16 v19, v94, v14, v19
v_dot2_f32_bf16 v16, v83, v15, v16
v_dot2_f32_bf16 v17, v87, v15, v17
v_dot2_f32_bf16 v18, v91, v15, v18
v_dot2_f32_bf16 v19, v95, v15, v19
buffer_load_dwordx4 v[80:83], v1, s[8:11], s56 offen offset:0 nt
buffer_load_dwordx4 v[84:87], v1, s[8:11], s56 offen offset:1024 nt
buffer_load_dwordx4 v[88:91], v1, s[8:11], s56 offen offset:2048 nt
buffer_load_dwordx4 v[92:95], v1, s[8:11], s56 offen offset:3072 nt
s_add_u32 s56, s56, 32768
v_add_f32_dpp v20, v16, v16 row_ror:8 row_mask:0xf bank_mask:0x3
v_add_f32_dpp v21, v17, v17 row_ror:8 row_mask:0xf bank_mask:0x3
s_nop 0
v_add_f32_dpp v20, v18, v18 row_ror:8 row_mask:0xf bank_mask:0xc
v_add_f32_dpp v21, v19, v19 row_ror:8 row_mask:0xf bank_mask:0xc
s_nop 0
v_add_f32_dpp v26, v20, v20 row_half_mirror row_mask:0xf bank_mask:0x5
s_nop 1
v_add_f32_dpp v26, v21, v21 row_half_mirror row_mask:0xf bank_mask:0xa
s_waitcnt vmcnt(12)
v_dot2_f32_bf16 v16, v96, v12, 0
v_dot2_f32_bf16 v17, v100, v12, 0
v_dot2_f32_bf16 v18, v104, v12, 0
v_dot2_f32_bf16 v19, v108, v12, 0
v_dot2_f32_bf16 v16, v97, v13, v16
v_dot2_f32_bf16 v17, v101, v13, v17
v_dot2_f32_bf16 v18, v105, v13, v18
v_dot2_f32_bf16 v19, v109, v13, v19
v_dot2_f32_bf16 v16, v98, v14, v16
v_dot2_f32_bf16 v17, v102, v14, v17
v_dot2_f32_bf16 v18, v106, v14, v18
v_dot2_f32_bf16 v19, v110, v14, v19
v_dot2_f32_bf16 v16, v99, v15, v16
v_dot2_f32_bf16 v17, v103, v15, v17
v_dot2_f32_bf16 v18, v107, v15, v18
v_dot2_f32_bf16 v19, v111, v15, v19
buffer_load_dwordx4 v[96:99], v1, s[8:11], s56 offen offset:0 nt
buffer_load_dwordx4 v[100:103], v1, s[8:11], s56 offen offset:1024 nt
buffer_load_dwordx4 v[104:107], v1, s[8:11], s56 offen offset:2048 nt
buffer_load_dwordx4 v[108:111], v1, s[8:11], s56 offen offset:3072 nt
s_add_u32 s56, s56, 32768
v_add_f32_dpp v20, v16, v16 row_ror:8 row_mask:0xf bank_mask:0x3
v_add_f32_dpp v21, v17, v17 row_ror:8 row_mask:0xf bank_mask:0x3
s_nop 0
v_add_f32_dpp v20, v18, v18 row_ror:8 row_mask:0xf bank_mask:0xc
v_add_f32_dpp v21, v19, v19 row_ror:8 row_mask:0xf bank_mask:0xc
s_nop 0
v_add_f32_dpp v27, v20, v20 row_half_mirror row_mask:0xf bank_mask:0x5
s_nop 1
v_add_f32_dpp v27, v21, v21 row_half_mirror row_mask:0xf bank_mask:0xa
v_add_f32_dpp v24, v24, v24 quad_perm:[2,3,0,1] row_mask:0xf bank_mask:0xf
v_add_f32_dpp v25, v25, v25 quad_perm:[2,3,0,1] row_mask:0xf bank_mask:0xf
v_add_f32_dpp v26, v26, v26 quad_perm:[2,3,0,1] row_mask:0xf bank_mask:0xf
v_add_f32_dpp v27, v27, v27 quad_perm:[2,3,0,1] row_mask:0xf bank_mask:0xf
v_cndmask_b32 v24, v24, v26, s[66:67]
v_cndmask_b32 v25, v25, v27, s[66:67]
s_nop 0
v_add_f32_dpp v24, v24, v24 quad_perm:[1,0,3,2] row_mask:0xf bank_mask:0xf
v_add_f32_dpp v25, v25, v25 quad_perm:[1,0,3,2] row_mask:0xf bank_mask:0xf
v_cndmask_b32 v23, v24, v25, s[68:69]
v_mov_b32 v28, v29
v_mov_b32 v29, v30
v_mov_b32 v30, v31
v_cvt_pk_bf16_f32 v31, v45, v23
s_sub_u32 s55, s55, 1
s_cmp_lg_u32 s55, 0
s_cbranch_scc1 LOOP_68
buffer_store_dwordx4 v[28:31], v1, s[16:19], s72 offen offset:0 sc1
s_waitcnt vmcnt(13)
v_dot2_f32_bf16 v16, v48, v12, 0
v_dot2_f32_bf16 v17, v52, v12, 0
v_dot2_f32_bf16 v18, v56, v12, 0
v_dot2_f32_bf16 v19, v60, v12, 0
v_dot2_f32_bf16 v16, v49, v13, v16
v_dot2_f32_bf16 v17, v53, v13, v17
v_dot2_f32_bf16 v18, v57, v13, v18
v_dot2_f32_bf16 v19, v61, v13, v19
v_dot2_f32_bf16 v16, v50, v14, v16
v_dot2_f32_bf16 v17, v54, v14, v17
v_dot2_f32_bf16 v18, v58, v14, v18
v_dot2_f32_bf16 v19, v62, v14, v19
v_dot2_f32_bf16 v16, v51, v15, v16
v_dot2_f32_bf16 v17, v55, v15, v17
v_dot2_f32_bf16 v18, v59, v15, v18
v_dot2_f32_bf16 v19, v63, v15, v19
s_add_u32 s57, s77, 1179648
buffer_load_dwordx4 v[48:51], v1, s[8:11], s57 offen offset:0 nt
buffer_load_dwordx4 v[52:55], v1, s[8:11], s57 offen offset:1024 nt
buffer_load_dwordx4 v[56:59], v1, s[8:11], s57 offen offset:2048 nt
buffer_load_dwordx4 v[60:63], v1, s[8:11], s57 offen offset:3072 nt
v_add_f32_dpp v20, v16, v16 row_ror:8 row_mask:0xf bank_mask:0x3
v_add_f32_dpp v21, v17, v17 row_ror:8 row_mask:0xf bank_mask:0x3
s_nop 0
v_add_f32_dpp v20, v18, v18 row_ror:8 row_mask:0xf bank_mask:0xc
v_add_f32_dpp v21, v19, v19 row_ror:8 row_mask:0xf bank_mask:0xc
s_nop 0
v_add_f32_dpp v24, v20, v20 row_half_mirror row_mask:0xf bank_mask:0x5
s_nop 1
v_add_f32_dpp v24, v21, v21 row_half_mirror row_mask:0xf bank_mask:0xa
s_waitcnt vmcnt(13)
v_dot2_f32_bf16 v16, v64, v12, 0
v_dot2_f32_bf16 v17, v68, v12, 0
v_dot2_f32_bf16 v18, v72, v12, 0
v_dot2_f32_bf16 v19, v76, v12, 0
v_dot2_f32_bf16 v16, v65, v13, v16
v_dot2_f32_bf16 v17, v69, v13, v17
v_dot2_f32_bf16 v18, v73, v13, v18
v_dot2_f32_bf16 v19, v77, v13, v19
v_dot2_f32_bf16 v16, v66, v14, v16
v_dot2_f32_bf16 v17, v70, v14, v17
v_dot2_f32_bf16 v18, v74, v14, v18
v_dot2_f32_bf16 v19, v78, v14, v19
v_dot2_f32_bf16 v16, v67, v15, v16
v_dot2_f32_bf16 v17, v71, v15, v17
v_dot2_f32_bf16 v18, v75, v15, v18
v_dot2_f32_bf16 v19, v79, v15, v19
s_add_u32 s57, s77, 1212416
buffer_load_dwordx4 v[64:67], v1, s[8:11], s57 offen offset:0 nt
buffer_load_dwordx4 v[68:71], v1, s[8:11], s57 offen offset:1024 nt
buffer_load_dwordx4 v[72:75], v1, s[8:11], s57 offen offset:2048 nt
buffer_load_dwordx4 v[76:79], v1, s[8:11], s57 offen offset:3072 nt
v_add_f32_dpp v20, v16, v16 row_ror:8 row_mask:0xf bank_mask:0x3
v_add_f32_dpp v21, v17, v17 row_ror:8 row_mask:0xf bank_mask:0x3
s_nop 0
v_add_f32_dpp v20, v18, v18 row_ror:8 row_mask:0xf bank_mask:0xc
v_add_f32_dpp v21, v19, v19 row_ror:8 row_mask:0xf bank_mask:0xc
s_nop 0
v_add_f32_dpp v25, v20, v20 row_half_mirror row_mask:0xf bank_mask:0x5
s_nop 1
v_add_f32_dpp v25, v21, v21 row_half_mirror row_mask:0xf bank_mask:0xa
s_waitcnt vmcnt(13)
v_dot2_f32_bf16 v16, v80, v12, 0
v_dot2_f32_bf16 v17, v84, v12, 0
v_dot2_f32_bf16 v18, v88, v12, 0
v_dot2_f32_bf16 v19, v92, v12, 0
v_dot2_f32_bf16 v16, v81, v13, v16
v_dot2_f32_bf16 v17, v85, v13, v17
v_dot2_f32_bf16 v18, v89, v13, v18
v_dot2_f32_bf16 v19, v93, v13, v19
v_dot2_f32_bf16 v16, v82, v14, v16
v_dot2_f32_bf16 v17, v86, v14, v17
v_dot2_f32_bf16 v18, v90, v14, v18
v_dot2_f32_bf16 v19, v94, v14, v19
v_dot2_f32_bf16 v16, v83, v15, v16
v_dot2_f32_bf16 v17, v87, v15, v17
v_dot2_f32_bf16 v18, v91, v15, v18
v_dot2_f32_bf16 v19, v95, v15, v19
s_add_u32 s57, s77, 1245184
buffer_load_dwordx4 v[80:83], v1, s[8:11], s57 offen offset:0 nt
buffer_load_dwordx4 v[84:87], v1, s[8:11], s57 offen offset:1024 nt
buffer_load_dwordx4 v[88:91], v1, s[8:11], s57 offen offset:2048 nt
buffer_load_dwordx4 v[92:95], v1, s[8:11], s57 offen offset:3072 nt
v_add_f32_dpp v20, v16, v16 row_ror:8 row_mask:0xf bank_mask:0x3
v_add_f32_dpp v21, v17, v17 row_ror:8 row_mask:0xf bank_mask:0x3
s_nop 0
v_add_f32_dpp v20, v18, v18 row_ror:8 row_mask:0xf bank_mask:0xc
v_add_f32_dpp v21, v19, v19 row_ror:8 row_mask:0xf bank_mask:0xc
s_nop 0
v_add_f32_dpp v26, v20, v20 row_half_mirror row_mask:0xf bank_mask:0x5
s_nop 1
v_add_f32_dpp v26, v21, v21 row_half_mirror row_mask:0xf bank_mask:0xa
s_waitcnt vmcnt(13)
v_dot2_f32_bf16 v16, v96, v12, 0
v_dot2_f32_bf16 v17, v100, v12, 0
v_dot2_f32_bf16 v18, v104, v12, 0
v_dot2_f32_bf16 v19, v108, v12, 0
v_dot2_f32_bf16 v16, v97, v13, v16
v_dot2_f32_bf16 v17, v101, v13, v17
v_dot2_f32_bf16 v18, v105, v13, v18
v_dot2_f32_bf16 v19, v109, v13, v19
v_dot2_f32_bf16 v16, v98, v14, v16
v_dot2_f32_bf16 v17, v102, v14, v17
v_dot2_f32_bf16 v18, v106, v14, v18
v_dot2_f32_bf16 v19, v110, v14, v19
v_dot2_f32_bf16 v16, v99, v15, v16
v_dot2_f32_bf16 v17, v103, v15, v17
v_dot2_f32_bf16 v18, v107, v15, v18
v_dot2_f32_bf16 v19, v111, v15, v19
s_add_u32 s57, s77, 1277952
buffer_load_dwordx4 v[96:99], v1, s[8:11], s57 offen offset:0 nt
buffer_load_dwordx4 v[100:103], v1, s[8:11], s57 offen offset:1024 nt
buffer_load_dwordx4 v[104:107], v1, s[8:11], s57 offen offset:2048 nt
buffer_load_dwordx4 v[108:111], v1, s[8:11], s57 offen offset:3072 nt
v_add_f32_dpp v20, v16, v16 row_ror:8 row_mask:0xf bank_mask:0x3
v_add_f32_dpp v21, v17, v17 row_ror:8 row_mask:0xf bank_mask:0x3
s_nop 0
v_add_f32_dpp v20, v18, v18 row_ror:8 row_mask:0xf bank_mask:0xc
v_add_f32_dpp v21, v19, v19 row_ror:8 row_mask:0xf bank_mask:0xc
s_nop 0
v_add_f32_dpp v27, v20, v20 row_half_mirror row_mask:0xf bank_mask:0x5
s_nop 1
v_add_f32_dpp v27, v21, v21 row_half_mirror row_mask:0xf bank_mask:0xa
v_add_f32_dpp v24, v24, v24 quad_perm:[2,3,0,1] row_mask:0xf bank_mask:0xf
v_add_f32_dpp v25, v25, v25 quad_perm:[2,3,0,1] row_mask:0xf bank_mask:0xf
v_add_f32_dpp v26, v26, v26 quad_perm:[2,3,0,1] row_mask:0xf bank_mask:0xf
v_add_f32_dpp v27, v27, v27 quad_perm:[2,3,0,1] row_mask:0xf bank_mask:0xf
v_cndmask_b32 v24, v24, v26, s[66:67]
v_cndmask_b32 v25, v25, v27, s[66:67]
s_nop 0
v_add_f32_dpp v24, v24, v24 quad_perm:[1,0,3,2] row_mask:0xf bank_mask:0xf
v_add_f32_dpp v25, v25, v25 quad_perm:[1,0,3,2] row_mask:0xf bank_mask:0xf
v_cndmask_b32 v45, v24, v25, s[68:69]
s_waitcnt vmcnt(12)
v_dot2_f32_bf16 v16, v48, v12, 0
v_dot2_f32_bf16 v17, v52, v12, 0
v_dot2_f32_bf16 v18, v56, v12, 0
v_dot2_f32_bf16 v19, v60, v12, 0
v_dot2_f32_bf16 v16, v49, v13, v16
v_dot2_f32_bf16 v17, v53, v13, v17
v_dot2_f32_bf16 v18, v57, v13, v18
v_dot2_f32_bf16 v19, v61, v13, v19
v_dot2_f32_bf16 v16, v50, v14, v16
v_dot2_f32_bf16 v17, v54, v14, v17
v_dot2_f32_bf16 v18, v58, v14, v18
v_dot2_f32_bf16 v19, v62, v14, v19
v_dot2_f32_bf16 v16, v51, v15, v16
v_dot2_f32_bf16 v17, v55, v15, v17
v_dot2_f32_bf16 v18, v59, v15, v18
v_dot2_f32_bf16 v19, v63, v15, v19
s_add_u32 s57, s77, 1310720
buffer_load_dwordx4 v[48:51], v1, s[8:11], s57 offen offset:0 nt
buffer_load_dwordx4 v[52:55], v1, s[8:11], s57 offen offset:1024 nt
buffer_load_dwordx4 v[56:59], v1, s[8:11], s57 offen offset:2048 nt
buffer_load_dwordx4 v[60:63], v1, s[8:11], s57 offen offset:3072 nt
v_add_f32_dpp v20, v16, v16 row_ror:8 row_mask:0xf bank_mask:0x3
v_add_f32_dpp v21, v17, v17 row_ror:8 row_mask:0xf bank_mask:0x3
s_nop 0
v_add_f32_dpp v20, v18, v18 row_ror:8 row_mask:0xf bank_mask:0xc
v_add_f32_dpp v21, v19, v19 row_ror:8 row_mask:0xf bank_mask:0xc
s_nop 0
v_add_f32_dpp v24, v20, v20 row_half_mirror row_mask:0xf bank_mask:0x5
s_nop 1
v_add_f32_dpp v24, v21, v21 row_half_mirror row_mask:0xf bank_mask:0xa
s_waitcnt vmcnt(12)
v_dot2_f32_bf16 v16, v64, v12, 0
v_dot2_f32_bf16 v17, v68, v12, 0
v_dot2_f32_bf16 v18, v72, v12, 0
v_dot2_f32_bf16 v19, v76, v12, 0
v_dot2_f32_bf16 v16, v65, v13, v16
v_dot2_f32_bf16 v17, v69, v13, v17
v_dot2_f32_bf16 v18, v73, v13, v18
v_dot2_f32_bf16 v19, v77, v13, v19
v_dot2_f32_bf16 v16, v66, v14, v16
v_dot2_f32_bf16 v17, v70, v14, v17
v_dot2_f32_bf16 v18, v74, v14, v18
v_dot2_f32_bf16 v19, v78, v14, v19
v_dot2_f32_bf16 v16, v67, v15, v16
v_dot2_f32_bf16 v17, v71, v15, v17
v_dot2_f32_bf16 v18, v75, v15, v18
v_dot2_f32_bf16 v19, v79, v15, v19
s_add_u32 s57, s77, 1343488
buffer_load_dwordx4 v[64:67], v1, s[8:11], s57 offen offset:0 nt
buffer_load_dwordx4 v[68:71], v1, s[8:11], s57 offen offset:1024 nt
buffer_load_dwordx4 v[72:75], v1, s[8:11], s57 offen offset:2048 nt
buffer_load_dwordx4 v[76:79], v1, s[8:11], s57 offen offset:3072 nt
v_add_f32_dpp v20, v16, v16 row_ror:8 row_mask:0xf bank_mask:0x3
v_add_f32_dpp v21, v17, v17 row_ror:8 row_mask:0xf bank_mask:0x3
s_nop 0
v_add_f32_dpp v20, v18, v18 row_ror:8 row_mask:0xf bank_mask:0xc
v_add_f32_dpp v21, v19, v19 row_ror:8 row_mask:0xf bank_mask:0xc
s_nop 0
v_add_f32_dpp v25, v20, v20 row_half_mirror row_mask:0xf bank_mask:0x5
s_nop 1
v_add_f32_dpp v25, v21, v21 row_half_mirror row_mask:0xf bank_mask:0xa
s_waitcnt vmcnt(12)
v_dot2_f32_bf16 v16, v80, v12, 0
v_dot2_f32_bf16 v17, v84, v12, 0
v_dot2_f32_bf16 v18, v88, v12, 0
v_dot2_f32_bf16 v19, v92, v12, 0
v_dot2_f32_bf16 v16, v81, v13, v16
v_dot2_f32_bf16 v17, v85, v13, v17
v_dot2_f32_bf16 v18, v89, v13, v18
v_dot2_f32_bf16 v19, v93, v13, v19
v_dot2_f32_bf16 v16, v82, v14, v16
v_dot2_f32_bf16 v17, v86, v14, v17
v_dot2_f32_bf16 v18, v90, v14, v18
v_dot2_f32_bf16 v19, v94, v14, v19
v_dot2_f32_bf16 v16, v83, v15, v16
v_dot2_f32_bf16 v17, v87, v15, v17
v_dot2_f32_bf16 v18, v91, v15, v18
v_dot2_f32_bf16 v19, v95, v15, v19
s_add_u32 s57, s77, 1376256
buffer_load_dwordx4 v[80:83], v1, s[8:11], s57 offen offset:0 nt
buffer_load_dwordx4 v[84:87], v1, s[8:11], s57 offen offset:1024 nt
buffer_load_dwordx4 v[88:91], v1, s[8:11], s57 offen offset:2048 nt
buffer_load_dwordx4 v[92:95], v1, s[8:11], s57 offen offset:3072 nt
v_add_f32_dpp v20, v16, v16 row_ror:8 row_mask:0xf bank_mask:0x3
v_add_f32_dpp v21, v17, v17 row_ror:8 row_mask:0xf bank_mask:0x3
s_nop 0
v_add_f32_dpp v20, v18, v18 row_ror:8 row_mask:0xf bank_mask:0xc
v_add_f32_dpp v21, v19, v19 row_ror:8 row_mask:0xf bank_mask:0xc
s_nop 0
v_add_f32_dpp v26, v20, v20 row_half_mirror row_mask:0xf bank_mask:0x5
s_nop 1
v_add_f32_dpp v26, v21, v21 row_half_mirror row_mask:0xf bank_mask:0xa
s_waitcnt vmcnt(12)
v_dot2_f32_bf16 v16, v96, v12, 0
v_dot2_f32_bf16 v17, v100, v12, 0
v_dot2_f32_bf16 v18, v104, v12, 0
v_dot2_f32_bf16 v19, v108, v12, 0
v_dot2_f32_bf16 v16, v97, v13, v16
v_dot2_f32_bf16 v17, v101, v13, v17
v_dot2_f32_bf16 v18, v105, v13, v18
v_dot2_f32_bf16 v19, v109, v13, v19
v_dot2_f32_bf16 v16, v98, v14, v16
v_dot2_f32_bf16 v17, v102, v14, v17
v_dot2_f32_bf16 v18, v106, v14, v18
v_dot2_f32_bf16 v19, v110, v14, v19
v_dot2_f32_bf16 v16, v99, v15, v16
v_dot2_f32_bf16 v17, v103, v15, v17
v_dot2_f32_bf16 v18, v107, v15, v18
v_dot2_f32_bf16 v19, v111, v15, v19
s_add_u32 s57, s77, 1409024
buffer_load_dwordx4 v[96:99], v1, s[8:11], s57 offen offset:0 nt
buffer_load_dwordx4 v[100:103], v1, s[8:11], s57 offen offset:1024 nt
buffer_load_dwordx4 v[104:107], v1, s[8:11], s57 offen offset:2048 nt
buffer_load_dwordx4 v[108:111], v1, s[8:11], s57 offen offset:3072 nt
v_add_f32_dpp v20, v16, v16 row_ror:8 row_mask:0xf bank_mask:0x3
v_add_f32_dpp v21, v17, v17 row_ror:8 row_mask:0xf bank_mask:0x3
s_nop 0
v_add_f32_dpp v20, v18, v18 row_ror:8 row_mask:0xf bank_mask:0xc
v_add_f32_dpp v21, v19, v19 row_ror:8 row_mask:0xf bank_mask:0xc
s_nop 0
v_add_f32_dpp v27, v20, v20 row_half_mirror row_mask:0xf bank_mask:0x5
s_nop 1
v_add_f32_dpp v27, v21, v21 row_half_mirror row_mask:0xf bank_mask:0xa
v_add_f32_dpp v24, v24, v24 quad_perm:[2,3,0,1] row_mask:0xf bank_mask:0xf
v_add_f32_dpp v25, v25, v25 quad_perm:[2,3,0,1] row_mask:0xf bank_mask:0xf
v_add_f32_dpp v26, v26, v26 quad_perm:[2,3,0,1] row_mask:0xf bank_mask:0xf
v_add_f32_dpp v27, v27, v27 quad_perm:[2,3,0,1] row_mask:0xf bank_mask:0xf
v_cndmask_b32 v24, v24, v26, s[66:67]
v_cndmask_b32 v25, v25, v27, s[66:67]
s_nop 0
v_add_f32_dpp v24, v24, v24 quad_perm:[1,0,3,2] row_mask:0xf bank_mask:0xf
v_add_f32_dpp v25, v25, v25 quad_perm:[1,0,3,2] row_mask:0xf bank_mask:0xf
v_cndmask_b32 v23, v24, v25, s[68:69]
v_mov_b32 v28, v29
v_mov_b32 v29, v30
v_mov_b32 v30, v31
v_cvt_pk_bf16_f32 v31, v45, v23
s_barrier
s_cmp_lg_u32 s3, 3
s_cbranch_scc1 SK_69
v_mov_b32 v24, 3
v_mov_b32 v25, 3
v_mov_b32 v26, 3
v_mov_b32 v27, 3
s_lshl_b32 s57, s2, 7
s_add_u32 s57, s57, 2097152
s_mov_b64 exec, 0xff
buffer_store_dwordx4 v[24:27], v1, s[16:19], s57 offen sc1
s_mov_b64 exec, -1
SK_69:
s_add_u32 s56, s77, 1441792
s_mov_b32 s55, 2
LOOP_70:
s_waitcnt vmcnt(12)
v_dot2_f32_bf16 v16, v48, v12, 0
v_dot2_f32_bf16 v17, v52, v12, 0
v_dot2_f32_bf16 v18, v56, v12, 0
v_dot2_f32_bf16 v19, v60, v12, 0
v_dot2_f32_bf16 v16, v49, v13, v16
v_dot2_f32_bf16 v17, v53, v13, v17
v_dot2_f32_bf16 v18, v57, v13, v18
v_dot2_f32_bf16 v19, v61, v13, v19
v_dot2_f32_bf16 v16, v50, v14, v16
v_dot2_f32_bf16 v17, v54, v14, v17
v_dot2_f32_bf16 v18, v58, v14, v18
v_dot2_f32_bf16 v19, v62, v14, v19
v_dot2_f32_bf16 v16, v51, v15, v16
v_dot2_f32_bf16 v17, v55, v15, v17
v_dot2_f32_bf16 v18, v59, v15, v18
v_dot2_f32_bf16 v19, v63, v15, v19
buffer_load_dwordx4 v[48:51], v1, s[8:11], s56 offen offset:0 nt
buffer_load_dwordx4 v[52:55], v1, s[8:11], s56 offen offset:1024 nt
buffer_load_dwordx4 v[56:59], v1, s[8:11], s56 offen offset:2048 nt
buffer_load_dwordx4 v[60:63], v1, s[8:11], s56 offen offset:3072 nt
s_add_u32 s56, s56, 32768
v_add_f32_dpp v20, v16, v16 row_ror:8 row_mask:0xf bank_mask:0x3
v_add_f32_dpp v21, v17, v17 row_ror:8 row_mask:0xf bank_mask:0x3
s_nop 0
v_add_f32_dpp v20, v18, v18 row_ror:8 row_mask:0xf bank_mask:0xc
v_add_f32_dpp v21, v19, v19 row_ror:8 row_mask:0xf bank_mask:0xc
s_nop 0
v_add_f32_dpp v24, v20, v20 row_half_mirror row_mask:0xf bank_mask:0x5
s_nop 1
v_add_f32_dpp v24, v21, v21 row_half_mirror row_mask:0xf bank_mask:0xa
s_waitcnt vmcnt(12)
v_dot2_f32_bf16 v16, v64, v12, 0
v_dot2_f32_bf16 v17, v68, v12, 0
v_dot2_f32_bf16 v18, v72, v12, 0
v_dot2_f32_bf16 v19, v76, v12, 0
v_dot2_f32_bf16 v16, v65, v13, v16
v_dot2_f32_bf16 v17, v69, v13, v17
v_dot2_f32_bf16 v18, v73, v13, v18
v_dot2_f32_bf16 v19, v77, v13, v19
v_dot2_f32_bf16 v16, v66, v14, v16
v_dot2_f32_bf16 v17, v70, v14, v17
v_dot2_f32_bf16 v18, v74, v14, v18
v_dot2_f32_bf16 v19, v78, v14, v19
v_dot2_f32_bf16 v16, v67, v15, v16
v_dot2_f32_bf16 v17, v71, v15, v17
v_dot2_f32_bf16 v18, v75, v15, v18
v_dot2_f32_bf16 v19, v79, v15, v19
buffer_load_dwordx4 v[64:67], v1, s[8:11], s56 offen offset:0 nt
buffer_load_dwordx4 v[68:71], v1, s[8:11], s56 offen offset:1024 nt
buffer_load_dwordx4 v[72:75], v1, s[8:11], s56 offen offset:2048 nt
buffer_load_dwordx4 v[76:79], v1, s[8:11], s56 offen offset:3072 nt
s_add_u32 s56, s56, 32768
v_add_f32_dpp v20, v16, v16 row_ror:8 row_mask:0xf bank_mask:0x3
v_add_f32_dpp v21, v17, v17 row_ror:8 row_mask:0xf bank_mask:0x3
s_nop 0
v_add_f32_dpp v20, v18, v18 row_ror:8 row_mask:0xf bank_mask:0xc
v_add_f32_dpp v21, v19, v19 row_ror:8 row_mask:0xf bank_mask:0xc
s_nop 0
v_add_f32_dpp v25, v20, v20 row_half_mirror row_mask:0xf bank_mask:0x5
s_nop 1
v_add_f32_dpp v25, v21, v21 row_half_mirror row_mask:0xf bank_mask:0xa
s_waitcnt vmcnt(12)
v_dot2_f32_bf16 v16, v80, v12, 0
v_dot2_f32_bf16 v17, v84, v12, 0
v_dot2_f32_bf16 v18, v88, v12, 0
v_dot2_f32_bf16 v19, v92, v12, 0
v_dot2_f32_bf16 v16, v81, v13, v16
v_dot2_f32_bf16 v17, v85, v13, v17
v_dot2_f32_bf16 v18, v89, v13, v18
v_dot2_f32_bf16 v19, v93, v13, v19
v_dot2_f32_bf16 v16, v82, v14, v16
v_dot2_f32_bf16 v17, v86, v14, v17
v_dot2_f32_bf16 v18, v90, v14, v18
v_dot2_f32_bf16 v19, v94, v14, v19
v_dot2_f32_bf16 v16, v83, v15, v16
v_dot2_f32_bf16 v17, v87, v15, v17
v_dot2_f32_bf16 v18, v91, v15, v18
v_dot2_f32_bf16 v19, v95, v15, v19
buffer_load_dwordx4 v[80:83], v1, s[8:11], s56 offen offset:0 nt
buffer_load_dwordx4 v[84:87], v1, s[8:11], s56 offen offset:1024 nt
buffer_load_dwordx4 v[88:91], v1, s[8:11], s56 offen offset:2048 nt
buffer_load_dwordx4 v[92:95], v1, s[8:11], s56 offen offset:3072 nt
s_add_u32 s56, s56, 32768
v_add_f32_dpp v20, v16, v16 row_ror:8 row_mask:0xf bank_mask:0x3
v_add_f32_dpp v21, v17, v17 row_ror:8 row_mask:0xf bank_mask:0x3
s_nop 0
v_add_f32_dpp v20, v18, v18 row_ror:8 row_mask:0xf bank_mask:0xc
v_add_f32_dpp v21, v19, v19 row_ror:8 row_mask:0xf bank_mask:0xc
s_nop 0
v_add_f32_dpp v26, v20, v20 row_half_mirror row_mask:0xf bank_mask:0x5
s_nop 1
v_add_f32_dpp v26, v21, v21 row_half_mirror row_mask:0xf bank_mask:0xa
s_waitcnt vmcnt(12)
v_dot2_f32_bf16 v16, v96, v12, 0
v_dot2_f32_bf16 v17, v100, v12, 0
v_dot2_f32_bf16 v18, v104, v12, 0
v_dot2_f32_bf16 v19, v108, v12, 0
v_dot2_f32_bf16 v16, v97, v13, v16
v_dot2_f32_bf16 v17, v101, v13, v17
v_dot2_f32_bf16 v18, v105, v13, v18
v_dot2_f32_bf16 v19, v109, v13, v19
v_dot2_f32_bf16 v16, v98, v14, v16
v_dot2_f32_bf16 v17, v102, v14, v17
v_dot2_f32_bf16 v18, v106, v14, v18
v_dot2_f32_bf16 v19, v110, v14, v19
v_dot2_f32_bf16 v16, v99, v15, v16
v_dot2_f32_bf16 v17, v103, v15, v17
v_dot2_f32_bf16 v18, v107, v15, v18
v_dot2_f32_bf16 v19, v111, v15, v19
buffer_load_dwordx4 v[96:99], v1, s[8:11], s56 offen offset:0 nt
buffer_load_dwordx4 v[100:103], v1, s[8:11], s56 offen offset:1024 nt
buffer_load_dwordx4 v[104:107], v1, s[8:11], s56 offen offset:2048 nt
buffer_load_dwordx4 v[108:111], v1, s[8:11], s56 offen offset:3072 nt
s_add_u32 s56, s56, 32768
v_add_f32_dpp v20, v16, v16 row_ror:8 row_mask:0xf bank_mask:0x3
v_add_f32_dpp v21, v17, v17 row_ror:8 row_mask:0xf bank_mask:0x3
s_nop 0
v_add_f32_dpp v20, v18, v18 row_ror:8 row_mask:0xf bank_mask:0xc
v_add_f32_dpp v21, v19, v19 row_ror:8 row_mask:0xf bank_mask:0xc
s_nop 0
v_add_f32_dpp v27, v20, v20 row_half_mirror row_mask:0xf bank_mask:0x5
s_nop 1
v_add_f32_dpp v27, v21, v21 row_half_mirror row_mask:0xf bank_mask:0xa
v_add_f32_dpp v24, v24, v24 quad_perm:[2,3,0,1] row_mask:0xf bank_mask:0xf
v_add_f32_dpp v25, v25, v25 quad_perm:[2,3,0,1] row_mask:0xf bank_mask:0xf
v_add_f32_dpp v26, v26, v26 quad_perm:[2,3,0,1] row_mask:0xf bank_mask:0xf
v_add_f32_dpp v27, v27, v27 quad_perm:[2,3,0,1] row_mask:0xf bank_mask:0xf
v_cndmask_b32 v24, v24, v26, s[66:67]
v_cndmask_b32 v25, v25, v27, s[66:67]
s_nop 0
v_add_f32_dpp v24, v24, v24 quad_perm:[1,0,3,2] row_mask:0xf bank_mask:0xf
v_add_f32_dpp v25, v25, v25 quad_perm:[1,0,3,2] row_mask:0xf bank_mask:0xf
v_cndmask_b32 v45, v24, v25, s[68:69]
s_waitcnt vmcnt(12)
v_dot2_f32_bf16 v16, v48, v12, 0
v_dot2_f32_bf16 v17, v52, v12, 0
v_dot2_f32_bf16 v18, v56, v12, 0
v_dot2_f32_bf16 v19, v60, v12, 0
v_dot2_f32_bf16 v16, v49, v13, v16
v_dot2_f32_bf16 v17, v53, v13, v17
v_dot2_f32_bf16 v18, v57, v13, v18
v_dot2_f32_bf16 v19, v61, v13, v19
v_dot2_f32_bf16 v16, v50, v14, v16
v_dot2_f32_bf16 v17, v54, v14, v17
v_dot2_f32_bf16 v18, v58, v14, v18
v_dot2_f32_bf16 v19, v62, v14, v19
v_dot2_f32_bf16 v16, v51, v15, v16
v_dot2_f32_bf16 v17, v55, v15, v17
v_dot2_f32_bf16 v18, v59, v15, v18
v_dot2_f32_bf16 v19, v63, v15, v19
buffer_load_dwordx4 v[48:51], v1, s[8:11], s56 offen offset:0 nt
buffer_load_dwordx4 v[52:55], v1, s[8:11], s56 offen offset:1024 nt
buffer_load_dwordx4 v[56:59], v1, s[8:11], s56 offen offset:2048 nt
buffer_load_dwordx4 v[60:63], v1, s[8:11], s56 offen offset:3072 nt
s_add_u32 s56, s56, 32768
v_add_f32_dpp v20, v16, v16 row_ror:8 row_mask:0xf bank_mask:0x3
v_add_f32_dpp v21, v17, v17 row_ror:8 row_mask:0xf bank_mask:0x3
s_nop 0
v_add_f32_dpp v20, v18, v18 row_ror:8 row_mask:0xf bank_mask:0xc
v_add_f32_dpp v21, v19, v19 row_ror:8 row_mask:0xf bank_mask:0xc
s_nop 0
v_add_f32_dpp v24, v20, v20 row_half_mirror row_mask:0xf bank_mask:0x5
s_nop 1
v_add_f32_dpp v24, v21, v21 row_half_mirror row_mask:0xf bank_mask:0xa
s_waitcnt vmcnt(12)
v_dot2_f32_bf16 v16, v64, v12, 0
v_dot2_f32_bf16 v17, v68, v12, 0
v_dot2_f32_bf16 v18, v72, v12, 0
v_dot2_f32_bf16 v19, v76, v12, 0
v_dot2_f32_bf16 v16, v65, v13, v16
v_dot2_f32_bf16 v17, v69, v13, v17
v_dot2_f32_bf16 v18, v73, v13, v18
v_dot2_f32_bf16 v19, v77, v13, v19
v_dot2_f32_bf16 v16, v66, v14, v16
v_dot2_f32_bf16 v17, v70, v14, v17
v_dot2_f32_bf16 v18, v74, v14, v18
v_dot2_f32_bf16 v19, v78, v14, v19
v_dot2_f32_bf16 v16, v67, v15, v16
v_dot2_f32_bf16 v17, v71, v15, v17
v_dot2_f32_bf16 v18, v75, v15, v18
v_dot2_f32_bf16 v19, v79, v15, v19
buffer_load_dwordx4 v[64:67], v1, s[8:11], s56 offen offset:0 nt
buffer_load_dwordx4 v[68:71], v1, s[8:11], s56 offen offset:1024 nt
buffer_load_dwordx4 v[72:75], v1, s[8:11], s56 offen offset:2048 nt
buffer_load_dwordx4 v[76:79], v1, s[8:11], s56 offen offset:3072 nt
s_add_u32 s56, s56, 32768
v_add_f32_dpp v20, v16, v16 row_ror:8 row_mask:0xf bank_mask:0x3
v_add_f32_dpp v21, v17, v17 row_ror:8 row_mask:0xf bank_mask:0x3
s_nop 0
v_add_f32_dpp v20, v18, v18 row_ror:8 row_mask:0xf bank_mask:0xc
v_add_f32_dpp v21, v19, v19 row_ror:8 row_mask:0xf bank_mask:0xc
s_nop 0
v_add_f32_dpp v25, v20, v20 row_half_mirror row_mask:0xf bank_mask:0x5
s_nop 1
v_add_f32_dpp v25, v21, v21 row_half_mirror row_mask:0xf bank_mask:0xa
s_waitcnt vmcnt(12)
v_dot2_f32_bf16 v16, v80, v12, 0
v_dot2_f32_bf16 v17, v84, v12, 0
v_dot2_f32_bf16 v18, v88, v12, 0
v_dot2_f32_bf16 v19, v92, v12, 0
v_dot2_f32_bf16 v16, v81, v13, v16
v_dot2_f32_bf16 v17, v85, v13, v17
v_dot2_f32_bf16 v18, v89, v13, v18
v_dot2_f32_bf16 v19, v93, v13, v19
v_dot2_f32_bf16 v16, v82, v14, v16
v_dot2_f32_bf16 v17, v86, v14, v17
v_dot2_f32_bf16 v18, v90, v14, v18
v_dot2_f32_bf16 v19, v94, v14, v19
v_dot2_f32_bf16 v16, v83, v15, v16
v_dot2_f32_bf16 v17, v87, v15, v17
v_dot2_f32_bf16 v18, v91, v15, v18
v_dot2_f32_bf16 v19, v95, v15, v19
buffer_load_dwordx4 v[80:83], v1, s[8:11], s56 offen offset:0 nt
buffer_load_dwordx4 v[84:87], v1, s[8:11], s56 offen offset:1024 nt
buffer_load_dwordx4 v[88:91], v1, s[8:11], s56 offen offset:2048 nt
buffer_load_dwordx4 v[92:95], v1, s[8:11], s56 offen offset:3072 nt
s_add_u32 s56, s56, 32768
v_add_f32_dpp v20, v16, v16 row_ror:8 row_mask:0xf bank_mask:0x3
v_add_f32_dpp v21, v17, v17 row_ror:8 row_mask:0xf bank_mask:0x3
s_nop 0
v_add_f32_dpp v20, v18, v18 row_ror:8 row_mask:0xf bank_mask:0xc
v_add_f32_dpp v21, v19, v19 row_ror:8 row_mask:0xf bank_mask:0xc
s_nop 0
v_add_f32_dpp v26, v20, v20 row_half_mirror row_mask:0xf bank_mask:0x5
s_nop 1
v_add_f32_dpp v26, v21, v21 row_half_mirror row_mask:0xf bank_mask:0xa
s_waitcnt vmcnt(12)
v_dot2_f32_bf16 v16, v96, v12, 0
v_dot2_f32_bf16 v17, v100, v12, 0
v_dot2_f32_bf16 v18, v104, v12, 0
v_dot2_f32_bf16 v19, v108, v12, 0
v_dot2_f32_bf16 v16, v97, v13, v16
v_dot2_f32_bf16 v17, v101, v13, v17
v_dot2_f32_bf16 v18, v105, v13, v18
v_dot2_f32_bf16 v19, v109, v13, v19
v_dot2_f32_bf16 v16, v98, v14, v16
v_dot2_f32_bf16 v17, v102, v14, v17
v_dot2_f32_bf16 v18, v106, v14, v18
v_dot2_f32_bf16 v19, v110, v14, v19
v_dot2_f32_bf16 v16, v99, v15, v16
v_dot2_f32_bf16 v17, v103, v15, v17
v_dot2_f32_bf16 v18, v107, v15, v18
v_dot2_f32_bf16 v19, v111, v15, v19
buffer_load_dwordx4 v[96:99], v1, s[8:11], s56 offen offset:0 nt
buffer_load_dwordx4 v[100:103], v1, s[8:11], s56 offen offset:1024 nt
buffer_load_dwordx4 v[104:107], v1, s[8:11], s56 offen offset:2048 nt
buffer_load_dwordx4 v[108:111], v1, s[8:11], s56 offen offset:3072 nt
s_add_u32 s56, s56, 32768
v_add_f32_dpp v20, v16, v16 row_ror:8 row_mask:0xf bank_mask:0x3
v_add_f32_dpp v21, v17, v17 row_ror:8 row_mask:0xf bank_mask:0x3
s_nop 0
v_add_f32_dpp v20, v18, v18 row_ror:8 row_mask:0xf bank_mask:0xc
v_add_f32_dpp v21, v19, v19 row_ror:8 row_mask:0xf bank_mask:0xc
s_nop 0
v_add_f32_dpp v27, v20, v20 row_half_mirror row_mask:0xf bank_mask:0x5
s_nop 1
v_add_f32_dpp v27, v21, v21 row_half_mirror row_mask:0xf bank_mask:0xa
v_add_f32_dpp v24, v24, v24 quad_perm:[2,3,0,1] row_mask:0xf bank_mask:0xf
v_add_f32_dpp v25, v25, v25 quad_perm:[2,3,0,1] row_mask:0xf bank_mask:0xf
v_add_f32_dpp v26, v26, v26 quad_perm:[2,3,0,1] row_mask:0xf bank_mask:0xf
v_add_f32_dpp v27, v27, v27 quad_perm:[2,3,0,1] row_mask:0xf bank_mask:0xf
v_cndmask_b32 v24, v24, v26, s[66:67]
v_cndmask_b32 v25, v25, v27, s[66:67]
s_nop 0
v_add_f32_dpp v24, v24, v24 quad_perm:[1,0,3,2] row_mask:0xf bank_mask:0xf
v_add_f32_dpp v25, v25, v25 quad_perm:[1,0,3,2] row_mask:0xf bank_mask:0xf
v_cndmask_b32 v23, v24, v25, s[68:69]
v_mov_b32 v28, v29
v_mov_b32 v29, v30
v_mov_b32 v30, v31
v_cvt_pk_bf16_f32 v31, v45, v23
s_sub_u32 s55, s55, 1
s_cmp_lg_u32 s55, 0
s_cbranch_scc1 LOOP_70
v_mov_b32 v23, v41
s_waitcnt vmcnt(12)
v_dot2_f32_bf16 v16, v48, v12, 0
v_dot2_f32_bf16 v17, v52, v12, 0
v_dot2_f32_bf16 v18, v56, v12, 0
v_dot2_f32_bf16 v19, v60, v12, 0
v_dot2_f32_bf16 v16, v49, v13, v16
v_dot2_f32_bf16 v17, v53, v13, v17
v_dot2_f32_bf16 v18, v57, v13, v18
v_dot2_f32_bf16 v19, v61, v13, v19
v_dot2_f32_bf16 v16, v50, v14, v16
v_dot2_f32_bf16 v17, v54, v14, v17
v_dot2_f32_bf16 v18, v58, v14, v18
v_dot2_f32_bf16 v19, v62, v14, v19
v_dot2_f32_bf16 v16, v51, v15, v16
v_dot2_f32_bf16 v17, v55, v15, v17
v_dot2_f32_bf16 v18, v59, v15, v18
v_dot2_f32_bf16 v19, v63, v15, v19
s_add_u32 s57, s61, 0
buffer_load_dwordx4 v[48:51], v1, s[8:11], s57 offen offset:0 nt
buffer_load_dwordx4 v[52:55], v1, s[8:11], s57 offen offset:1024 nt
buffer_load_dwordx4 v[56:59], v1, s[8:11], s57 offen offset:2048 nt
buffer_load_dwordx4 v[60:63], v1, s[8:11], s57 offen offset:3072 nt
v_add_f32_dpp v20, v16, v16 row_ror:8 row_mask:0xf bank_mask:0x3
v_add_f32_dpp v21, v17, v17 row_ror:8 row_mask:0xf bank_mask:0x3
s_nop 0
v_add_f32_dpp v20, v18, v18 row_ror:8 row_mask:0xf bank_mask:0xc
v_add_f32_dpp v21, v19, v19 row_ror:8 row_mask:0xf bank_mask:0xc
s_nop 0
v_add_f32_dpp v24, v20, v20 row_half_mirror row_mask:0xf bank_mask:0x5
s_nop 1
v_add_f32_dpp v24, v21, v21 row_half_mirror row_mask:0xf bank_mask:0xa
s_waitcnt vmcnt(12)
v_dot2_f32_bf16 v16, v64, v12, 0
v_dot2_f32_bf16 v17, v68, v12, 0
v_dot2_f32_bf16 v18, v72, v12, 0
v_dot2_f32_bf16 v19, v76, v12, 0
v_dot2_f32_bf16 v16, v65, v13, v16
v_dot2_f32_bf16 v17, v69, v13, v17
v_dot2_f32_bf16 v18, v73, v13, v18
v_dot2_f32_bf16 v19, v77, v13, v19
v_dot2_f32_bf16 v16, v66, v14, v16
v_dot2_f32_bf16 v17, v70, v14, v17
v_dot2_f32_bf16 v18, v74, v14, v18
v_dot2_f32_bf16 v19, v78, v14, v19
v_dot2_f32_bf16 v16, v67, v15, v16
v_dot2_f32_bf16 v17, v71, v15, v17
v_dot2_f32_bf16 v18, v75, v15, v18
v_dot2_f32_bf16 v19, v79, v15, v19
s_add_u32 s57, s61, 32768
buffer_load_dwordx4 v[64:67], v1, s[8:11], s57 offen offset:0 nt
buffer_load_dwordx4 v[68:71], v1, s[8:11], s57 offen offset:1024 nt
buffer_load_dwordx4 v[72:75], v1, s[8:11], s57 offen offset:2048 nt
buffer_load_dwordx4 v[76:79], v1, s[8:11], s57 offen offset:3072 nt
v_add_f32_dpp v20, v16, v16 row_ror:8 row_mask:0xf bank_mask:0x3
v_add_f32_dpp v21, v17, v17 row_ror:8 row_mask:0xf bank_mask:0x3
s_nop 0
v_add_f32_dpp v20, v18, v18 row_ror:8 row_mask:0xf bank_mask:0xc
v_add_f32_dpp v21, v19, v19 row_ror:8 row_mask:0xf bank_mask:0xc
s_nop 0
v_add_f32_dpp v25, v20, v20 row_half_mirror row_mask:0xf bank_mask:0x5
s_nop 1
v_add_f32_dpp v25, v21, v21 row_half_mirror row_mask:0xf bank_mask:0xa
s_waitcnt vmcnt(12)
v_dot2_f32_bf16 v16, v80, v12, 0
v_dot2_f32_bf16 v17, v84, v12, 0
v_dot2_f32_bf16 v18, v88, v12, 0
v_dot2_f32_bf16 v19, v92, v12, 0
v_dot2_f32_bf16 v16, v81, v13, v16
v_dot2_f32_bf16 v17, v85, v13, v17
v_dot2_f32_bf16 v18, v89, v13, v18
v_dot2_f32_bf16 v19, v93, v13, v19
v_dot2_f32_bf16 v16, v82, v14, v16
v_dot2_f32_bf16 v17, v86, v14, v17
v_dot2_f32_bf16 v18, v90, v14, v18
v_dot2_f32_bf16 v19, v94, v14, v19
v_dot2_f32_bf16 v16, v83, v15, v16
v_dot2_f32_bf16 v17, v87, v15, v17
v_dot2_f32_bf16 v18, v91, v15, v18
v_dot2_f32_bf16 v19, v95, v15, v19
s_add_u32 s57, s61, 65536
buffer_load_dwordx4 v[80:83], v1, s[8:11], s57 offen offset:0 nt
buffer_load_dwordx4 v[84:87], v1, s[8:11], s57 offen offset:1024 nt
buffer_load_dwordx4 v[88:91], v1, s[8:11], s57 offen offset:2048 nt
buffer_load_dwordx4 v[92:95], v1, s[8:11], s57 offen offset:3072 nt
v_add_f32_dpp v20, v16, v16 row_ror:8 row_mask:0xf bank_mask:0x3
v_add_f32_dpp v21, v17, v17 row_ror:8 row_mask:0xf bank_mask:0x3
s_nop 0
v_add_f32_dpp v20, v18, v18 row_ror:8 row_mask:0xf bank_mask:0xc
v_add_f32_dpp v21, v19, v19 row_ror:8 row_mask:0xf bank_mask:0xc
s_nop 0
v_add_f32_dpp v26, v20, v20 row_half_mirror row_mask:0xf bank_mask:0x5
s_nop 1
v_add_f32_dpp v26, v21, v21 row_half_mirror row_mask:0xf bank_mask:0xa
s_waitcnt vmcnt(12)
v_dot2_f32_bf16 v16, v96, v12, 0
v_dot2_f32_bf16 v17, v100, v12, 0
v_dot2_f32_bf16 v18, v104, v12, 0
v_dot2_f32_bf16 v19, v108, v12, 0
v_dot2_f32_bf16 v16, v97, v13, v16
v_dot2_f32_bf16 v17, v101, v13, v17
v_dot2_f32_bf16 v18, v105, v13, v18
v_dot2_f32_bf16 v19, v109, v13, v19
v_dot2_f32_bf16 v16, v98, v14, v16
v_dot2_f32_bf16 v17, v102, v14, v17
v_dot2_f32_bf16 v18, v106, v14, v18
v_dot2_f32_bf16 v19, v110, v14, v19
v_dot2_f32_bf16 v16, v99, v15, v16
v_dot2_f32_bf16 v17, v103, v15, v17
v_dot2_f32_bf16 v18, v107, v15, v18
v_dot2_f32_bf16 v19, v111, v15, v19
s_add_u32 s57, s61, 98304
buffer_load_dwordx4 v[96:99], v1, s[8:11], s57 offen offset:0 nt
buffer_load_dwordx4 v[100:103], v1, s[8:11], s57 offen offset:1024 nt
buffer_load_dwordx4 v[104:107], v1, s[8:11], s57 offen offset:2048 nt
buffer_load_dwordx4 v[108:111], v1, s[8:11], s57 offen offset:3072 nt
v_add_f32_dpp v20, v16, v16 row_ror:8 row_mask:0xf bank_mask:0x3
v_add_f32_dpp v21, v17, v17 row_ror:8 row_mask:0xf bank_mask:0x3
s_nop 0
v_add_f32_dpp v20, v18, v18 row_ror:8 row_mask:0xf bank_mask:0xc
v_add_f32_dpp v21, v19, v19 row_ror:8 row_mask:0xf bank_mask:0xc
s_nop 0
v_add_f32_dpp v27, v20, v20 row_half_mirror row_mask:0xf bank_mask:0x5
s_nop 1
v_add_f32_dpp v27, v21, v21 row_half_mirror row_mask:0xf bank_mask:0xa
v_add_f32_dpp v24, v24, v24 quad_perm:[2,3,0,1] row_mask:0xf bank_mask:0xf
v_add_f32_dpp v25, v25, v25 quad_perm:[2,3,0,1] row_mask:0xf bank_mask:0xf
v_add_f32_dpp v26, v26, v26 quad_perm:[2,3,0,1] row_mask:0xf bank_mask:0xf
v_add_f32_dpp v27, v27, v27 quad_perm:[2,3,0,1] row_mask:0xf bank_mask:0xf
v_cndmask_b32 v24, v24, v26, s[66:67]
v_cndmask_b32 v25, v25, v27, s[66:67]
s_nop 0
v_add_f32_dpp v24, v24, v24 quad_perm:[1,0,3,2] row_mask:0xf bank_mask:0xf
v_add_f32_dpp v25, v25, v25 quad_perm:[1,0,3,2] row_mask:0xf bank_mask:0xf
v_cndmask_b32 v45, v24, v25, s[68:69]
v_mov_b32 v28, v29
v_mov_b32 v29, v30
v_mov_b32 v30, v31
v_cvt_pk_bf16_f32 v31, v45, v23
buffer_store_dwordx4 v[28:31], v1, s[16:19], s72 offen offset:1024 sc1
s_xor_b32 s57, s2, 4
s_lshl_b32 s57, s57, 7
s_add_u32 s57, s57, 2097152
s_add_u32 s0, s46, s57
s_addc_u32 s1, s47, 0
s_load_dword s20, s[0:1], 0 glc
s_waitcnt vmcnt(13)
v_dot2_f32_bf16 v16, v48, v12, 0
v_dot2_f32_bf16 v17, v52, v12, 0
v_dot2_f32_bf16 v18, v56, v12, 0
v_dot2_f32_bf16 v19, v60, v12, 0
v_dot2_f32_bf16 v16, v49, v13, v16
v_dot2_f32_bf16 v17, v53, v13, v17
v_dot2_f32_bf16 v18, v57, v13, v18
v_dot2_f32_bf16 v19, v61, v13, v19
v_dot2_f32_bf16 v16, v50, v14, v16
v_dot2_f32_bf16 v17, v54, v14, v17
v_dot2_f32_bf16 v18, v58, v14, v18
v_dot2_f32_bf16 v19, v62, v14, v19
v_dot2_f32_bf16 v16, v51, v15, v16
v_dot2_f32_bf16 v17, v55, v15, v17
v_dot2_f32_bf16 v18, v59, v15, v18
v_dot2_f32_bf16 v19, v63, v15, v19
s_add_u32 s57, s61, 131072
buffer_load_dwordx4 v[48:51], v1, s[8:11], s57 offen offset:0 nt
buffer_load_dwordx4 v[52:55], v1, s[8:11], s57 offen offset:1024 nt
buffer_load_dwordx4 v[56:59], v1, s[8:11], s57 offen offset:2048 nt
buffer_load_dwordx4 v[60:63], v1, s[8:11], s57 offen offset:3072 nt
v_add_f32_dpp v20, v16, v16 row_ror:8 row_mask:0xf bank_mask:0x3
v_add_f32_dpp v21, v17, v17 row_ror:8 row_mask:0xf bank_mask:0x3
s_nop 0
v_add_f32_dpp v20, v18, v18 row_ror:8 row_mask:0xf bank_mask:0xc
v_add_f32_dpp v21, v19, v19 row_ror:8 row_mask:0xf bank_mask:0xc
s_nop 0
v_add_f32_dpp v24, v20, v20 row_half_mirror row_mask:0xf bank_mask:0x5
s_nop 1
v_add_f32_dpp v24, v21, v21 row_half_mirror row_mask:0xf bank_mask:0xa
s_waitcnt vmcnt(13)
v_dot2_f32_bf16 v16, v64, v12, 0
v_dot2_f32_bf16 v17, v68, v12, 0
v_dot2_f32_bf16 v18, v72, v12, 0
v_dot2_f32_bf16 v19, v76, v12, 0
v_dot2_f32_bf16 v16, v65, v13, v16
v_dot2_f32_bf16 v17, v69, v13, v17
v_dot2_f32_bf16 v18, v73, v13, v18
v_dot2_f32_bf16 v19, v77, v13, v19
v_dot2_f32_bf16 v16, v66, v14, v16
v_dot2_f32_bf16 v17, v70, v14, v17
v_dot2_f32_bf16 v18, v74, v14, v18
v_dot2_f32_bf16 v19, v78, v14, v19
v_dot2_f32_bf16 v16, v67, v15, v16
v_dot2_f32_bf16 v17, v71, v15, v17
v_dot2_f32_bf16 v18, v75, v15, v18
v_dot2_f32_bf16 v19, v79, v15, v19
s_add_u32 s57, s61, 163840
buffer_load_dwordx4 v[64:67], v1, s[8:11], s57 offen offset:0 nt
buffer_load_dwordx4 v[68:71], v1, s[8:11], s57 offen offset:1024 nt
buffer_load_dwordx4 v[72:75], v1, s[8:11], s57 offen offset:2048 nt
buffer_load_dwordx4 v[76:79], v1, s[8:11], s57 offen offset:3072 nt
v_add_f32_dpp v20, v16, v16 row_ror:8 row_mask:0xf bank_mask:0x3
v_add_f32_dpp v21, v17, v17 row_ror:8 row_mask:0xf bank_mask:0x3
s_nop 0
v_add_f32_dpp v20, v18, v18 row_ror:8 row_mask:0xf bank_mask:0xc
v_add_f32_dpp v21, v19, v19 row_ror:8 row_mask:0xf bank_mask:0xc
s_nop 0
v_add_f32_dpp v25, v20, v20 row_half_mirror row_mask:0xf bank_mask:0x5
s_nop 1
v_add_f32_dpp v25, v21, v21 row_half_mirror row_mask:0xf bank_mask:0xa
s_waitcnt vmcnt(13)
v_dot2_f32_bf16 v16, v80, v12, 0
v_dot2_f32_bf16 v17, v84, v12, 0
v_dot2_f32_bf16 v18, v88, v12, 0
v_dot2_f32_bf16 v19, v92, v12, 0
v_dot2_f32_bf16 v16, v81, v13, v16
v_dot2_f32_bf16 v17, v85, v13, v17
v_dot2_f32_bf16 v18, v89, v13, v18
v_dot2_f32_bf16 v19, v93, v13, v19
v_dot2_f32_bf16 v16, v82, v14, v16
v_dot2_f32_bf16 v17, v86, v14, v17
v_dot2_f32_bf16 v18, v90, v14, v18
v_dot2_f32_bf16 v19, v94, v14, v19
v_dot2_f32_bf16 v16, v83, v15, v16
v_dot2_f32_bf16 v17, v87, v15, v17
v_dot2_f32_bf16 v18, v91, v15, v18
v_dot2_f32_bf16 v19, v95, v15, v19
s_add_u32 s57, s61, 196608
buffer_load_dwordx4 v[80:83], v1, s[8:11], s57 offen offset:0 nt
buffer_load_dwordx4 v[84:87], v1, s[8:11], s57 offen offset:1024 nt
buffer_load_dwordx4 v[88:91], v1, s[8:11], s57 offen offset:2048 nt
buffer_load_dwordx4 v[92:95], v1, s[8:11], s57 offen offset:3072 nt
v_add_f32_dpp v20, v16, v16 row_ror:8 row_mask:0xf bank_mask:0x3
v_add_f32_dpp v21, v17, v17 row_ror:8 row_mask:0xf bank_mask:0x3
s_nop 0
v_add_f32_dpp v20, v18, v18 row_ror:8 row_mask:0xf bank_mask:0xc
v_add_f32_dpp v21, v19, v19 row_ror:8 row_mask:0xf bank_mask:0xc
s_nop 0
v_add_f32_dpp v26, v20, v20 row_half_mirror row_mask:0xf bank_mask:0x5
s_nop 1
v_add_f32_dpp v26, v21, v21 row_half_mirror row_mask:0xf bank_mask:0xa
s_waitcnt vmcnt(13)
v_dot2_f32_bf16 v16, v96, v12, 0
v_dot2_f32_bf16 v17, v100, v12, 0
v_dot2_f32_bf16 v18, v104, v12, 0
v_dot2_f32_bf16 v19, v108, v12, 0
v_dot2_f32_bf16 v16, v97, v13, v16
v_dot2_f32_bf16 v17, v101, v13, v17
v_dot2_f32_bf16 v18, v105, v13, v18
v_dot2_f32_bf16 v19, v109, v13, v19
v_dot2_f32_bf16 v16, v98, v14, v16
v_dot2_f32_bf16 v17, v102, v14, v17
v_dot2_f32_bf16 v18, v106, v14, v18
v_dot2_f32_bf16 v19, v110, v14, v19
v_dot2_f32_bf16 v16, v99, v15, v16
v_dot2_f32_bf16 v17, v103, v15, v17
v_dot2_f32_bf16 v18, v107, v15, v18
v_dot2_f32_bf16 v19, v111, v15, v19
s_add_u32 s57, s61, 229376
buffer_load_dwordx4 v[96:99], v1, s[8:11], s57 offen offset:0 nt
buffer_load_dwordx4 v[100:103], v1, s[8:11], s57 offen offset:1024 nt
buffer_load_dwordx4 v[104:107], v1, s[8:11], s57 offen offset:2048 nt
buffer_load_dwordx4 v[108:111], v1, s[8:11], s57 offen offset:3072 nt
v_add_f32_dpp v20, v16, v16 row_ror:8 row_mask:0xf bank_mask:0x3
v_add_f32_dpp v21, v17, v17 row_ror:8 row_mask:0xf bank_mask:0x3
s_nop 0
v_add_f32_dpp v20, v18, v18 row_ror:8 row_mask:0xf bank_mask:0xc
v_add_f32_dpp v21, v19, v19 row_ror:8 row_mask:0xf bank_mask:0xc
s_nop 0
v_add_f32_dpp v27, v20, v20 row_half_mirror row_mask:0xf bank_mask:0x5
s_nop 1
v_add_f32_dpp v27, v21, v21 row_half_mirror row_mask:0xf bank_mask:0xa
v_add_f32_dpp v24, v24, v24 quad_perm:[2,3,0,1] row_mask:0xf bank_mask:0xf
v_add_f32_dpp v25, v25, v25 quad_perm:[2,3,0,1] row_mask:0xf bank_mask:0xf
v_add_f32_dpp v26, v26, v26 quad_perm:[2,3,0,1] row_mask:0xf bank_mask:0xf
v_add_f32_dpp v27, v27, v27 quad_perm:[2,3,0,1] row_mask:0xf bank_mask:0xf
v_cndmask_b32 v24, v24, v26, s[66:67]
v_cndmask_b32 v25, v25, v27, s[66:67]
s_nop 0
v_add_f32_dpp v24, v24, v24 quad_perm:[1,0,3,2] row_mask:0xf bank_mask:0xf
v_add_f32_dpp v25, v25, v25 quad_perm:[1,0,3,2] row_mask:0xf bank_mask:0xf
v_cndmask_b32 v45, v24, v25, s[68:69]
s_waitcnt lgkmcnt(0)
s_cmp_lt_i32 s20, 3
s_cbranch_scc1 LV_71_SLOW
LV_71_OK:
s_waitcnt vmcnt(12)
v_dot2_f32_bf16 v16, v48, v12, 0
v_dot2_f32_bf16 v17, v52, v12, 0
v_dot2_f32_bf16 v18, v56, v12, 0
v_dot2_f32_bf16 v19, v60, v12, 0
v_dot2_f32_bf16 v16, v49, v13, v16
v_dot2_f32_bf16 v17, v53, v13, v17
v_dot2_f32_bf16 v18, v57, v13, v18
v_dot2_f32_bf16 v19, v61, v13, v19
v_dot2_f32_bf16 v16, v50, v14, v16
v_dot2_f32_bf16 v17, v54, v14, v17
v_dot2_f32_bf16 v18, v58, v14, v18
v_dot2_f32_bf16 v19, v62, v14, v19
v_dot2_f32_bf16 v16, v51, v15, v16
v_dot2_f32_bf16 v17, v55, v15, v17
v_dot2_f32_bf16 v18, v59, v15, v18
v_dot2_f32_bf16 v19, v63, v15, v19
s_add_u32 s57, s63, 1048576
buffer_load_dwordx4 v[48:51], v1, s[12:15], s57 offen offset:0 nt
buffer_load_dwordx4 v[52:55], v1, s[12:15], s57 offen offset:1024 nt
buffer_load_dwordx4 v[56:59], v1, s[12:15], s57 offen offset:2048 nt
buffer_load_dwordx4 v[60:63], v1, s[12:15], s57 offen offset:3072 nt
v_add_f32_dpp v20, v16, v16 row_ror:8 row_mask:0xf bank_mask:0x3
v_add_f32_dpp v21, v17, v17 row_ror:8 row_mask:0xf bank_mask:0x3
s_nop 0
v_add_f32_dpp v20, v18, v18 row_ror:8 row_mask:0xf bank_mask:0xc
v_add_f32_dpp v21, v19, v19 row_ror:8 row_mask:0xf bank_mask:0xc
s_nop 0
v_add_f32_dpp v24, v20, v20 row_half_mirror row_mask:0xf bank_mask:0x5
s_nop 1
v_add_f32_dpp v24, v21, v21 row_half_mirror row_mask:0xf bank_mask:0xa
s_waitcnt vmcnt(12)
v_dot2_f32_bf16 v16, v64, v12, 0
v_dot2_f32_bf16 v17, v68, v12, 0
v_dot2_f32_bf16 v18, v72, v12, 0
v_dot2_f32_bf16 v19, v76, v12, 0
v_dot2_f32_bf16 v16, v65, v13, v16
v_dot2_f32_bf16 v17, v69, v13, v17
v_dot2_f32_bf16 v18, v73, v13, v18
v_dot2_f32_bf16 v19, v77, v13, v19
v_dot2_f32_bf16 v16, v66, v14, v16
v_dot2_f32_bf16 v17, v70, v14, v17
v_dot2_f32_bf16 v18, v74, v14, v18
v_dot2_f32_bf16 v19, v78, v14, v19
v_dot2_f32_bf16 v16, v67, v15, v16
v_dot2_f32_bf16 v17, v71, v15, v17
v_dot2_f32_bf16 v18, v75, v15, v18
v_dot2_f32_bf16 v19, v79, v15, v19
s_add_u32 s57, s63, 1081344
buffer_load_dwordx4 v[64:67], v1, s[12:15], s57 offen offset:0 nt
buffer_load_dwordx4 v[68:71], v1, s[12:15], s57 offen offset:1024 nt
buffer_load_dwordx4 v[72:75], v1, s[12:15], s57 offen offset:2048 nt
buffer_load_dwordx4 v[76:79], v1, s[12:15], s57 offen offset:3072 nt
v_add_f32_dpp v20, v16, v16 row_ror:8 row_mask:0xf bank_mask:0x3
v_add_f32_dpp v21, v17, v17 row_ror:8 row_mask:0xf bank_mask:0x3
s_nop 0
v_add_f32_dpp v20, v18, v18 row_ror:8 row_mask:0xf bank_mask:0xc
v_add_f32_dpp v21, v19, v19 row_ror:8 row_mask:0xf bank_mask:0xc
s_nop 0
v_add_f32_dpp v25, v20, v20 row_half_mirror row_mask:0xf bank_mask:0x5
s_nop 1
v_add_f32_dpp v25, v21, v21 row_half_mirror row_mask:0xf bank_mask:0xa
s_waitcnt vmcnt(12)
v_dot2_f32_bf16 v16, v80, v12, 0
v_dot2_f32_bf16 v17, v84, v12, 0
v_dot2_f32_bf16 v18, v88, v12, 0
v_dot2_f32_bf16 v19, v92, v12, 0
v_dot2_f32_bf16 v16, v81, v13, v16
v_dot2_f32_bf16 v17, v85, v13, v17
v_dot2_f32_bf16 v18, v89, v13, v18
v_dot2_f32_bf16 v19, v93, v13, v19
v_dot2_f32_bf16 v16, v82, v14, v16
v_dot2_f32_bf16 v17, v86, v14, v17
v_dot2_f32_bf16 v18, v90, v14, v18
v_dot2_f32_bf16 v19, v94, v14, v19
v_dot2_f32_bf16 v16, v83, v15, v16
v_dot2_f32_bf16 v17, v87, v15, v17
v_dot2_f32_bf16 v18, v91, v15, v18
v_dot2_f32_bf16 v19, v95, v15, v19
s_add_u32 s57, s63, 1114112
buffer_load_dwordx4 v[80:83], v1, s[12:15], s57 offen offset:0 nt
buffer_load_dwordx4 v[84:87], v1, s[12:15], s57 offen offset:1024 nt
buffer_load_dwordx4 v[88:91], v1, s[12:15], s57 offen offset:2048 nt
buffer_load_dwordx4 v[92:95], v1, s[12:15], s57 offen offset:3072 nt
v_add_f32_dpp v20, v16, v16 row_ror:8 row_mask:0xf bank_mask:0x3
v_add_f32_dpp v21, v17, v17 row_ror:8 row_mask:0xf bank_mask:0x3
s_nop 0
v_add_f32_dpp v20, v18, v18 row_ror:8 row_mask:0xf bank_mask:0xc
v_add_f32_dpp v21, v19, v19 row_ror:8 row_mask:0xf bank_mask:0xc
s_nop 0
v_add_f32_dpp v26, v20, v20 row_half_mirror row_mask:0xf bank_mask:0x5
s_nop 1
v_add_f32_dpp v26, v21, v21 row_half_mirror row_mask:0xf bank_mask:0xa
s_waitcnt vmcnt(12)
v_dot2_f32_bf16 v16, v96, v12, 0
v_dot2_f32_bf16 v17, v100, v12, 0
v_dot2_f32_bf16 v18, v104, v12, 0
v_dot2_f32_bf16 v19, v108, v12, 0
v_dot2_f32_bf16 v16, v97, v13, v16
v_dot2_f32_bf16 v17, v101, v13, v17
v_dot2_f32_bf16 v18, v105, v13, v18
v_dot2_f32_bf16 v19, v109, v13, v19
v_dot2_f32_bf16 v16, v98, v14, v16
v_dot2_f32_bf16 v17, v102, v14, v17
v_dot2_f32_bf16 v18, v106, v14, v18
v_dot2_f32_bf16 v19, v110, v14, v19
v_dot2_f32_bf16 v16, v99, v15, v16
v_dot2_f32_bf16 v17, v103, v15, v17
v_dot2_f32_bf16 v18, v107, v15, v18
v_dot2_f32_bf16 v19, v111, v15, v19
s_add_u32 s57, s63, 1146880
buffer_load_dwordx4 v[96:99], v1, s[12:15], s57 offen offset:0 nt
buffer_load_dwordx4 v[100:103], v1, s[12:15], s57 offen offset:1024 nt
buffer_load_dwordx4 v[104:107], v1, s[12:15], s57 offen offset:2048 nt
buffer_load_dwordx4 v[108:111], v1, s[12:15], s57 offen offset:3072 nt
v_add_f32_dpp v20, v16, v16 row_ror:8 row_mask:0xf bank_mask:0x3
v_add_f32_dpp v21, v17, v17 row_ror:8 row_mask:0xf bank_mask:0x3
s_nop 0
v_add_f32_dpp v20, v18, v18 row_ror:8 row_mask:0xf bank_mask:0xc
v_add_f32_dpp v21, v19, v19 row_ror:8 row_mask:0xf bank_mask:0xc
s_nop 0
v_add_f32_dpp v27, v20, v20 row_half_mirror row_mask:0xf bank_mask:0x5
s_nop 1
v_add_f32_dpp v27, v21, v21 row_half_mirror row_mask:0xf bank_mask:0xa
v_add_f32_dpp v24, v24, v24 quad_perm:[2,3,0,1] row_mask:0xf bank_mask:0xf
v_add_f32_dpp v25, v25, v25 quad_perm:[2,3,0,1] row_mask:0xf bank_mask:0xf
v_add_f32_dpp v26, v26, v26 quad_perm:[2,3,0,1] row_mask:0xf bank_mask:0xf
v_add_f32_dpp v27, v27, v27 quad_perm:[2,3,0,1] row_mask:0xf bank_mask:0xf
v_cndmask_b32 v24, v24, v26, s[66:67]
v_cndmask_b32 v25, v25, v27, s[66:67]
s_nop 0
v_add_f32_dpp v24, v24, v24 quad_perm:[1,0,3,2] row_mask:0xf bank_mask:0xf
v_add_f32_dpp v25, v25, v25 quad_perm:[1,0,3,2] row_mask:0xf bank_mask:0xf
v_cndmask_b32 v23, v24, v25, s[68:69]
v_cvt_pk_bf16_f32 v47, v45, v23
s_barrier
s_cmp_lg_u32 s3, 3
s_cbranch_scc1 SK_72
v_mov_b32 v24, 4
v_mov_b32 v25, 4
v_mov_b32 v26, 4
v_mov_b32 v27, 4
s_lshl_b32 s57, s2, 7
s_add_u32 s57, s57, 2097152
s_mov_b64 exec, 0xff
buffer_store_dwordx4 v[24:27], v1, s[16:19], s57 offen sc1
s_mov_b64 exec, -1
SK_72:
buffer_load_dwordx4 v[12:15], v1, s[16:19], s73 offen sc1
v_lshlrev_b32 v22, 16, v47
v_fmamk_f32 v23, v22, 0x3e0293ee, v6
v_cmp_lt_f32 vcc, 0, v23
s_cbranch_vccnz RS_73
RB_74:
v_exp_f32 v23, v23
s_nop 0
v_add_f32 v7, v7, v23
v_cvt_pk_bf16_f32 v23, v23, v23
s_nop 1
v_and_b32_dpp v24, v23, v2 row_newbcast:0 row_mask:0xf bank_mask:0xf
v_and_b32_dpp v25, v23, v3 row_newbcast:0 row_mask:0xf bank_mask:0xf
v_and_b32_dpp v26, v23, v4 row_newbcast:0 row_mask:0xf bank_mask:0xf
v_and_b32_dpp v27, v23, v5 row_newbcast:0 row_mask:0xf bank_mask:0xf
v_and_b32_dpp v28, v23, v2 row_newbcast:4 row_mask:0xf bank_mask:0xf
v_and_b32_dpp v29, v23, v3 row_newbcast:4 row_mask:0xf bank_mask:0xf
v_and_b32_dpp v30, v23, v4 row_newbcast:4 row_mask:0xf bank_mask:0xf
v_and_b32_dpp v31, v23, v5 row_newbcast:4 row_mask:0xf bank_mask:0xf
v_mfma_f32_16x16x32_bf16 v[8:11], a[64:67], v[24:27], v[8:11]
v_and_b32_dpp v24, v23, v2 row_newbcast:8 row_mask:0xf bank_mask:0xf
v_and_b32_dpp v25, v23, v3 row_newbcast:8 row_mask:0xf bank_mask:0xf
v_and_b32_dpp v26, v23, v4 row_newbcast:8 row_mask:0xf bank_mask:0xf
v_and_b32_dpp v27, v23, v5 row_newbcast:8 row_mask:0xf bank_mask:0xf
v_mfma_f32_16x16x32_bf16 v[8:11], a[68:71], v[28:31], v[8:11]
v_and_b32_dpp v28, v23, v2 row_newbcast:12 row_mask:0xf bank_mask:0xf
v_and_b32_dpp v29, v23, v3 row_newbcast:12 row_mask:0xf bank_mask:0xf
v_and_b32_dpp v30, v23, v4 row_newbcast:12 row_mask:0xf bank_mask:0xf
v_and_b32_dpp v31, v23, v5 row_newbcast:12 row_mask:0xf bank_mask:0xf
v_mfma_f32_16x16x32_bf16 v[8:11], a[72:75], v[24:27], v[8:11]
s_nop 0
v_mfma_f32_16x16x32_bf16 v[8:11], a[76:79], v[28:31], v[8:11]
s_add_u32 s57, s63, 1179648
buffer_load_dwordx4 a[64:67], v1, s[12:15], s57 offen offset:0 nt
buffer_load_dwordx4 a[68:71], v1, s[12:15], s57 offen offset:1024 nt
buffer_load_dwordx4 a[72:75], v1, s[12:15], s57 offen offset:2048 nt
buffer_load_dwordx4 a[76:79], v1, s[12:15], s57 offen offset:3072 nt
v_and_b32_dpp v24, v23, v2 row_newbcast:1 row_mask:0xf bank_mask:0xf
v_and_b32_dpp v25, v23, v3 row_newbcast:1 row_mask:0xf bank_mask:0xf
v_and_b32_dpp v26, v23, v4 row_newbcast:1 row_mask:0xf bank_mask:0xf
v_and_b32_dpp v27, v23, v5 row_newbcast:1 row_mask:0xf bank_mask:0xf
v_and_b32_dpp v28, v23, v2 row_newbcast:5 row_mask:0xf bank_mask:0xf
v_and_b32_dpp v29, v23, v3 row_newbcast:5 row_mask:0xf bank_mask:0xf
v_and_b32_dpp v30, v23, v4 row_newbcast:5 row_mask:0xf bank_mask:0xf
v_and_b32_dpp v31, v23, v5 row_newbcast:5 row_mask:0xf bank_mask:0xf
v_mfma_f32_16x16x32_bf16 v[8:11], a[80:83], v[24:27], v[8:11]
v_and_b32_dpp v24, v23, v2 row_newbcast:9 row_mask:0xf bank_mask:0xf
v_and_b32_dpp v25, v23, v3 row_newbcast:9 row_mask:0xf bank_mask:0xf
v_and_b32_dpp v26, v23, v4 row_newbcast:9 row_mask:0xf bank_mask:0xf
v_and_b32_dpp v27, v23, v5 row_newbcast:9 row_mask:0xf bank_mask:0xf
v_mfma_f32_16x16x32_bf16 v[8:11], a[84:87], v[28:31], v[8:11]
v_and_b32_dpp v28, v23, v2 row_newbcast:13 row_mask:0xf bank_mask:0xf
v_and_b32_dpp v29, v23, v3 row_newbcast:13 row_mask:0xf bank_mask:0xf
v_and_b32_dpp v30, v23, v4 row_newbcast:13 row_mask:0xf bank_mask:0xf
v_and_b32_dpp v31, v23, v5 row_newbcast:13 row_mask:0xf bank_mask:0xf
v_mfma_f32_16x16x32_bf16 v[8:11], a[88:91], v[24:27], v[8:11]
s_nop 0
v_mfma_f32_16x16x32_bf16 v[8:11], a[92:95], v[28:31], v[8:11]
s_add_u32 s57, s63, 1212416
buffer_load_dwordx4 a[80:83], v1, s[12:15], s57 offen offset:0 nt
buffer_load_dwordx4 a[84:87], v1, s[12:15], s57 offen offset:1024 nt
buffer_load_dwordx4 a[88:91], v1, s[12:15], s57 offen offset:2048 nt
buffer_load_dwordx4 a[92:95], v1, s[12:15], s57 offen offset:3072 nt
v_and_b32_dpp v24, v23, v2 row_newbcast:2 row_mask:0xf bank_mask:0xf
v_and_b32_dpp v25, v23, v3 row_newbcast:2 row_mask:0xf bank_mask:0xf
v_and_b32_dpp v26, v23, v4 row_newbcast:2 row_mask:0xf bank_mask:0xf
v_and_b32_dpp v27, v23, v5 row_newbcast:2 row_mask:0xf bank_mask:0xf
v_and_b32_dpp v28, v23, v2 row_newbcast:6 row_mask:0xf bank_mask:0xf
v_and_b32_dpp v29, v23, v3 row_newbcast:6 row_mask:0xf bank_mask:0xf
v_and_b32_dpp v30, v23, v4 row_newbcast:6 row_mask:0xf bank_mask:0xf
v_and_b32_dpp v31, v23, v5 row_newbcast:6 row_mask:0xf bank_mask:0xf
v_mfma_f32_16x16x32_bf16 v[8:11], a[96:99], v[24:27], v[8:11]
v_and_b32_dpp v24, v23, v2 row_newbcast:10 row_mask:0xf bank_mask:0xf
v_and_b32_dpp v25, v23, v3 row_newbcast:10 row_mask:0xf bank_mask:0xf
v_and_b32_dpp v26, v23, v4 row_newbcast:10 row_mask:0xf bank_mask:0xf
v_and_b32_dpp v27, v23, v5 row_newbcast:10 row_mask:0xf bank_mask:0xf
v_mfma_f32_16x16x32_bf16 v[8:11], a[100:103], v[28:31], v[8:11]
v_and_b32_dpp v28, v23, v2 row_newbcast:14 row_mask:0xf bank_mask:0xf
v_and_b32_dpp v29, v23, v3 row_newbcast:14 row_mask:0xf bank_mask:0xf
v_and_b32_dpp v30, v23, v4 row_newbcast:14 row_mask:0xf bank_mask:0xf
v_and_b32_dpp v31, v23, v5 row_newbcast:14 row_mask:0xf bank_mask:0xf
v_mfma_f32_16x16x32_bf16 v[8:11], a[104:107], v[24:27], v[8:11]
s_nop 0
v_mfma_f32_16x16x32_bf16 v[8:11], a[108:111], v[28:31], v[8:11]
s_add_u32 s57, s63, 1245184
buffer_load_dwordx4 a[96:99], v1, s[12:15], s57 offen offset:0 nt
buffer_load_dwordx4 a[100:103], v1, s[12:15], s57 offen offset:1024 nt
buffer_load_dwordx4 a[104:107], v1, s[12:15], s57 offen offset:2048 nt
buffer_load_dwordx4 a[108:111], v1, s[12:15], s57 offen offset:3072 nt
v_and_b32_dpp v24, v23, v2 row_newbcast:3 row_mask:0xf bank_mask:0xf
v_and_b32_dpp v25, v23, v3 row_newbcast:3 row_mask:0xf bank_mask:0xf
v_and_b32_dpp v26, v23, v4 row_newbcast:3 row_mask:0xf bank_mask:0xf
v_and_b32_dpp v27, v23, v5 row_newbcast:3 row_mask:0xf bank_mask:0xf
v_and_b32_dpp v28, v23, v2 row_newbcast:7 row_mask:0xf bank_mask:0xf
v_and_b32_dpp v29, v23, v3 row_newbcast:7 row_mask:0xf bank_mask:0xf
v_and_b32_dpp v30, v23, v4 row_newbcast:7 row_mask:0xf bank_mask:0xf
v_and_b32_dpp v31, v23, v5 row_newbcast:7 row_mask:0xf bank_mask:0xf
v_mfma_f32_16x16x32_bf16 v[8:11], a[112:115], v[24:27], v[8:11]
v_and_b32_dpp v24, v23, v2 row_newbcast:11 row_mask:0xf bank_mask:0xf
v_and_b32_dpp v25, v23, v3 row_newbcast:11 row_mask:0xf bank_mask:0xf
v_and_b32_dpp v26, v23, v4 row_newbcast:11 row_mask:0xf bank_mask:0xf
v_and_b32_dpp v27, v23, v5 row_newbcast:11 row_mask:0xf bank_mask:0xf
v_mfma_f32_16x16x32_bf16 v[8:11], a[116:119], v[28:31], v[8:11]
v_and_b32_dpp v28, v23, v2 row_newbcast:15 row_mask:0xf bank_mask:0xf
v_and_b32_dpp v29, v23, v3 row_newbcast:15 row_mask:0xf bank_mask:0xf
v_and_b32_dpp v30, v23, v4 row_newbcast:15 row_mask:0xf bank_mask:0xf
v_and_b32_dpp v31, v23, v5 row_newbcast:15 row_mask:0xf bank_mask:0xf
v_mfma_f32_16x16x32_bf16 v[8:11], a[120:123], v[24:27], v[8:11]
s_nop 0
v_mfma_f32_16x16x32_bf16 v[8:11], a[124:127], v[28:31], v[8:11]
s_add_u32 s57, s63, 1277952
buffer_load_dwordx4 a[112:115], v1, s[12:15], s57 offen offset:0 nt
buffer_load_dwordx4 a[116:119], v1, s[12:15], s57 offen offset:1024 nt
buffer_load_dwordx4 a[120:123], v1, s[12:15], s57 offen offset:2048 nt
buffer_load_dwordx4 a[124:127], v1, s[12:15], s57 offen offset:3072 nt
v_and_b32 v22, 0xffff0000, v47
v_fmamk_f32 v23, v22, 0x3e0293ee, v6
v_cmp_lt_f32 vcc, 0, v23
s_cbranch_vccnz RS_75
RB_76:
v_exp_f32 v23, v23
s_nop 0
v_add_f32 v7, v7, v23
v_cvt_pk_bf16_f32 v23, v23, v23
s_nop 1
v_and_b32_dpp v24, v23, v2 row_newbcast:0 row_mask:0xf bank_mask:0xf
v_and_b32_dpp v25, v23, v3 row_newbcast:0 row_mask:0xf bank_mask:0xf
v_and_b32_dpp v26, v23, v4 row_newbcast:0 row_mask:0xf bank_mask:0xf
v_and_b32_dpp v27, v23, v5 row_newbcast:0 row_mask:0xf bank_mask:0xf
v_and_b32_dpp v28, v23, v2 row_newbcast:4 row_mask:0xf bank_mask:0xf
v_and_b32_dpp v29, v23, v3 row_newbcast:4 row_mask:0xf bank_mask:0xf
v_and_b32_dpp v30, v23, v4 row_newbcast:4 row_mask:0xf bank_mask:0xf
v_and_b32_dpp v31, v23, v5 row_newbcast:4 row_mask:0xf bank_mask:0xf
v_mfma_f32_16x16x32_bf16 v[8:11], a[128:131], v[24:27], v[8:11]
v_and_b32_dpp v24, v23, v2 row_newbcast:8 row_mask:0xf bank_mask:0xf
v_and_b32_dpp v25, v23, v3 row_newbcast:8 row_mask:0xf bank_mask:0xf
v_and_b32_dpp v26, v23, v4 row_newbcast:8 row_mask:0xf bank_mask:0xf
v_and_b32_dpp v27, v23, v5 row_newbcast:8 row_mask:0xf bank_mask:0xf
v_mfma_f32_16x16x32_bf16 v[8:11], a[132:135], v[28:31], v[8:11]
v_and_b32_dpp v28, v23, v2 row_newbcast:12 row_mask:0xf bank_mask:0xf
v_and_b32_dpp v29, v23, v3 row_newbcast:12 row_mask:0xf bank_mask:0xf
v_and_b32_dpp v30, v23, v4 row_newbcast:12 row_mask:0xf bank_mask:0xf
v_and_b32_dpp v31, v23, v5 row_newbcast:12 row_mask:0xf bank_mask:0xf
v_mfma_f32_16x16x32_bf16 v[8:11], a[136:139], v[24:27], v[8:11]
s_nop 0
v_mfma_f32_16x16x32_bf16 v[8:11], a[140:143], v[28:31], v[8:11]
s_add_u32 s57, s63, 1310720
buffer_load_dwordx4 a[128:131], v1, s[12:15], s57 offen offset:0 nt
buffer_load_dwordx4 a[132:135], v1, s[12:15], s57 offen offset:1024 nt
buffer_load_dwordx4 a[136:139], v1, s[12:15], s57 offen offset:2048 nt
buffer_load_dwordx4 a[140:143], v1, s[12:15], s57 offen offset:3072 nt
v_and_b32_dpp v24, v23, v2 row_newbcast:1 row_mask:0xf bank_mask:0xf
v_and_b32_dpp v25, v23, v3 row_newbcast:1 row_mask:0xf bank_mask:0xf
v_and_b32_dpp v26, v23, v4 row_newbcast:1 row_mask:0xf bank_mask:0xf
v_and_b32_dpp v27, v23, v5 row_newbcast:1 row_mask:0xf bank_mask:0xf
v_and_b32_dpp v28, v23, v2 row_newbcast:5 row_mask:0xf bank_mask:0xf
v_and_b32_dpp v29, v23, v3 row_newbcast:5 row_mask:0xf bank_mask:0xf
v_and_b32_dpp v30, v23, v4 row_newbcast:5 row_mask:0xf bank_mask:0xf
v_and_b32_dpp v31, v23, v5 row_newbcast:5 row_mask:0xf bank_mask:0xf
v_mfma_f32_16x16x32_bf16 v[8:11], a[144:147], v[24:27], v[8:11]
v_and_b32_dpp v24, v23, v2 row_newbcast:9 row_mask:0xf bank_mask:0xf
v_and_b32_dpp v25, v23, v3 row_newbcast:9 row_mask:0xf bank_mask:0xf
v_and_b32_dpp v26, v23, v4 row_newbcast:9 row_mask:0xf bank_mask:0xf
v_and_b32_dpp v27, v23, v5 row_newbcast:9 row_mask:0xf bank_mask:0xf
v_mfma_f32_16x16x32_bf16 v[8:11], a[148:151], v[28:31], v[8:11]
v_and_b32_dpp v28, v23, v2 row_newbcast:13 row_mask:0xf bank_mask:0xf
v_and_b32_dpp v29, v23, v3 row_newbcast:13 row_mask:0xf bank_mask:0xf
v_and_b32_dpp v30, v23, v4 row_newbcast:13 row_mask:0xf bank_mask:0xf
v_and_b32_dpp v31, v23, v5 row_newbcast:13 row_mask:0xf bank_mask:0xf
v_mfma_f32_16x16x32_bf16 v[8:11], a[152:155], v[24:27], v[8:11]
s_nop 0
v_mfma_f32_16x16x32_bf16 v[8:11], a[156:159], v[28:31], v[8:11]
s_add_u32 s57, s63, 1343488
buffer_load_dwordx4 a[144:147], v1, s[12:15], s57 offen offset:0 nt
buffer_load_dwordx4 a[148:151], v1, s[12:15], s57 offen offset:1024 nt
buffer_load_dwordx4 a[152:155], v1, s[12:15], s57 offen offset:2048 nt
buffer_load_dwordx4 a[156:159], v1, s[12:15], s57 offen offset:3072 nt
v_and_b32_dpp v24, v23, v2 row_newbcast:2 row_mask:0xf bank_mask:0xf
v_and_b32_dpp v25, v23, v3 row_newbcast:2 row_mask:0xf bank_mask:0xf
v_and_b32_dpp v26, v23, v4 row_newbcast:2 row_mask:0xf bank_mask:0xf
v_and_b32_dpp v27, v23, v5 row_newbcast:2 row_mask:0xf bank_mask:0xf
v_and_b32_dpp v28, v23, v2 row_newbcast:6 row_mask:0xf bank_mask:0xf
v_and_b32_dpp v29, v23, v3 row_newbcast:6 row_mask:0xf bank_mask:0xf
v_and_b32_dpp v30, v23, v4 row_newbcast:6 row_mask:0xf bank_mask:0xf
v_and_b32_dpp v31, v23, v5 row_newbcast:6 row_mask:0xf bank_mask:0xf
v_mfma_f32_16x16x32_bf16 v[8:11], a[160:163], v[24:27], v[8:11]
v_and_b32_dpp v24, v23, v2 row_newbcast:10 row_mask:0xf bank_mask:0xf
v_and_b32_dpp v25, v23, v3 row_newbcast:10 row_mask:0xf bank_mask:0xf
v_and_b32_dpp v26, v23, v4 row_newbcast:10 row_mask:0xf bank_mask:0xf
v_and_b32_dpp v27, v23, v5 row_newbcast:10 row_mask:0xf bank_mask:0xf
v_mfma_f32_16x16x32_bf16 v[8:11], a[164:167], v[28:31], v[8:11]
v_and_b32_dpp v28, v23, v2 row_newbcast:14 row_mask:0xf bank_mask:0xf
v_and_b32_dpp v29, v23, v3 row_newbcast:14 row_mask:0xf bank_mask:0xf
v_and_b32_dpp v30, v23, v4 row_newbcast:14 row_mask:0xf bank_mask:0xf
v_and_b32_dpp v31, v23, v5 row_newbcast:14 row_mask:0xf bank_mask:0xf
v_mfma_f32_16x16x32_bf16 v[8:11], a[168:171], v[24:27], v[8:11]
s_nop 0
v_mfma_f32_16x16x32_bf16 v[8:11], a[172:175], v[28:31], v[8:11]
s_add_u32 s57, s63, 1376256
buffer_load_dwordx4 a[160:163], v1, s[12:15], s57 offen offset:0 nt
buffer_load_dwordx4 a[164:167], v1, s[12:15], s57 offen offset:1024 nt
buffer_load_dwordx4 a[168:171], v1, s[12:15], s57 offen offset:2048 nt
buffer_load_dwordx4 a[172:175], v1, s[12:15], s57 offen offset:3072 nt
v_and_b32_dpp v24, v23, v2 row_newbcast:3 row_mask:0xf bank_mask:0xf
v_and_b32_dpp v25, v23, v3 row_newbcast:3 row_mask:0xf bank_mask:0xf
v_and_b32_dpp v26, v23, v4 row_newbcast:3 row_mask:0xf bank_mask:0xf
v_and_b32_dpp v27, v23, v5 row_newbcast:3 row_mask:0xf bank_mask:0xf
v_and_b32_dpp v28, v23, v2 row_newbcast:7 row_mask:0xf bank_mask:0xf
v_and_b32_dpp v29, v23, v3 row_newbcast:7 row_mask:0xf bank_mask:0xf
v_and_b32_dpp v30, v23, v4 row_newbcast:7 row_mask:0xf bank_mask:0xf
v_and_b32_dpp v31, v23, v5 row_newbcast:7 row_mask:0xf bank_mask:0xf
v_mfma_f32_16x16x32_bf16 v[8:11], a[176:179], v[24:27], v[8:11]
v_and_b32_dpp v24, v23, v2 row_newbcast:11 row_mask:0xf bank_mask:0xf
v_and_b32_dpp v25, v23, v3 row_newbcast:11 row_mask:0xf bank_mask:0xf
v_and_b32_dpp v26, v23, v4 row_newbcast:11 row_mask:0xf bank_mask:0xf
v_and_b32_dpp v27, v23, v5 row_newbcast:11 row_mask:0xf bank_mask:0xf
v_mfma_f32_16x16x32_bf16 v[8:11], a[180:183], v[28:31], v[8:11]
v_and_b32_dpp v28, v23, v2 row_newbcast:15 row_mask:0xf bank_mask:0xf
v_and_b32_dpp v29, v23, v3 row_newbcast:15 row_mask:0xf bank_mask:0xf
v_and_b32_dpp v30, v23, v4 row_newbcast:15 row_mask:0xf bank_mask:0xf
v_and_b32_dpp v31, v23, v5 row_newbcast:15 row_mask:0xf bank_mask:0xf
v_mfma_f32_16x16x32_bf16 v[8:11], a[184:187], v[24:27], v[8:11]
s_nop 0
v_mfma_f32_16x16x32_bf16 v[8:11], a[188:191], v[28:31], v[8:11]
s_add_u32 s57, s63, 1409024
buffer_load_dwordx4 a[176:179], v1, s[12:15], s57 offen offset:0 nt
buffer_load_dwordx4 a[180:183], v1, s[12:15], s57 offen offset:1024 nt
buffer_load_dwordx4 a[184:187], v1, s[12:15], s57 offen offset:2048 nt
buffer_load_dwordx4 a[188:191], v1, s[12:15], s57 offen offset:3072 nt
v_mov_b32 v16, 0
s_lshl_b32 s76, s48, 9
s_lshr_b32 s57, s49, 2
s_lshl_b32 s57, s57, 7
s_add_u32 s76, s76, s57
s_add_u32 s76, s76, 2162944
s_waitcnt vmcnt(32)
v_lshlrev_b32 v22, 16, v14
v_fmamk_f32 v23, v22, 0x3e0293ee, v6
v_cmp_lt_f32 vcc, 0, v23
s_cbranch_vccnz RS_77
RB_78:
v_exp_f32 v23, v23
s_nop 0
v_add_f32 v7, v7, v23
v_cvt_pk_bf16_f32 v23, v23, v23
s_nop 1
v_and_b32_dpp v24, v23, v2 row_newbcast:0 row_mask:0xf bank_mask:0xf
v_and_b32_dpp v25, v23, v3 row_newbcast:0 row_mask:0xf bank_mask:0xf
v_and_b32_dpp v26, v23, v4 row_newbcast:0 row_mask:0xf bank_mask:0xf
v_and_b32_dpp v27, v23, v5 row_newbcast:0 row_mask:0xf bank_mask:0xf
v_and_b32_dpp v28, v23, v2 row_newbcast:4 row_mask:0xf bank_mask:0xf
v_and_b32_dpp v29, v23, v3 row_newbcast:4 row_mask:0xf bank_mask:0xf
v_and_b32_dpp v30, v23, v4 row_newbcast:4 row_mask:0xf bank_mask:0xf
v_and_b32_dpp v31, v23, v5 row_newbcast:4 row_mask:0xf bank_mask:0xf
v_mfma_f32_16x16x32_bf16 v[8:11], v[176:179], v[24:27], v[8:11]
v_and_b32_dpp v24, v23, v2 row_newbcast:8 row_mask:0xf bank_mask:0xf
v_and_b32_dpp v25, v23, v3 row_newbcast:8 row_mask:0xf bank_mask:0xf
v_and_b32_dpp v26, v23, v4 row_newbcast:8 row_mask:0xf bank_mask:0xf
v_and_b32_dpp v27, v23, v5 row_newbcast:8 row_mask:0xf bank_mask:0xf
v_mfma_f32_16x16x32_bf16 v[8:11], v[180:183], v[28:31], v[8:11]
v_and_b32_dpp v28, v23, v2 row_newbcast:12 row_mask:0xf bank_mask:0xf
v_and_b32_dpp v29, v23, v3 row_newbcast:12 row_mask:0xf bank_mask:0xf
v_and_b32_dpp v30, v23, v4 row_newbcast:12 row_mask:0xf bank_mask:0xf
v_and_b32_dpp v31, v23, v5 row_newbcast:12 row_mask:0xf bank_mask:0xf
v_mfma_f32_16x16x32_bf16 v[8:11], v[184:187], v[24:27], v[8:11]
s_nop 0
v_mfma_f32_16x16x32_bf16 v[8:11], v[188:191], v[28:31], v[8:11]
v_and_b32_dpp v24, v23, v2 row_newbcast:1 row_mask:0xf bank_mask:0xf
v_and_b32_dpp v25, v23, v3 row_newbcast:1 row_mask:0xf bank_mask:0xf
v_and_b32_dpp v26, v23, v4 row_newbcast:1 row_mask:0xf bank_mask:0xf
v_and_b32_dpp v27, v23, v5 row_newbcast:1 row_mask:0xf bank_mask:0xf
v_and_b32_dpp v28, v23, v2 row_newbcast:5 row_mask:0xf bank_mask:0xf
v_and_b32_dpp v29, v23, v3 row_newbcast:5 row_mask:0xf bank_mask:0xf
v_and_b32_dpp v30, v23, v4 row_newbcast:5 row_mask:0xf bank_mask:0xf
v_and_b32_dpp v31, v23, v5 row_newbcast:5 row_mask:0xf bank_mask:0xf
v_mfma_f32_16x16x32_bf16 v[8:11], v[192:195], v[24:27], v[8:11]
v_and_b32_dpp v24, v23, v2 row_newbcast:9 row_mask:0xf bank_mask:0xf
v_and_b32_dpp v25, v23, v3 row_newbcast:9 row_mask:0xf bank_mask:0xf
v_and_b32_dpp v26, v23, v4 row_newbcast:9 row_mask:0xf bank_mask:0xf
v_and_b32_dpp v27, v23, v5 row_newbcast:9 row_mask:0xf bank_mask:0xf
v_mfma_f32_16x16x32_bf16 v[8:11], v[196:199], v[28:31], v[8:11]
v_and_b32_dpp v28, v23, v2 row_newbcast:13 row_mask:0xf bank_mask:0xf
v_and_b32_dpp v29, v23, v3 row_newbcast:13 row_mask:0xf bank_mask:0xf
v_and_b32_dpp v30, v23, v4 row_newbcast:13 row_mask:0xf bank_mask:0xf
v_and_b32_dpp v31, v23, v5 row_newbcast:13 row_mask:0xf bank_mask:0xf
v_mfma_f32_16x16x32_bf16 v[8:11], v[200:203], v[24:27], v[8:11]
s_nop 0
v_mfma_f32_16x16x32_bf16 v[8:11], v[204:207], v[28:31], v[8:11]
v_and_b32_dpp v24, v23, v2 row_newbcast:2 row_mask:0xf bank_mask:0xf
v_and_b32_dpp v25, v23, v3 row_newbcast:2 row_mask:0xf bank_mask:0xf
v_and_b32_dpp v26, v23, v4 row_newbcast:2 row_mask:0xf bank_mask:0xf
v_and_b32_dpp v27, v23, v5 row_newbcast:2 row_mask:0xf bank_mask:0xf
v_and_b32_dpp v28, v23, v2 row_newbcast:6 row_mask:0xf bank_mask:0xf
v_and_b32_dpp v29, v23, v3 row_newbcast:6 row_mask:0xf bank_mask:0xf
v_and_b32_dpp v30, v23, v4 row_newbcast:6 row_mask:0xf bank_mask:0xf
v_and_b32_dpp v31, v23, v5 row_newbcast:6 row_mask:0xf bank_mask:0xf
v_mfma_f32_16x16x32_bf16 v[8:11], v[208:211], v[24:27], v[8:11]
v_and_b32_dpp v24, v23, v2 row_newbcast:10 row_mask:0xf bank_mask:0xf
v_and_b32_dpp v25, v23, v3 row_newbcast:10 row_mask:0xf bank_mask:0xf
v_and_b32_dpp v26, v23, v4 row_newbcast:10 row_mask:0xf bank_mask:0xf
v_and_b32_dpp v27, v23, v5 row_newbcast:10 row_mask:0xf bank_mask:0xf
v_mfma_f32_16x16x32_bf16 v[8:11], v[212:215], v[28:31], v[8:11]
v_and_b32_dpp v28, v23, v2 row_newbcast:14 row_mask:0xf bank_mask:0xf
v_and_b32_dpp v29, v23, v3 row_newbcast:14 row_mask:0xf bank_mask:0xf
v_and_b32_dpp v30, v23, v4 row_newbcast:14 row_mask:0xf bank_mask:0xf
v_and_b32_dpp v31, v23, v5 row_newbcast:14 row_mask:0xf bank_mask:0xf
v_mfma_f32_16x16x32_bf16 v[8:11], v[216:219], v[24:27], v[8:11]
s_nop 0
v_mfma_f32_16x16x32_bf16 v[8:11], v[220:223], v[28:31], v[8:11]
v_and_b32_dpp v24, v23, v2 row_newbcast:3 row_mask:0xf bank_mask:0xf
v_and_b32_dpp v25, v23, v3 row_newbcast:3 row_mask:0xf bank_mask:0xf
v_and_b32_dpp v26, v23, v4 row_newbcast:3 row_mask:0xf bank_mask:0xf
v_and_b32_dpp v27, v23, v5 row_newbcast:3 row_mask:0xf bank_mask:0xf
v_and_b32_dpp v28, v23, v2 row_newbcast:7 row_mask:0xf bank_mask:0xf
v_and_b32_dpp v29, v23, v3 row_newbcast:7 row_mask:0xf bank_mask:0xf
v_and_b32_dpp v30, v23, v4 row_newbcast:7 row_mask:0xf bank_mask:0xf
v_and_b32_dpp v31, v23, v5 row_newbcast:7 row_mask:0xf bank_mask:0xf
v_mfma_f32_16x16x32_bf16 v[8:11], v[224:227], v[24:27], v[8:11]
v_and_b32_dpp v24, v23, v2 row_newbcast:11 row_mask:0xf bank_mask:0xf
v_and_b32_dpp v25, v23, v3 row_newbcast:11 row_mask:0xf bank_mask:0xf
v_and_b32_dpp v26, v23, v4 row_newbcast:11 row_mask:0xf bank_mask:0xf
v_and_b32_dpp v27, v23, v5 row_newbcast:11 row_mask:0xf bank_mask:0xf
v_mfma_f32_16x16x32_bf16 v[8:11], v[228:231], v[28:31], v[8:11]
v_and_b32_dpp v28, v23, v2 row_newbcast:15 row_mask:0xf bank_mask:0xf
v_and_b32_dpp v29, v23, v3 row_newbcast:15 row_mask:0xf bank_mask:0xf
v_and_b32_dpp v30, v23, v4 row_newbcast:15 row_mask:0xf bank_mask:0xf
v_and_b32_dpp v31, v23, v5 row_newbcast:15 row_mask:0xf bank_mask:0xf
v_mfma_f32_16x16x32_bf16 v[8:11], v[232:235], v[24:27], v[8:11]
s_nop 0
v_mfma_f32_16x16x32_bf16 v[8:11], v[236:239], v[28:31], v[8:11]
ds_read_b128 v[176:179], v44 offset:32768
ds_read_b128 v[180:183], v44 offset:33792
ds_read_b128 v[184:187], v44 offset:34816
ds_read_b128 v[188:191], v44 offset:35840
s_cmp_lt_u32 s3, 2
s_cbranch_scc1 SK_79
s_add_u32 s57, s63, 360448
buffer_load_dwordx4 v[192:195], v1, s[12:15], s57 offen offset:0 nt
buffer_load_dwordx4 v[196:199], v1, s[12:15], s57 offen offset:1024 nt
buffer_load_dwordx4 v[200:203], v1, s[12:15], s57 offen offset:2048 nt
buffer_load_dwordx4 v[204:207], v1, s[12:15], s57 offen offset:3072 nt
s_branch SK_80
SK_79:
ds_read_b128 v[192:195], v44 offset:36864
ds_read_b128 v[196:199], v44 offset:37888
ds_read_b128 v[200:203], v44 offset:38912
ds_read_b128 v[204:207], v44 offset:39936
SK_80:
s_xor_b32 s57, s2, 4
s_lshl_b32 s57, s57, 7
s_add_u32 s57, s57, 2097152
s_add_u32 s0, s46, s57
s_addc_u32 s1, s47, 0
s_load_dword s20, s[0:1], 0 glc
v_and_b32 v22, 0xffff0000, v13
v_fmamk_f32 v23, v22, 0x3e0293ee, v6
v_cmp_lt_f32 vcc, 0, v23
s_cbranch_vccnz RS_81
RB_82:
v_exp_f32 v23, v23
s_nop 0
v_add_f32 v7, v7, v23
v_cvt_pk_bf16_f32 v23, v23, v23
s_nop 1
v_and_b32_dpp v24, v23, v2 row_newbcast:0 row_mask:0xf bank_mask:0xf
v_and_b32_dpp v25, v23, v3 row_newbcast:0 row_mask:0xf bank_mask:0xf
v_and_b32_dpp v26, v23, v4 row_newbcast:0 row_mask:0xf bank_mask:0xf
v_and_b32_dpp v27, v23, v5 row_newbcast:0 row_mask:0xf bank_mask:0xf
v_and_b32_dpp v28, v23, v2 row_newbcast:4 row_mask:0xf bank_mask:0xf
v_and_b32_dpp v29, v23, v3 row_newbcast:4 row_mask:0xf bank_mask:0xf
v_and_b32_dpp v30, v23, v4 row_newbcast:4 row_mask:0xf bank_mask:0xf
v_and_b32_dpp v31, v23, v5 row_newbcast:4 row_mask:0xf bank_mask:0xf
v_mfma_f32_16x16x32_bf16 v[8:11], v[112:115], v[24:27], v[8:11]
v_and_b32_dpp v24, v23, v2 row_newbcast:8 row_mask:0xf bank_mask:0xf
v_and_b32_dpp v25, v23, v3 row_newbcast:8 row_mask:0xf bank_mask:0xf
v_and_b32_dpp v26, v23, v4 row_newbcast:8 row_mask:0xf bank_mask:0xf
v_and_b32_dpp v27, v23, v5 row_newbcast:8 row_mask:0xf bank_mask:0xf
v_mfma_f32_16x16x32_bf16 v[8:11], v[116:119], v[28:31], v[8:11]
v_and_b32_dpp v28, v23, v2 row_newbcast:12 row_mask:0xf bank_mask:0xf
v_and_b32_dpp v29, v23, v3 row_newbcast:12 row_mask:0xf bank_mask:0xf
v_and_b32_dpp v30, v23, v4 row_newbcast:12 row_mask:0xf bank_mask:0xf
v_and_b32_dpp v31, v23, v5 row_newbcast:12 row_mask:0xf bank_mask:0xf
v_mfma_f32_16x16x32_bf16 v[8:11], v[120:123], v[24:27], v[8:11]
s_nop 0
v_mfma_f32_16x16x32_bf16 v[8:11], v[124:127], v[28:31], v[8:11]
v_and_b32_dpp v24, v23, v2 row_newbcast:1 row_mask:0xf bank_mask:0xf
v_and_b32_dpp v25, v23, v3 row_newbcast:1 row_mask:0xf bank_mask:0xf
v_and_b32_dpp v26, v23, v4 row_newbcast:1 row_mask:0xf bank_mask:0xf
v_and_b32_dpp v27, v23, v5 row_newbcast:1 row_mask:0xf bank_mask:0xf
v_and_b32_dpp v28, v23, v2 row_newbcast:5 row_mask:0xf bank_mask:0xf
v_and_b32_dpp v29, v23, v3 row_newbcast:5 row_mask:0xf bank_mask:0xf
v_and_b32_dpp v30, v23, v4 row_newbcast:5 row_mask:0xf bank_mask:0xf
v_and_b32_dpp v31, v23, v5 row_newbcast:5 row_mask:0xf bank_mask:0xf
v_mfma_f32_16x16x32_bf16 v[8:11], v[128:131], v[24:27], v[8:11]
v_and_b32_dpp v24, v23, v2 row_newbcast:9 row_mask:0xf bank_mask:0xf
v_and_b32_dpp v25, v23, v3 row_newbcast:9 row_mask:0xf bank_mask:0xf
v_and_b32_dpp v26, v23, v4 row_newbcast:9 row_mask:0xf bank_mask:0xf
v_and_b32_dpp v27, v23, v5 row_newbcast:9 row_mask:0xf bank_mask:0xf
v_mfma_f32_16x16x32_bf16 v[8:11], v[132:135], v[28:31], v[8:11]
v_and_b32_dpp v28, v23, v2 row_newbcast:13 row_mask:0xf bank_mask:0xf
v_and_b32_dpp v29, v23, v3 row_newbcast:13 row_mask:0xf bank_mask:0xf
v_and_b32_dpp v30, v23, v4 row_newbcast:13 row_mask:0xf bank_mask:0xf
v_and_b32_dpp v31, v23, v5 row_newbcast:13 row_mask:0xf bank_mask:0xf
v_mfma_f32_16x16x32_bf16 v[8:11], v[136:139], v[24:27], v[8:11]
s_nop 0
v_mfma_f32_16x16x32_bf16 v[8:11], v[140:143], v[28:31], v[8:11]
v_and_b32_dpp v24, v23, v2 row_newbcast:2 row_mask:0xf bank_mask:0xf
v_and_b32_dpp v25, v23, v3 row_newbcast:2 row_mask:0xf bank_mask:0xf
v_and_b32_dpp v26, v23, v4 row_newbcast:2 row_mask:0xf bank_mask:0xf
v_and_b32_dpp v27, v23, v5 row_newbcast:2 row_mask:0xf bank_mask:0xf
v_and_b32_dpp v28, v23, v2 row_newbcast:6 row_mask:0xf bank_mask:0xf
v_and_b32_dpp v29, v23, v3 row_newbcast:6 row_mask:0xf bank_mask:0xf
v_and_b32_dpp v30, v23, v4 row_newbcast:6 row_mask:0xf bank_mask:0xf
v_and_b32_dpp v31, v23, v5 row_newbcast:6 row_mask:0xf bank_mask:0xf
v_mfma_f32_16x16x32_bf16 v[8:11], v[144:147], v[24:27], v[8:11]
v_and_b32_dpp v24, v23, v2 row_newbcast:10 row_mask:0xf bank_mask:0xf
v_and_b32_dpp v25, v23, v3 row_newbcast:10 row_mask:0xf bank_mask:0xf
v_and_b32_dpp v26, v23, v4 row_newbcast:10 row_mask:0xf bank_mask:0xf
v_and_b32_dpp v27, v23, v5 row_newbcast:10 row_mask:0xf bank_mask:0xf
v_mfma_f32_16x16x32_bf16 v[8:11], v[148:151], v[28:31], v[8:11]
v_and_b32_dpp v28, v23, v2 row_newbcast:14 row_mask:0xf bank_mask:0xf
v_and_b32_dpp v29, v23, v3 row_newbcast:14 row_mask:0xf bank_mask:0xf
v_and_b32_dpp v30, v23, v4 row_newbcast:14 row_mask:0xf bank_mask:0xf
v_and_b32_dpp v31, v23, v5 row_newbcast:14 row_mask:0xf bank_mask:0xf
v_mfma_f32_16x16x32_bf16 v[8:11], v[152:155], v[24:27], v[8:11]
s_nop 0
v_mfma_f32_16x16x32_bf16 v[8:11], v[156:159], v[28:31], v[8:11]
v_and_b32_dpp v24, v23, v2 row_newbcast:3 row_mask:0xf bank_mask:0xf
v_and_b32_dpp v25, v23, v3 row_newbcast:3 row_mask:0xf bank_mask:0xf
v_and_b32_dpp v26, v23, v4 row_newbcast:3 row_mask:0xf bank_mask:0xf
v_and_b32_dpp v27, v23, v5 row_newbcast:3 row_mask:0xf bank_mask:0xf
v_and_b32_dpp v28, v23, v2 row_newbcast:7 row_mask:0xf bank_mask:0xf
v_and_b32_dpp v29, v23, v3 row_newbcast:7 row_mask:0xf bank_mask:0xf
v_and_b32_dpp v30, v23, v4 row_newbcast:7 row_mask:0xf bank_mask:0xf
v_and_b32_dpp v31, v23, v5 row_newbcast:7 row_mask:0xf bank_mask:0xf
v_mfma_f32_16x16x32_bf16 v[8:11], v[160:163], v[24:27], v[8:11]
v_and_b32_dpp v24, v23, v2 row_newbcast:11 row_mask:0xf bank_mask:0xf
v_and_b32_dpp v25, v23, v3 row_newbcast:11 row_mask:0xf bank_mask:0xf
v_and_b32_dpp v26, v23, v4 row_newbcast:11 row_mask:0xf bank_mask:0xf
v_and_b32_dpp v27, v23, v5 row_newbcast:11 row_mask:0xf bank_mask:0xf
v_mfma_f32_16x16x32_bf16 v[8:11], v[164:167], v[28:31], v[8:11]
v_and_b32_dpp v28, v23, v2 row_newbcast:15 row_mask:0xf bank_mask:0xf
v_and_b32_dpp v29, v23, v3 row_newbcast:15 row_mask:0xf bank_mask:0xf
v_and_b32_dpp v30, v23, v4 row_newbcast:15 row_mask:0xf bank_mask:0xf
v_and_b32_dpp v31, v23, v5 row_newbcast:15 row_mask:0xf bank_mask:0xf
v_mfma_f32_16x16x32_bf16 v[8:11], v[168:171], v[24:27], v[8:11]
s_nop 0
v_mfma_f32_16x16x32_bf16 v[8:11], v[172:175], v[28:31], v[8:11]
v_and_b32 v22, 0xffff0000, v15
s_waitcnt lgkmcnt(0)
s_cmp_lt_i32 s20, 4
s_cbranch_scc1 LV_83_SLOW
LV_83_OK:
v_mov_b32 v47, 1
s_mov_b64 exec, 1
buffer_atomic_add v47, v16, s[16:19], s76 offen sc0 sc1
s_mov_b64 exec, -1
s_add_u32 s75, s73, 1024
buffer_load_dword v41, v1, s[16:19], s75 offen sc1
s_add_u32 s75, s73, 1028
buffer_load_dword v46, v1, s[16:19], s75 offen sc1
v_fmamk_f32 v23, v22, 0x3e0293ee, v6
v_cmp_lt_f32 vcc, 0, v23
s_cbranch_vccnz RS_84
RB_85:
v_exp_f32 v23, v23
s_nop 0
v_add_f32 v7, v7, v23
v_cvt_pk_bf16_f32 v23, v23, v23
s_nop 1
v_and_b32_dpp v24, v23, v2 row_newbcast:0 row_mask:0xf bank_mask:0xf
v_and_b32_dpp v25, v23, v3 row_newbcast:0 row_mask:0xf bank_mask:0xf
v_and_b32_dpp v26, v23, v4 row_newbcast:0 row_mask:0xf bank_mask:0xf
v_and_b32_dpp v27, v23, v5 row_newbcast:0 row_mask:0xf bank_mask:0xf
v_and_b32_dpp v28, v23, v2 row_newbcast:4 row_mask:0xf bank_mask:0xf
v_and_b32_dpp v29, v23, v3 row_newbcast:4 row_mask:0xf bank_mask:0xf
v_and_b32_dpp v30, v23, v4 row_newbcast:4 row_mask:0xf bank_mask:0xf
v_and_b32_dpp v31, v23, v5 row_newbcast:4 row_mask:0xf bank_mask:0xf
v_mfma_f32_16x16x32_bf16 v[8:11], a[0:3], v[24:27], v[8:11]
v_and_b32_dpp v24, v23, v2 row_newbcast:8 row_mask:0xf bank_mask:0xf
v_and_b32_dpp v25, v23, v3 row_newbcast:8 row_mask:0xf bank_mask:0xf
v_and_b32_dpp v26, v23, v4 row_newbcast:8 row_mask:0xf bank_mask:0xf
v_and_b32_dpp v27, v23, v5 row_newbcast:8 row_mask:0xf bank_mask:0xf
v_mfma_f32_16x16x32_bf16 v[8:11], a[4:7], v[28:31], v[8:11]
v_and_b32_dpp v28, v23, v2 row_newbcast:12 row_mask:0xf bank_mask:0xf
v_and_b32_dpp v29, v23, v3 row_newbcast:12 row_mask:0xf bank_mask:0xf
v_and_b32_dpp v30, v23, v4 row_newbcast:12 row_mask:0xf bank_mask:0xf
v_and_b32_dpp v31, v23, v5 row_newbcast:12 row_mask:0xf bank_mask:0xf
v_mfma_f32_16x16x32_bf16 v[8:11], a[8:11], v[24:27], v[8:11]
s_nop 0
v_mfma_f32_16x16x32_bf16 v[8:11], a[12:15], v[28:31], v[8:11]
s_add_u32 s57, s63, 1441792
buffer_load_dwordx4 a[0:3], v1, s[12:15], s57 offen offset:0 nt
buffer_load_dwordx4 a[4:7], v1, s[12:15], s57 offen offset:1024 nt
buffer_load_dwordx4 a[8:11], v1, s[12:15], s57 offen offset:2048 nt
buffer_load_dwordx4 a[12:15], v1, s[12:15], s57 offen offset:3072 nt
v_and_b32_dpp v24, v23, v2 row_newbcast:1 row_mask:0xf bank_mask:0xf
v_and_b32_dpp v25, v23, v3 row_newbcast:1 row_mask:0xf bank_mask:0xf
v_and_b32_dpp v26, v23, v4 row_newbcast:1 row_mask:0xf bank_mask:0xf
v_and_b32_dpp v27, v23, v5 row_newbcast:1 row_mask:0xf bank_mask:0xf
v_and_b32_dpp v28, v23, v2 row_newbcast:5 row_mask:0xf bank_mask:0xf
v_and_b32_dpp v29, v23, v3 row_newbcast:5 row_mask:0xf bank_mask:0xf
v_and_b32_dpp v30, v23, v4 row_newbcast:5 row_mask:0xf bank_mask:0xf
v_and_b32_dpp v31, v23, v5 row_newbcast:5 row_mask:0xf bank_mask:0xf
v_mfma_f32_16x16x32_bf16 v[8:11], a[16:19], v[24:27], v[8:11]
v_and_b32_dpp v24, v23, v2 row_newbcast:9 row_mask:0xf bank_mask:0xf
v_and_b32_dpp v25, v23, v3 row_newbcast:9 row_mask:0xf bank_mask:0xf
v_and_b32_dpp v26, v23, v4 row_newbcast:9 row_mask:0xf bank_mask:0xf
v_and_b32_dpp v27, v23, v5 row_newbcast:9 row_mask:0xf bank_mask:0xf
v_mfma_f32_16x16x32_bf16 v[8:11], a[20:23], v[28:31], v[8:11]
v_and_b32_dpp v28, v23, v2 row_newbcast:13 row_mask:0xf bank_mask:0xf
v_and_b32_dpp v29, v23, v3 row_newbcast:13 row_mask:0xf bank_mask:0xf
v_and_b32_dpp v30, v23, v4 row_newbcast:13 row_mask:0xf bank_mask:0xf
v_and_b32_dpp v31, v23, v5 row_newbcast:13 row_mask:0xf bank_mask:0xf
v_mfma_f32_16x16x32_bf16 v[8:11], a[24:27], v[24:27], v[8:11]
s_nop 0
v_mfma_f32_16x16x32_bf16 v[8:11], a[28:31], v[28:31], v[8:11]
s_add_u32 s57, s63, 1474560
buffer_load_dwordx4 a[16:19], v1, s[12:15], s57 offen offset:0 nt
buffer_load_dwordx4 a[20:23], v1, s[12:15], s57 offen offset:1024 nt
buffer_load_dwordx4 a[24:27], v1, s[12:15], s57 offen offset:2048 nt
buffer_load_dwordx4 a[28:31], v1, s[12:15], s57 offen offset:3072 nt
v_and_b32_dpp v24, v23, v2 row_newbcast:2 row_mask:0xf bank_mask:0xf
v_and_b32_dpp v25, v23, v3 row_newbcast:2 row_mask:0xf bank_mask:0xf
v_and_b32_dpp v26, v23, v4 row_newbcast:2 row_mask:0xf bank_mask:0xf
v_and_b32_dpp v27, v23, v5 row_newbcast:2 row_mask:0xf bank_mask:0xf
v_and_b32_dpp v28, v23, v2 row_newbcast:6 row_mask:0xf bank_mask:0xf
v_and_b32_dpp v29, v23, v3 row_newbcast:6 row_mask:0xf bank_mask:0xf
v_and_b32_dpp v30, v23, v4 row_newbcast:6 row_mask:0xf bank_mask:0xf
v_and_b32_dpp v31, v23, v5 row_newbcast:6 row_mask:0xf bank_mask:0xf
v_mfma_f32_16x16x32_bf16 v[8:11], a[32:35], v[24:27], v[8:11]
v_and_b32_dpp v24, v23, v2 row_newbcast:10 row_mask:0xf bank_mask:0xf
v_and_b32_dpp v25, v23, v3 row_newbcast:10 row_mask:0xf bank_mask:0xf
v_and_b32_dpp v26, v23, v4 row_newbcast:10 row_mask:0xf bank_mask:0xf
v_and_b32_dpp v27, v23, v5 row_newbcast:10 row_mask:0xf bank_mask:0xf
v_mfma_f32_16x16x32_bf16 v[8:11], a[36:39], v[28:31], v[8:11]
v_and_b32_dpp v28, v23, v2 row_newbcast:14 row_mask:0xf bank_mask:0xf
v_and_b32_dpp v29, v23, v3 row_newbcast:14 row_mask:0xf bank_mask:0xf
v_and_b32_dpp v30, v23, v4 row_newbcast:14 row_mask:0xf bank_mask:0xf
v_and_b32_dpp v31, v23, v5 row_newbcast:14 row_mask:0xf bank_mask:0xf
v_mfma_f32_16x16x32_bf16 v[8:11], a[40:43], v[24:27], v[8:11]
s_nop 0
v_mfma_f32_16x16x32_bf16 v[8:11], a[44:47], v[28:31], v[8:11]
s_add_u32 s57, s63, 1507328
buffer_load_dwordx4 a[32:35], v1, s[12:15], s57 offen offset:0 nt
buffer_load_dwordx4 a[36:39], v1, s[12:15], s57 offen offset:1024 nt
buffer_load_dwordx4 a[40:43], v1, s[12:15], s57 offen offset:2048 nt
buffer_load_dwordx4 a[44:47], v1, s[12:15], s57 offen offset:3072 nt
v_and_b32_dpp v24, v23, v2 row_newbcast:3 row_mask:0xf bank_mask:0xf
v_and_b32_dpp v25, v23, v3 row_newbcast:3 row_mask:0xf bank_mask:0xf
v_and_b32_dpp v26, v23, v4 row_newbcast:3 row_mask:0xf bank_mask:0xf
v_and_b32_dpp v27, v23, v5 row_newbcast:3 row_mask:0xf bank_mask:0xf
v_and_b32_dpp v28, v23, v2 row_newbcast:7 row_mask:0xf bank_mask:0xf
v_and_b32_dpp v29, v23, v3 row_newbcast:7 row_mask:0xf bank_mask:0xf
v_and_b32_dpp v30, v23, v4 row_newbcast:7 row_mask:0xf bank_mask:0xf
v_and_b32_dpp v31, v23, v5 row_newbcast:7 row_mask:0xf bank_mask:0xf
v_mfma_f32_16x16x32_bf16 v[8:11], a[48:51], v[24:27], v[8:11]
v_and_b32_dpp v24, v23, v2 row_newbcast:11 row_mask:0xf bank_mask:0xf
v_and_b32_dpp v25, v23, v3 row_newbcast:11 row_mask:0xf bank_mask:0xf
v_and_b32_dpp v26, v23, v4 row_newbcast:11 row_mask:0xf bank_mask:0xf
v_and_b32_dpp v27, v23, v5 row_newbcast:11 row_mask:0xf bank_mask:0xf
v_mfma_f32_16x16x32_bf16 v[8:11], a[52:55], v[28:31], v[8:11]
v_and_b32_dpp v28, v23, v2 row_newbcast:15 row_mask:0xf bank_mask:0xf
v_and_b32_dpp v29, v23, v3 row_newbcast:15 row_mask:0xf bank_mask:0xf
v_and_b32_dpp v30, v23, v4 row_newbcast:15 row_mask:0xf bank_mask:0xf
v_and_b32_dpp v31, v23, v5 row_newbcast:15 row_mask:0xf bank_mask:0xf
v_mfma_f32_16x16x32_bf16 v[8:11], a[56:59], v[24:27], v[8:11]
s_nop 0
v_mfma_f32_16x16x32_bf16 v[8:11], a[60:63], v[28:31], v[8:11]
s_add_u32 s57, s63, 1540096
buffer_load_dwordx4 a[48:51], v1, s[12:15], s57 offen offset:0 nt
buffer_load_dwordx4 a[52:55], v1, s[12:15], s57 offen offset:1024 nt
buffer_load_dwordx4 a[56:59], v1, s[12:15], s57 offen offset:2048 nt
buffer_load_dwordx4 a[60:63], v1, s[12:15], s57 offen offset:3072 nt
ds_read_b128 v[112:115], v44 offset:0
ds_read_b128 v[116:119], v44 offset:1024
ds_read_b128 v[120:123], v44 offset:2048
ds_read_b128 v[124:127], v44 offset:3072
ds_read_b128 v[128:131], v44 offset:4096
ds_read_b128 v[132:135], v44 offset:5120
ds_read_b128 v[136:139], v44 offset:6144
ds_read_b128 v[140:143], v44 offset:7168
ds_read_b128 v[144:147], v44 offset:8192
ds_read_b128 v[148:151], v44 offset:9216
ds_read_b128 v[152:155], v44 offset:10240
ds_read_b128 v[156:159], v44 offset:11264
ds_read_b128 v[160:163], v44 offset:12288
ds_read_b128 v[164:167], v44 offset:13312
ds_read_b128 v[168:171], v44 offset:14336
ds_read_b128 v[172:175], v44 offset:15360
v_and_b32 v22, 0xffff0000, v14
v_fmamk_f32 v23, v22, 0x3e0293ee, v6
v_cmp_lt_f32 vcc, 0, v23
s_cbranch_vccnz RS_86
RB_87:
v_exp_f32 v23, v23
s_nop 0
v_add_f32 v7, v7, v23
v_cvt_pk_bf16_f32 v23, v23, v23
s_waitcnt lgkmcnt(0)
s_nop 0
v_and_b32_dpp v24, v23, v2 row_newbcast:0 row_mask:0xf bank_mask:0xf
v_and_b32_dpp v25, v23, v3 row_newbcast:0 row_mask:0xf bank_mask:0xf
v_and_b32_dpp v26, v23, v4 row_newbcast:0 row_mask:0xf bank_mask:0xf
v_and_b32_dpp v27, v23, v5 row_newbcast:0 row_mask:0xf bank_mask:0xf
v_and_b32_dpp v28, v23, v2 row_newbcast:4 row_mask:0xf bank_mask:0xf
v_and_b32_dpp v29, v23, v3 row_newbcast:4 row_mask:0xf bank_mask:0xf
v_and_b32_dpp v30, v23, v4 row_newbcast:4 row_mask:0xf bank_mask:0xf
v_and_b32_dpp v31, v23, v5 row_newbcast:4 row_mask:0xf bank_mask:0xf
v_mfma_f32_16x16x32_bf16 v[8:11], v[112:115], v[24:27], v[8:11]
v_and_b32_dpp v24, v23, v2 row_newbcast:8 row_mask:0xf bank_mask:0xf
v_and_b32_dpp v25, v23, v3 row_newbcast:8 row_mask:0xf bank_mask:0xf
v_and_b32_dpp v26, v23, v4 row_newbcast:8 row_mask:0xf bank_mask:0xf
v_and_b32_dpp v27, v23, v5 row_newbcast:8 row_mask:0xf bank_mask:0xf
v_mfma_f32_16x16x32_bf16 v[8:11], v[116:119], v[28:31], v[8:11]
v_and_b32_dpp v28, v23, v2 row_newbcast:12 row_mask:0xf bank_mask:0xf
v_and_b32_dpp v29, v23, v3 row_newbcast:12 row_mask:0xf bank_mask:0xf
v_and_b32_dpp v30, v23, v4 row_newbcast:12 row_mask:0xf bank_mask:0xf
v_and_b32_dpp v31, v23, v5 row_newbcast:12 row_mask:0xf bank_mask:0xf
v_mfma_f32_16x16x32_bf16 v[8:11], v[120:123], v[24:27], v[8:11]
s_nop 0
v_mfma_f32_16x16x32_bf16 v[8:11], v[124:127], v[28:31], v[8:11]
v_and_b32_dpp v24, v23, v2 row_newbcast:1 row_mask:0xf bank_mask:0xf
v_and_b32_dpp v25, v23, v3 row_newbcast:1 row_mask:0xf bank_mask:0xf
v_and_b32_dpp v26, v23, v4 row_newbcast:1 row_mask:0xf bank_mask:0xf
v_and_b32_dpp v27, v23, v5 row_newbcast:1 row_mask:0xf bank_mask:0xf
v_and_b32_dpp v28, v23, v2 row_newbcast:5 row_mask:0xf bank_mask:0xf
v_and_b32_dpp v29, v23, v3 row_newbcast:5 row_mask:0xf bank_mask:0xf
v_and_b32_dpp v30, v23, v4 row_newbcast:5 row_mask:0xf bank_mask:0xf
v_and_b32_dpp v31, v23, v5 row_newbcast:5 row_mask:0xf bank_mask:0xf
v_mfma_f32_16x16x32_bf16 v[8:11], v[128:131], v[24:27], v[8:11]
v_and_b32_dpp v24, v23, v2 row_newbcast:9 row_mask:0xf bank_mask:0xf
v_and_b32_dpp v25, v23, v3 row_newbcast:9 row_mask:0xf bank_mask:0xf
v_and_b32_dpp v26, v23, v4 row_newbcast:9 row_mask:0xf bank_mask:0xf
v_and_b32_dpp v27, v23, v5 row_newbcast:9 row_mask:0xf bank_mask:0xf
v_mfma_f32_16x16x32_bf16 v[8:11], v[132:135], v[28:31], v[8:11]
v_and_b32_dpp v28, v23, v2 row_newbcast:13 row_mask:0xf bank_mask:0xf
v_and_b32_dpp v29, v23, v3 row_newbcast:13 row_mask:0xf bank_mask:0xf
v_and_b32_dpp v30, v23, v4 row_newbcast:13 row_mask:0xf bank_mask:0xf
v_and_b32_dpp v31, v23, v5 row_newbcast:13 row_mask:0xf bank_mask:0xf
v_mfma_f32_16x16x32_bf16 v[8:11], v[136:139], v[24:27], v[8:11]
s_nop 0
v_mfma_f32_16x16x32_bf16 v[8:11], v[140:143], v[28:31], v[8:11]
v_and_b32_dpp v24, v23, v2 row_newbcast:2 row_mask:0xf bank_mask:0xf
v_and_b32_dpp v25, v23, v3 row_newbcast:2 row_mask:0xf bank_mask:0xf
v_and_b32_dpp v26, v23, v4 row_newbcast:2 row_mask:0xf bank_mask:0xf
v_and_b32_dpp v27, v23, v5 row_newbcast:2 row_mask:0xf bank_mask:0xf
v_and_b32_dpp v28, v23, v2 row_newbcast:6 row_mask:0xf bank_mask:0xf
v_and_b32_dpp v29, v23, v3 row_newbcast:6 row_mask:0xf bank_mask:0xf
v_and_b32_dpp v30, v23, v4 row_newbcast:6 row_mask:0xf bank_mask:0xf
v_and_b32_dpp v31, v23, v5 row_newbcast:6 row_mask:0xf bank_mask:0xf
v_mfma_f32_16x16x32_bf16 v[8:11], v[144:147], v[24:27], v[8:11]
v_and_b32_dpp v24, v23, v2 row_newbcast:10 row_mask:0xf bank_mask:0xf
v_and_b32_dpp v25, v23, v3 row_newbcast:10 row_mask:0xf bank_mask:0xf
v_and_b32_dpp v26, v23, v4 row_newbcast:10 row_mask:0xf bank_mask:0xf
v_and_b32_dpp v27, v23, v5 row_newbcast:10 row_mask:0xf bank_mask:0xf
v_mfma_f32_16x16x32_bf16 v[8:11], v[148:151], v[28:31], v[8:11]
v_and_b32_dpp v28, v23, v2 row_newbcast:14 row_mask:0xf bank_mask:0xf
v_and_b32_dpp v29, v23, v3 row_newbcast:14 row_mask:0xf bank_mask:0xf
v_and_b32_dpp v30, v23, v4 row_newbcast:14 row_mask:0xf bank_mask:0xf
v_and_b32_dpp v31, v23, v5 row_newbcast:14 row_mask:0xf bank_mask:0xf
v_mfma_f32_16x16x32_bf16 v[8:11], v[152:155], v[24:27], v[8:11]
s_nop 0
v_mfma_f32_16x16x32_bf16 v[8:11], v[156:159], v[28:31], v[8:11]
v_and_b32_dpp v24, v23, v2 row_newbcast:3 row_mask:0xf bank_mask:0xf
v_and_b32_dpp v25, v23, v3 row_newbcast:3 row_mask:0xf bank_mask:0xf
v_and_b32_dpp v26, v23, v4 row_newbcast:3 row_mask:0xf bank_mask:0xf
v_and_b32_dpp v27, v23, v5 row_newbcast:3 row_mask:0xf bank_mask:0xf
v_and_b32_dpp v28, v23, v2 row_newbcast:7 row_mask:0xf bank_mask:0xf
v_and_b32_dpp v29, v23, v3 row_newbcast:7 row_mask:0xf bank_mask:0xf
v_and_b32_dpp v30, v23, v4 row_newbcast:7 row_mask:0xf bank_mask:0xf
v_and_b32_dpp v31, v23, v5 row_newbcast:7 row_mask:0xf bank_mask:0xf
v_mfma_f32_16x16x32_bf16 v[8:11], v[160:163], v[24:27], v[8:11]
v_and_b32_dpp v24, v23, v2 row_newbcast:11 row_mask:0xf bank_mask:0xf
v_and_b32_dpp v25, v23, v3 row_newbcast:11 row_mask:0xf bank_mask:0xf
v_and_b32_dpp v26, v23, v4 row_newbcast:11 row_mask:0xf bank_mask:0xf
v_and_b32_dpp v27, v23, v5 row_newbcast:11 row_mask:0xf bank_mask:0xf
v_mfma_f32_16x16x32_bf16 v[8:11], v[164:167], v[28:31], v[8:11]
v_and_b32_dpp v28, v23, v2 row_newbcast:15 row_mask:0xf bank_mask:0xf
v_and_b32_dpp v29, v23, v3 row_newbcast:15 row_mask:0xf bank_mask:0xf
v_and_b32_dpp v30, v23, v4 row_newbcast:15 row_mask:0xf bank_mask:0xf
v_and_b32_dpp v31, v23, v5 row_newbcast:15 row_mask:0xf bank_mask:0xf
v_mfma_f32_16x16x32_bf16 v[8:11], v[168:171], v[24:27], v[8:11]
s_nop 0
v_mfma_f32_16x16x32_bf16 v[8:11], v[172:175], v[28:31], v[8:11]
ds_read_b128 v[112:115], v44 offset:16384
ds_read_b128 v[116:119], v44 offset:17408
ds_read_b128 v[120:123], v44 offset:18432
ds_read_b128 v[124:127], v44 offset:19456
ds_read_b128 v[128:131], v44 offset:20480
ds_read_b128 v[132:135], v44 offset:21504
ds_read_b128 v[136:139], v44 offset:22528
ds_read_b128 v[140:143], v44 offset:23552
ds_read_b128 v[144:147], v44 offset:24576
ds_read_b128 v[148:151], v44 offset:25600
ds_read_b128 v[152:155], v44 offset:26624
ds_read_b128 v[156:159], v44 offset:27648
ds_read_b128 v[160:163], v44 offset:28672
ds_read_b128 v[164:167], v44 offset:29696
ds_read_b128 v[168:171], v44 offset:30720
ds_read_b128 v[172:175], v44 offset:31744
v_lshlrev_b32 v22, 16, v15
v_fmamk_f32 v23, v22, 0x3e0293ee, v6
v_cmp_lt_f32 vcc, 0, v23
s_cbranch_vccnz RS_88
RB_89:
v_exp_f32 v23, v23
s_nop 0
v_add_f32 v7, v7, v23
v_cvt_pk_bf16_f32 v23, v23, v23
s_waitcnt lgkmcnt(0)
s_nop 0
v_and_b32_dpp v24, v23, v2 row_newbcast:0 row_mask:0xf bank_mask:0xf
v_and_b32_dpp v25, v23, v3 row_newbcast:0 row_mask:0xf bank_mask:0xf
v_and_b32_dpp v26, v23, v4 row_newbcast:0 row_mask:0xf bank_mask:0xf
v_and_b32_dpp v27, v23, v5 row_newbcast:0 row_mask:0xf bank_mask:0xf
v_and_b32_dpp v28, v23, v2 row_newbcast:4 row_mask:0xf bank_mask:0xf
v_and_b32_dpp v29, v23, v3 row_newbcast:4 row_mask:0xf bank_mask:0xf
v_and_b32_dpp v30, v23, v4 row_newbcast:4 row_mask:0xf bank_mask:0xf
v_and_b32_dpp v31, v23, v5 row_newbcast:4 row_mask:0xf bank_mask:0xf
v_mfma_f32_16x16x32_bf16 v[8:11], v[112:115], v[24:27], v[8:11]
v_and_b32_dpp v24, v23, v2 row_newbcast:8 row_mask:0xf bank_mask:0xf
v_and_b32_dpp v25, v23, v3 row_newbcast:8 row_mask:0xf bank_mask:0xf
v_and_b32_dpp v26, v23, v4 row_newbcast:8 row_mask:0xf bank_mask:0xf
v_and_b32_dpp v27, v23, v5 row_newbcast:8 row_mask:0xf bank_mask:0xf
v_mfma_f32_16x16x32_bf16 v[8:11], v[116:119], v[28:31], v[8:11]
v_and_b32_dpp v28, v23, v2 row_newbcast:12 row_mask:0xf bank_mask:0xf
v_and_b32_dpp v29, v23, v3 row_newbcast:12 row_mask:0xf bank_mask:0xf
v_and_b32_dpp v30, v23, v4 row_newbcast:12 row_mask:0xf bank_mask:0xf
v_and_b32_dpp v31, v23, v5 row_newbcast:12 row_mask:0xf bank_mask:0xf
v_mfma_f32_16x16x32_bf16 v[8:11], v[120:123], v[24:27], v[8:11]
s_nop 0
v_mfma_f32_16x16x32_bf16 v[8:11], v[124:127], v[28:31], v[8:11]
v_and_b32_dpp v24, v23, v2 row_newbcast:1 row_mask:0xf bank_mask:0xf
v_and_b32_dpp v25, v23, v3 row_newbcast:1 row_mask:0xf bank_mask:0xf
v_and_b32_dpp v26, v23, v4 row_newbcast:1 row_mask:0xf bank_mask:0xf
v_and_b32_dpp v27, v23, v5 row_newbcast:1 row_mask:0xf bank_mask:0xf
v_and_b32_dpp v28, v23, v2 row_newbcast:5 row_mask:0xf bank_mask:0xf
v_and_b32_dpp v29, v23, v3 row_newbcast:5 row_mask:0xf bank_mask:0xf
v_and_b32_dpp v30, v23, v4 row_newbcast:5 row_mask:0xf bank_mask:0xf
v_and_b32_dpp v31, v23, v5 row_newbcast:5 row_mask:0xf bank_mask:0xf
v_mfma_f32_16x16x32_bf16 v[8:11], v[128:131], v[24:27], v[8:11]
v_and_b32_dpp v24, v23, v2 row_newbcast:9 row_mask:0xf bank_mask:0xf
v_and_b32_dpp v25, v23, v3 row_newbcast:9 row_mask:0xf bank_mask:0xf
v_and_b32_dpp v26, v23, v4 row_newbcast:9 row_mask:0xf bank_mask:0xf
v_and_b32_dpp v27, v23, v5 row_newbcast:9 row_mask:0xf bank_mask:0xf
v_mfma_f32_16x16x32_bf16 v[8:11], v[132:135], v[28:31], v[8:11]
v_and_b32_dpp v28, v23, v2 row_newbcast:13 row_mask:0xf bank_mask:0xf
v_and_b32_dpp v29, v23, v3 row_newbcast:13 row_mask:0xf bank_mask:0xf
v_and_b32_dpp v30, v23, v4 row_newbcast:13 row_mask:0xf bank_mask:0xf
v_and_b32_dpp v31, v23, v5 row_newbcast:13 row_mask:0xf bank_mask:0xf
v_mfma_f32_16x16x32_bf16 v[8:11], v[136:139], v[24:27], v[8:11]
s_nop 0
v_mfma_f32_16x16x32_bf16 v[8:11], v[140:143], v[28:31], v[8:11]
v_and_b32_dpp v24, v23, v2 row_newbcast:2 row_mask:0xf bank_mask:0xf
v_and_b32_dpp v25, v23, v3 row_newbcast:2 row_mask:0xf bank_mask:0xf
v_and_b32_dpp v26, v23, v4 row_newbcast:2 row_mask:0xf bank_mask:0xf
v_and_b32_dpp v27, v23, v5 row_newbcast:2 row_mask:0xf bank_mask:0xf
v_and_b32_dpp v28, v23, v2 row_newbcast:6 row_mask:0xf bank_mask:0xf
v_and_b32_dpp v29, v23, v3 row_newbcast:6 row_mask:0xf bank_mask:0xf
v_and_b32_dpp v30, v23, v4 row_newbcast:6 row_mask:0xf bank_mask:0xf
v_and_b32_dpp v31, v23, v5 row_newbcast:6 row_mask:0xf bank_mask:0xf
v_mfma_f32_16x16x32_bf16 v[8:11], v[144:147], v[24:27], v[8:11]
v_and_b32_dpp v24, v23, v2 row_newbcast:10 row_mask:0xf bank_mask:0xf
v_and_b32_dpp v25, v23, v3 row_newbcast:10 row_mask:0xf bank_mask:0xf
v_and_b32_dpp v26, v23, v4 row_newbcast:10 row_mask:0xf bank_mask:0xf
v_and_b32_dpp v27, v23, v5 row_newbcast:10 row_mask:0xf bank_mask:0xf
v_mfma_f32_16x16x32_bf16 v[8:11], v[148:151], v[28:31], v[8:11]
v_and_b32_dpp v28, v23, v2 row_newbcast:14 row_mask:0xf bank_mask:0xf
v_and_b32_dpp v29, v23, v3 row_newbcast:14 row_mask:0xf bank_mask:0xf
v_and_b32_dpp v30, v23, v4 row_newbcast:14 row_mask:0xf bank_mask:0xf
v_and_b32_dpp v31, v23, v5 row_newbcast:14 row_mask:0xf bank_mask:0xf
v_mfma_f32_16x16x32_bf16 v[8:11], v[152:155], v[24:27], v[8:11]
s_nop 0
v_mfma_f32_16x16x32_bf16 v[8:11], v[156:159], v[28:31], v[8:11]
v_and_b32_dpp v24, v23, v2 row_newbcast:3 row_mask:0xf bank_mask:0xf
v_and_b32_dpp v25, v23, v3 row_newbcast:3 row_mask:0xf bank_mask:0xf
v_and_b32_dpp v26, v23, v4 row_newbcast:3 row_mask:0xf bank_mask:0xf
v_and_b32_dpp v27, v23, v5 row_newbcast:3 row_mask:0xf bank_mask:0xf
v_and_b32_dpp v28, v23, v2 row_newbcast:7 row_mask:0xf bank_mask:0xf
v_and_b32_dpp v29, v23, v3 row_newbcast:7 row_mask:0xf bank_mask:0xf
v_and_b32_dpp v30, v23, v4 row_newbcast:7 row_mask:0xf bank_mask:0xf
v_and_b32_dpp v31, v23, v5 row_newbcast:7 row_mask:0xf bank_mask:0xf
v_mfma_f32_16x16x32_bf16 v[8:11], v[160:163], v[24:27], v[8:11]
v_and_b32_dpp v24, v23, v2 row_newbcast:11 row_mask:0xf bank_mask:0xf
v_and_b32_dpp v25, v23, v3 row_newbcast:11 row_mask:0xf bank_mask:0xf
v_and_b32_dpp v26, v23, v4 row_newbcast:11 row_mask:0xf bank_mask:0xf
v_and_b32_dpp v27, v23, v5 row_newbcast:11 row_mask:0xf bank_mask:0xf
v_mfma_f32_16x16x32_bf16 v[8:11], v[164:167], v[28:31], v[8:11]
v_and_b32_dpp v28, v23, v2 row_newbcast:15 row_mask:0xf bank_mask:0xf
v_and_b32_dpp v29, v23, v3 row_newbcast:15 row_mask:0xf bank_mask:0xf
v_and_b32_dpp v30, v23, v4 row_newbcast:15 row_mask:0xf bank_mask:0xf
v_and_b32_dpp v31, v23, v5 row_newbcast:15 row_mask:0xf bank_mask:0xf
v_mfma_f32_16x16x32_bf16 v[8:11], v[168:171], v[24:27], v[8:11]
s_nop 0
v_mfma_f32_16x16x32_bf16 v[8:11], v[172:175], v[28:31], v[8:11]
s_and_b32 s57, s2, 0xf8
s_lshl_b32 s57, s57, 7
s_add_u32 s57, s57, 2097152
s_add_u32 s0, s46, s57
s_addc_u32 s1, s47, 0
s_load_dword s20, s[0:1], 0 glc
s_load_dword s21, s[0:1], 128 glc
s_load_dword s22, s[0:1], 256 glc
s_load_dword s23, s[0:1], 384 glc
s_load_dword s34, s[0:1], 512 glc
s_load_dword s35, s[0:1], 640 glc
s_load_dword s72, s[0:1], 768 glc
s_load_dword s74, s[0:1], 896 glc
s_waitcnt vmcnt(17)
v_lshlrev_b32 v22, 16, v41
v_fmamk_f32 v23, v22, 0x3e0293ee, v6
v_cmp_lt_f32 vcc, 0, v23
s_cbranch_vccnz RS_90
RB_91:
v_exp_f32 v23, v23
s_nop 0
v_add_f32 v7, v7, v23
v_cvt_pk_bf16_f32 v23, v23, v23
s_nop 1
v_and_b32_dpp v24, v23, v2 row_newbcast:0 row_mask:0xf bank_mask:0xf
v_and_b32_dpp v25, v23, v3 row_newbcast:0 row_mask:0xf bank_mask:0xf
v_and_b32_dpp v26, v23, v4 row_newbcast:0 row_mask:0xf bank_mask:0xf
v_and_b32_dpp v27, v23, v5 row_newbcast:0 row_mask:0xf bank_mask:0xf
v_and_b32_dpp v28, v23, v2 row_newbcast:4 row_mask:0xf bank_mask:0xf
v_and_b32_dpp v29, v23, v3 row_newbcast:4 row_mask:0xf bank_mask:0xf
v_and_b32_dpp v30, v23, v4 row_newbcast:4 row_mask:0xf bank_mask:0xf
v_and_b32_dpp v31, v23, v5 row_newbcast:4 row_mask:0xf bank_mask:0xf
v_mfma_f32_16x16x32_bf16 v[8:11], v[48:51], v[24:27], v[8:11]
v_and_b32_dpp v24, v23, v2 row_newbcast:8 row_mask:0xf bank_mask:0xf
v_and_b32_dpp v25, v23, v3 row_newbcast:8 row_mask:0xf bank_mask:0xf
v_and_b32_dpp v26, v23, v4 row_newbcast:8 row_mask:0xf bank_mask:0xf
v_and_b32_dpp v27, v23, v5 row_newbcast:8 row_mask:0xf bank_mask:0xf
v_mfma_f32_16x16x32_bf16 v[8:11], v[52:55], v[28:31], v[8:11]
v_and_b32_dpp v28, v23, v2 row_newbcast:12 row_mask:0xf bank_mask:0xf
v_and_b32_dpp v29, v23, v3 row_newbcast:12 row_mask:0xf bank_mask:0xf
v_and_b32_dpp v30, v23, v4 row_newbcast:12 row_mask:0xf bank_mask:0xf
v_and_b32_dpp v31, v23, v5 row_newbcast:12 row_mask:0xf bank_mask:0xf
v_mfma_f32_16x16x32_bf16 v[8:11], v[56:59], v[24:27], v[8:11]
s_nop 0
v_mfma_f32_16x16x32_bf16 v[8:11], v[60:63], v[28:31], v[8:11]
v_and_b32_dpp v24, v23, v2 row_newbcast:1 row_mask:0xf bank_mask:0xf
v_and_b32_dpp v25, v23, v3 row_newbcast:1 row_mask:0xf bank_mask:0xf
v_and_b32_dpp v26, v23, v4 row_newbcast:1 row_mask:0xf bank_mask:0xf
v_and_b32_dpp v27, v23, v5 row_newbcast:1 row_mask:0xf bank_mask:0xf
v_and_b32_dpp v28, v23, v2 row_newbcast:5 row_mask:0xf bank_mask:0xf
v_and_b32_dpp v29, v23, v3 row_newbcast:5 row_mask:0xf bank_mask:0xf
v_and_b32_dpp v30, v23, v4 row_newbcast:5 row_mask:0xf bank_mask:0xf
v_and_b32_dpp v31, v23, v5 row_newbcast:5 row_mask:0xf bank_mask:0xf
v_mfma_f32_16x16x32_bf16 v[8:11], v[64:67], v[24:27], v[8:11]
v_and_b32_dpp v24, v23, v2 row_newbcast:9 row_mask:0xf bank_mask:0xf
v_and_b32_dpp v25, v23, v3 row_newbcast:9 row_mask:0xf bank_mask:0xf
v_and_b32_dpp v26, v23, v4 row_newbcast:9 row_mask:0xf bank_mask:0xf
v_and_b32_dpp v27, v23, v5 row_newbcast:9 row_mask:0xf bank_mask:0xf
v_mfma_f32_16x16x32_bf16 v[8:11], v[68:71], v[28:31], v[8:11]
v_and_b32_dpp v28, v23, v2 row_newbcast:13 row_mask:0xf bank_mask:0xf
v_and_b32_dpp v29, v23, v3 row_newbcast:13 row_mask:0xf bank_mask:0xf
v_and_b32_dpp v30, v23, v4 row_newbcast:13 row_mask:0xf bank_mask:0xf
v_and_b32_dpp v31, v23, v5 row_newbcast:13 row_mask:0xf bank_mask:0xf
v_mfma_f32_16x16x32_bf16 v[8:11], v[72:75], v[24:27], v[8:11]
s_nop 0
v_mfma_f32_16x16x32_bf16 v[8:11], v[76:79], v[28:31], v[8:11]
v_and_b32_dpp v24, v23, v2 row_newbcast:2 row_mask:0xf bank_mask:0xf
v_and_b32_dpp v25, v23, v3 row_newbcast:2 row_mask:0xf bank_mask:0xf
v_and_b32_dpp v26, v23, v4 row_newbcast:2 row_mask:0xf bank_mask:0xf
v_and_b32_dpp v27, v23, v5 row_newbcast:2 row_mask:0xf bank_mask:0xf
v_and_b32_dpp v28, v23, v2 row_newbcast:6 row_mask:0xf bank_mask:0xf
v_and_b32_dpp v29, v23, v3 row_newbcast:6 row_mask:0xf bank_mask:0xf
v_and_b32_dpp v30, v23, v4 row_newbcast:6 row_mask:0xf bank_mask:0xf
v_and_b32_dpp v31, v23, v5 row_newbcast:6 row_mask:0xf bank_mask:0xf
v_mfma_f32_16x16x32_bf16 v[8:11], v[80:83], v[24:27], v[8:11]
v_and_b32_dpp v24, v23, v2 row_newbcast:10 row_mask:0xf bank_mask:0xf
v_and_b32_dpp v25, v23, v3 row_newbcast:10 row_mask:0xf bank_mask:0xf
v_and_b32_dpp v26, v23, v4 row_newbcast:10 row_mask:0xf bank_mask:0xf
v_and_b32_dpp v27, v23, v5 row_newbcast:10 row_mask:0xf bank_mask:0xf
v_mfma_f32_16x16x32_bf16 v[8:11], v[84:87], v[28:31], v[8:11]
v_and_b32_dpp v28, v23, v2 row_newbcast:14 row_mask:0xf bank_mask:0xf
v_and_b32_dpp v29, v23, v3 row_newbcast:14 row_mask:0xf bank_mask:0xf
v_and_b32_dpp v30, v23, v4 row_newbcast:14 row_mask:0xf bank_mask:0xf
v_and_b32_dpp v31, v23, v5 row_newbcast:14 row_mask:0xf bank_mask:0xf
v_mfma_f32_16x16x32_bf16 v[8:11], v[88:91], v[24:27], v[8:11]
s_nop 0
v_mfma_f32_16x16x32_bf16 v[8:11], v[92:95], v[28:31], v[8:11]
v_and_b32_dpp v24, v23, v2 row_newbcast:3 row_mask:0xf bank_mask:0xf
v_and_b32_dpp v25, v23, v3 row_newbcast:3 row_mask:0xf bank_mask:0xf
v_and_b32_dpp v26, v23, v4 row_newbcast:3 row_mask:0xf bank_mask:0xf
v_and_b32_dpp v27, v23, v5 row_newbcast:3 row_mask:0xf bank_mask:0xf
v_and_b32_dpp v28, v23, v2 row_newbcast:7 row_mask:0xf bank_mask:0xf
v_and_b32_dpp v29, v23, v3 row_newbcast:7 row_mask:0xf bank_mask:0xf
v_and_b32_dpp v30, v23, v4 row_newbcast:7 row_mask:0xf bank_mask:0xf
v_and_b32_dpp v31, v23, v5 row_newbcast:7 row_mask:0xf bank_mask:0xf
v_mfma_f32_16x16x32_bf16 v[8:11], v[96:99], v[24:27], v[8:11]
v_and_b32_dpp v24, v23, v2 row_newbcast:11 row_mask:0xf bank_mask:0xf
v_and_b32_dpp v25, v23, v3 row_newbcast:11 row_mask:0xf bank_mask:0xf
v_and_b32_dpp v26, v23, v4 row_newbcast:11 row_mask:0xf bank_mask:0xf
v_and_b32_dpp v27, v23, v5 row_newbcast:11 row_mask:0xf bank_mask:0xf
v_mfma_f32_16x16x32_bf16 v[8:11], v[100:103], v[28:31], v[8:11]
v_and_b32_dpp v28, v23, v2 row_newbcast:15 row_mask:0xf bank_mask:0xf
v_and_b32_dpp v29, v23, v3 row_newbcast:15 row_mask:0xf bank_mask:0xf
v_and_b32_dpp v30, v23, v4 row_newbcast:15 row_mask:0xf bank_mask:0xf
v_and_b32_dpp v31, v23, v5 row_newbcast:15 row_mask:0xf bank_mask:0xf
v_mfma_f32_16x16x32_bf16 v[8:11], v[104:107], v[24:27], v[8:11]
s_nop 0
v_mfma_f32_16x16x32_bf16 v[8:11], v[108:111], v[28:31], v[8:11]
v_lshlrev_b32 v22, 16, v13
v_fmamk_f32 v23, v22, 0x3e0293ee, v6
v_cmp_lt_f32 vcc, 0, v23
s_cbranch_vccnz RS_92
RB_93:
v_exp_f32 v23, v23
s_nop 0
v_add_f32 v7, v7, v23
v_cvt_pk_bf16_f32 v23, v23, v23
s_nop 1
v_and_b32_dpp v24, v23, v2 row_newbcast:0 row_mask:0xf bank_mask:0xf
v_and_b32_dpp v25, v23, v3 row_newbcast:0 row_mask:0xf bank_mask:0xf
v_and_b32_dpp v26, v23, v4 row_newbcast:0 row_mask:0xf bank_mask:0xf
v_and_b32_dpp v27, v23, v5 row_newbcast:0 row_mask:0xf bank_mask:0xf
v_and_b32_dpp v28, v23, v2 row_newbcast:4 row_mask:0xf bank_mask:0xf
v_and_b32_dpp v29, v23, v3 row_newbcast:4 row_mask:0xf bank_mask:0xf
v_and_b32_dpp v30, v23, v4 row_newbcast:4 row_mask:0xf bank_mask:0xf
v_and_b32_dpp v31, v23, v5 row_newbcast:4 row_mask:0xf bank_mask:0xf
v_mfma_f32_16x16x32_bf16 v[8:11], a[192:195], v[24:27], v[8:11]
v_and_b32_dpp v24, v23, v2 row_newbcast:8 row_mask:0xf bank_mask:0xf
v_and_b32_dpp v25, v23, v3 row_newbcast:8 row_mask:0xf bank_mask:0xf
v_and_b32_dpp v26, v23, v4 row_newbcast:8 row_mask:0xf bank_mask:0xf
v_and_b32_dpp v27, v23, v5 row_newbcast:8 row_mask:0xf bank_mask:0xf
v_mfma_f32_16x16x32_bf16 v[8:11], a[196:199], v[28:31], v[8:11]
v_and_b32_dpp v28, v23, v2 row_newbcast:12 row_mask:0xf bank_mask:0xf
v_and_b32_dpp v29, v23, v3 row_newbcast:12 row_mask:0xf bank_mask:0xf
v_and_b32_dpp v30, v23, v4 row_newbcast:12 row_mask:0xf bank_mask:0xf
v_and_b32_dpp v31, v23, v5 row_newbcast:12 row_mask:0xf bank_mask:0xf
v_mfma_f32_16x16x32_bf16 v[8:11], a[200:203], v[24:27], v[8:11]
s_nop 0
v_mfma_f32_16x16x32_bf16 v[8:11], a[204:207], v[28:31], v[8:11]
v_and_b32_dpp v24, v23, v2 row_newbcast:1 row_mask:0xf bank_mask:0xf
v_and_b32_dpp v25, v23, v3 row_newbcast:1 row_mask:0xf bank_mask:0xf
v_and_b32_dpp v26, v23, v4 row_newbcast:1 row_mask:0xf bank_mask:0xf
v_and_b32_dpp v27, v23, v5 row_newbcast:1 row_mask:0xf bank_mask:0xf
v_and_b32_dpp v28, v23, v2 row_newbcast:5 row_mask:0xf bank_mask:0xf
v_and_b32_dpp v29, v23, v3 row_newbcast:5 row_mask:0xf bank_mask:0xf
v_and_b32_dpp v30, v23, v4 row_newbcast:5 row_mask:0xf bank_mask:0xf
v_and_b32_dpp v31, v23, v5 row_newbcast:5 row_mask:0xf bank_mask:0xf
v_mfma_f32_16x16x32_bf16 v[8:11], v[240:243], v[24:27], v[8:11]
v_and_b32_dpp v24, v23, v2 row_newbcast:9 row_mask:0xf bank_mask:0xf
v_and_b32_dpp v25, v23, v3 row_newbcast:9 row_mask:0xf bank_mask:0xf
v_and_b32_dpp v26, v23, v4 row_newbcast:9 row_mask:0xf bank_mask:0xf
v_and_b32_dpp v27, v23, v5 row_newbcast:9 row_mask:0xf bank_mask:0xf
v_mfma_f32_16x16x32_bf16 v[8:11], v[244:247], v[28:31], v[8:11]
v_and_b32_dpp v28, v23, v2 row_newbcast:13 row_mask:0xf bank_mask:0xf
v_and_b32_dpp v29, v23, v3 row_newbcast:13 row_mask:0xf bank_mask:0xf
v_and_b32_dpp v30, v23, v4 row_newbcast:13 row_mask:0xf bank_mask:0xf
v_and_b32_dpp v31, v23, v5 row_newbcast:13 row_mask:0xf bank_mask:0xf
v_mfma_f32_16x16x32_bf16 v[8:11], v[248:251], v[24:27], v[8:11]
s_nop 0
v_mfma_f32_16x16x32_bf16 v[8:11], v[252:255], v[28:31], v[8:11]
v_and_b32_dpp v24, v23, v2 row_newbcast:2 row_mask:0xf bank_mask:0xf
v_and_b32_dpp v25, v23, v3 row_newbcast:2 row_mask:0xf bank_mask:0xf
v_and_b32_dpp v26, v23, v4 row_newbcast:2 row_mask:0xf bank_mask:0xf
v_and_b32_dpp v27, v23, v5 row_newbcast:2 row_mask:0xf bank_mask:0xf
v_and_b32_dpp v28, v23, v2 row_newbcast:6 row_mask:0xf bank_mask:0xf
v_and_b32_dpp v29, v23, v3 row_newbcast:6 row_mask:0xf bank_mask:0xf
v_and_b32_dpp v30, v23, v4 row_newbcast:6 row_mask:0xf bank_mask:0xf
v_and_b32_dpp v31, v23, v5 row_newbcast:6 row_mask:0xf bank_mask:0xf
v_mfma_f32_16x16x32_bf16 v[8:11], v[176:179], v[24:27], v[8:11]
v_and_b32_dpp v24, v23, v2 row_newbcast:10 row_mask:0xf bank_mask:0xf
v_and_b32_dpp v25, v23, v3 row_newbcast:10 row_mask:0xf bank_mask:0xf
v_and_b32_dpp v26, v23, v4 row_newbcast:10 row_mask:0xf bank_mask:0xf
v_and_b32_dpp v27, v23, v5 row_newbcast:10 row_mask:0xf bank_mask:0xf
v_mfma_f32_16x16x32_bf16 v[8:11], v[180:183], v[28:31], v[8:11]
v_and_b32_dpp v28, v23, v2 row_newbcast:14 row_mask:0xf bank_mask:0xf
v_and_b32_dpp v29, v23, v3 row_newbcast:14 row_mask:0xf bank_mask:0xf
v_and_b32_dpp v30, v23, v4 row_newbcast:14 row_mask:0xf bank_mask:0xf
v_and_b32_dpp v31, v23, v5 row_newbcast:14 row_mask:0xf bank_mask:0xf
v_mfma_f32_16x16x32_bf16 v[8:11], v[184:187], v[24:27], v[8:11]
s_nop 0
v_mfma_f32_16x16x32_bf16 v[8:11], v[188:191], v[28:31], v[8:11]
v_and_b32_dpp v24, v23, v2 row_newbcast:3 row_mask:0xf bank_mask:0xf
v_and_b32_dpp v25, v23, v3 row_newbcast:3 row_mask:0xf bank_mask:0xf
v_and_b32_dpp v26, v23, v4 row_newbcast:3 row_mask:0xf bank_mask:0xf
v_and_b32_dpp v27, v23, v5 row_newbcast:3 row_mask:0xf bank_mask:0xf
v_and_b32_dpp v28, v23, v2 row_newbcast:7 row_mask:0xf bank_mask:0xf
v_and_b32_dpp v29, v23, v3 row_newbcast:7 row_mask:0xf bank_mask:0xf
v_and_b32_dpp v30, v23, v4 row_newbcast:7 row_mask:0xf bank_mask:0xf
v_and_b32_dpp v31, v23, v5 row_newbcast:7 row_mask:0xf bank_mask:0xf
v_mfma_f32_16x16x32_bf16 v[8:11], v[192:195], v[24:27], v[8:11]
v_and_b32_dpp v24, v23, v2 row_newbcast:11 row_mask:0xf bank_mask:0xf
v_and_b32_dpp v25, v23, v3 row_newbcast:11 row_mask:0xf bank_mask:0xf
v_and_b32_dpp v26, v23, v4 row_newbcast:11 row_mask:0xf bank_mask:0xf
v_and_b32_dpp v27, v23, v5 row_newbcast:11 row_mask:0xf bank_mask:0xf
v_mfma_f32_16x16x32_bf16 v[8:11], v[196:199], v[28:31], v[8:11]
v_and_b32_dpp v28, v23, v2 row_newbcast:15 row_mask:0xf bank_mask:0xf
v_and_b32_dpp v29, v23, v3 row_newbcast:15 row_mask:0xf bank_mask:0xf
v_and_b32_dpp v30, v23, v4 row_newbcast:15 row_mask:0xf bank_mask:0xf
v_and_b32_dpp v31, v23, v5 row_newbcast:15 row_mask:0xf bank_mask:0xf
v_mfma_f32_16x16x32_bf16 v[8:11], v[200:203], v[24:27], v[8:11]
s_nop 0
v_mfma_f32_16x16x32_bf16 v[8:11], v[204:207], v[28:31], v[8:11]
v_and_b32 v22, 0xffff0000, v41
v_fmamk_f32 v23, v22, 0x3e0293ee, v6
v_cmp_lt_f32 vcc, 0, v23
s_cbranch_vccnz RS_94
RB_95:
v_exp_f32 v23, v23
s_nop 0
v_add_f32 v7, v7, v23
v_cvt_pk_bf16_f32 v23, v23, v23
s_nop 1
v_and_b32_dpp v24, v23, v2 row_newbcast:0 row_mask:0xf bank_mask:0xf
v_and_b32_dpp v25, v23, v3 row_newbcast:0 row_mask:0xf bank_mask:0xf
v_and_b32_dpp v26, v23, v4 row_newbcast:0 row_mask:0xf bank_mask:0xf
v_and_b32_dpp v27, v23, v5 row_newbcast:0 row_mask:0xf bank_mask:0xf
v_and_b32_dpp v28, v23, v2 row_newbcast:4 row_mask:0xf bank_mask:0xf
v_and_b32_dpp v29, v23, v3 row_newbcast:4 row_mask:0xf bank_mask:0xf
v_and_b32_dpp v30, v23, v4 row_newbcast:4 row_mask:0xf bank_mask:0xf
v_and_b32_dpp v31, v23, v5 row_newbcast:4 row_mask:0xf bank_mask:0xf
v_mfma_f32_16x16x32_bf16 v[8:11], a[64:67], v[24:27], v[8:11]
v_and_b32_dpp v24, v23, v2 row_newbcast:8 row_mask:0xf bank_mask:0xf
v_and_b32_dpp v25, v23, v3 row_newbcast:8 row_mask:0xf bank_mask:0xf
v_and_b32_dpp v26, v23, v4 row_newbcast:8 row_mask:0xf bank_mask:0xf
v_and_b32_dpp v27, v23, v5 row_newbcast:8 row_mask:0xf bank_mask:0xf
v_mfma_f32_16x16x32_bf16 v[8:11], a[68:71], v[28:31], v[8:11]
v_and_b32_dpp v28, v23, v2 row_newbcast:12 row_mask:0xf bank_mask:0xf
v_and_b32_dpp v29, v23, v3 row_newbcast:12 row_mask:0xf bank_mask:0xf
v_and_b32_dpp v30, v23, v4 row_newbcast:12 row_mask:0xf bank_mask:0xf
v_and_b32_dpp v31, v23, v5 row_newbcast:12 row_mask:0xf bank_mask:0xf
v_mfma_f32_16x16x32_bf16 v[8:11], a[72:75], v[24:27], v[8:11]
s_nop 0
v_mfma_f32_16x16x32_bf16 v[8:11], a[76:79], v[28:31], v[8:11]
v_and_b32_dpp v24, v23, v2 row_newbcast:1 row_mask:0xf bank_mask:0xf
v_and_b32_dpp v25, v23, v3 row_newbcast:1 row_mask:0xf bank_mask:0xf
v_and_b32_dpp v26, v23, v4 row_newbcast:1 row_mask:0xf bank_mask:0xf
v_and_b32_dpp v27, v23, v5 row_newbcast:1 row_mask:0xf bank_mask:0xf
v_and_b32_dpp v28, v23, v2 row_newbcast:5 row_mask:0xf bank_mask:0xf
v_and_b32_dpp v29, v23, v3 row_newbcast:5 row_mask:0xf bank_mask:0xf
v_and_b32_dpp v30, v23, v4 row_newbcast:5 row_mask:0xf bank_mask:0xf
v_and_b32_dpp v31, v23, v5 row_newbcast:5 row_mask:0xf bank_mask:0xf
v_mfma_f32_16x16x32_bf16 v[8:11], a[80:83], v[24:27], v[8:11]
v_and_b32_dpp v24, v23, v2 row_newbcast:9 row_mask:0xf bank_mask:0xf
v_and_b32_dpp v25, v23, v3 row_newbcast:9 row_mask:0xf bank_mask:0xf
v_and_b32_dpp v26, v23, v4 row_newbcast:9 row_mask:0xf bank_mask:0xf
v_and_b32_dpp v27, v23, v5 row_newbcast:9 row_mask:0xf bank_mask:0xf
v_mfma_f32_16x16x32_bf16 v[8:11], a[84:87], v[28:31], v[8:11]
v_and_b32_dpp v28, v23, v2 row_newbcast:13 row_mask:0xf bank_mask:0xf
v_and_b32_dpp v29, v23, v3 row_newbcast:13 row_mask:0xf bank_mask:0xf
v_and_b32_dpp v30, v23, v4 row_newbcast:13 row_mask:0xf bank_mask:0xf
v_and_b32_dpp v31, v23, v5 row_newbcast:13 row_mask:0xf bank_mask:0xf
v_mfma_f32_16x16x32_bf16 v[8:11], a[88:91], v[24:27], v[8:11]
s_nop 0
v_mfma_f32_16x16x32_bf16 v[8:11], a[92:95], v[28:31], v[8:11]
v_and_b32_dpp v24, v23, v2 row_newbcast:2 row_mask:0xf bank_mask:0xf
v_and_b32_dpp v25, v23, v3 row_newbcast:2 row_mask:0xf bank_mask:0xf
v_and_b32_dpp v26, v23, v4 row_newbcast:2 row_mask:0xf bank_mask:0xf
v_and_b32_dpp v27, v23, v5 row_newbcast:2 row_mask:0xf bank_mask:0xf
v_and_b32_dpp v28, v23, v2 row_newbcast:6 row_mask:0xf bank_mask:0xf
v_and_b32_dpp v29, v23, v3 row_newbcast:6 row_mask:0xf bank_mask:0xf
v_and_b32_dpp v30, v23, v4 row_newbcast:6 row_mask:0xf bank_mask:0xf
v_and_b32_dpp v31, v23, v5 row_newbcast:6 row_mask:0xf bank_mask:0xf
v_mfma_f32_16x16x32_bf16 v[8:11], a[96:99], v[24:27], v[8:11]
v_and_b32_dpp v24, v23, v2 row_newbcast:10 row_mask:0xf bank_mask:0xf
v_and_b32_dpp v25, v23, v3 row_newbcast:10 row_mask:0xf bank_mask:0xf
v_and_b32_dpp v26, v23, v4 row_newbcast:10 row_mask:0xf bank_mask:0xf
v_and_b32_dpp v27, v23, v5 row_newbcast:10 row_mask:0xf bank_mask:0xf
v_mfma_f32_16x16x32_bf16 v[8:11], a[100:103], v[28:31], v[8:11]
v_and_b32_dpp v28, v23, v2 row_newbcast:14 row_mask:0xf bank_mask:0xf
v_and_b32_dpp v29, v23, v3 row_newbcast:14 row_mask:0xf bank_mask:0xf
v_and_b32_dpp v30, v23, v4 row_newbcast:14 row_mask:0xf bank_mask:0xf
v_and_b32_dpp v31, v23, v5 row_newbcast:14 row_mask:0xf bank_mask:0xf
v_mfma_f32_16x16x32_bf16 v[8:11], a[104:107], v[24:27], v[8:11]
s_nop 0
v_mfma_f32_16x16x32_bf16 v[8:11], a[108:111], v[28:31], v[8:11]
v_and_b32_dpp v24, v23, v2 row_newbcast:3 row_mask:0xf bank_mask:0xf
v_and_b32_dpp v25, v23, v3 row_newbcast:3 row_mask:0xf bank_mask:0xf
v_and_b32_dpp v26, v23, v4 row_newbcast:3 row_mask:0xf bank_mask:0xf
v_and_b32_dpp v27, v23, v5 row_newbcast:3 row_mask:0xf bank_mask:0xf
v_and_b32_dpp v28, v23, v2 row_newbcast:7 row_mask:0xf bank_mask:0xf
v_and_b32_dpp v29, v23, v3 row_newbcast:7 row_mask:0xf bank_mask:0xf
v_and_b32_dpp v30, v23, v4 row_newbcast:7 row_mask:0xf bank_mask:0xf
v_and_b32_dpp v31, v23, v5 row_newbcast:7 row_mask:0xf bank_mask:0xf
v_mfma_f32_16x16x32_bf16 v[8:11], a[112:115], v[24:27], v[8:11]
v_and_b32_dpp v24, v23, v2 row_newbcast:11 row_mask:0xf bank_mask:0xf
v_and_b32_dpp v25, v23, v3 row_newbcast:11 row_mask:0xf bank_mask:0xf
v_and_b32_dpp v26, v23, v4 row_newbcast:11 row_mask:0xf bank_mask:0xf
v_and_b32_dpp v27, v23, v5 row_newbcast:11 row_mask:0xf bank_mask:0xf
v_mfma_f32_16x16x32_bf16 v[8:11], a[116:119], v[28:31], v[8:11]
v_and_b32_dpp v28, v23, v2 row_newbcast:15 row_mask:0xf bank_mask:0xf
v_and_b32_dpp v29, v23, v3 row_newbcast:15 row_mask:0xf bank_mask:0xf
v_and_b32_dpp v30, v23, v4 row_newbcast:15 row_mask:0xf bank_mask:0xf
v_and_b32_dpp v31, v23, v5 row_newbcast:15 row_mask:0xf bank_mask:0xf
v_mfma_f32_16x16x32_bf16 v[8:11], a[120:123], v[24:27], v[8:11]
s_nop 0
v_mfma_f32_16x16x32_bf16 v[8:11], a[124:127], v[28:31], v[8:11]
s_waitcnt vmcnt(16)
v_lshlrev_b32 v22, 16, v46
v_fmamk_f32 v23, v22, 0x3e0293ee, v6
v_cmp_lt_f32 vcc, 0, v23
s_cbranch_vccnz RS_96
RB_97:
v_exp_f32 v23, v23
s_nop 0
v_add_f32 v7, v7, v23
v_cvt_pk_bf16_f32 v23, v23, v23
s_nop 1
v_and_b32_dpp v24, v23, v2 row_newbcast:0 row_mask:0xf bank_mask:0xf
v_and_b32_dpp v25, v23, v3 row_newbcast:0 row_mask:0xf bank_mask:0xf
v_and_b32_dpp v26, v23, v4 row_newbcast:0 row_mask:0xf bank_mask:0xf
v_and_b32_dpp v27, v23, v5 row_newbcast:0 row_mask:0xf bank_mask:0xf
v_and_b32_dpp v28, v23, v2 row_newbcast:4 row_mask:0xf bank_mask:0xf
v_and_b32_dpp v29, v23, v3 row_newbcast:4 row_mask:0xf bank_mask:0xf
v_and_b32_dpp v30, v23, v4 row_newbcast:4 row_mask:0xf bank_mask:0xf
v_and_b32_dpp v31, v23, v5 row_newbcast:4 row_mask:0xf bank_mask:0xf
v_mfma_f32_16x16x32_bf16 v[8:11], a[128:131], v[24:27], v[8:11]
v_and_b32_dpp v24, v23, v2 row_newbcast:8 row_mask:0xf bank_mask:0xf
v_and_b32_dpp v25, v23, v3 row_newbcast:8 row_mask:0xf bank_mask:0xf
v_and_b32_dpp v26, v23, v4 row_newbcast:8 row_mask:0xf bank_mask:0xf
v_and_b32_dpp v27, v23, v5 row_newbcast:8 row_mask:0xf bank_mask:0xf
v_mfma_f32_16x16x32_bf16 v[8:11], a[132:135], v[28:31], v[8:11]
v_and_b32_dpp v28, v23, v2 row_newbcast:12 row_mask:0xf bank_mask:0xf
v_and_b32_dpp v29, v23, v3 row_newbcast:12 row_mask:0xf bank_mask:0xf
v_and_b32_dpp v30, v23, v4 row_newbcast:12 row_mask:0xf bank_mask:0xf
v_and_b32_dpp v31, v23, v5 row_newbcast:12 row_mask:0xf bank_mask:0xf
v_mfma_f32_16x16x32_bf16 v[8:11], a[136:139], v[24:27], v[8:11]
s_nop 0
v_mfma_f32_16x16x32_bf16 v[8:11], a[140:143], v[28:31], v[8:11]
v_and_b32_dpp v24, v23, v2 row_newbcast:1 row_mask:0xf bank_mask:0xf
v_and_b32_dpp v25, v23, v3 row_newbcast:1 row_mask:0xf bank_mask:0xf
v_and_b32_dpp v26, v23, v4 row_newbcast:1 row_mask:0xf bank_mask:0xf
v_and_b32_dpp v27, v23, v5 row_newbcast:1 row_mask:0xf bank_mask:0xf
v_and_b32_dpp v28, v23, v2 row_newbcast:5 row_mask:0xf bank_mask:0xf
v_and_b32_dpp v29, v23, v3 row_newbcast:5 row_mask:0xf bank_mask:0xf
v_and_b32_dpp v30, v23, v4 row_newbcast:5 row_mask:0xf bank_mask:0xf
v_and_b32_dpp v31, v23, v5 row_newbcast:5 row_mask:0xf bank_mask:0xf
v_mfma_f32_16x16x32_bf16 v[8:11], a[144:147], v[24:27], v[8:11]
v_and_b32_dpp v24, v23, v2 row_newbcast:9 row_mask:0xf bank_mask:0xf
v_and_b32_dpp v25, v23, v3 row_newbcast:9 row_mask:0xf bank_mask:0xf
v_and_b32_dpp v26, v23, v4 row_newbcast:9 row_mask:0xf bank_mask:0xf
v_and_b32_dpp v27, v23, v5 row_newbcast:9 row_mask:0xf bank_mask:0xf
v_mfma_f32_16x16x32_bf16 v[8:11], a[148:151], v[28:31], v[8:11]
v_and_b32_dpp v28, v23, v2 row_newbcast:13 row_mask:0xf bank_mask:0xf
v_and_b32_dpp v29, v23, v3 row_newbcast:13 row_mask:0xf bank_mask:0xf
v_and_b32_dpp v30, v23, v4 row_newbcast:13 row_mask:0xf bank_mask:0xf
v_and_b32_dpp v31, v23, v5 row_newbcast:13 row_mask:0xf bank_mask:0xf
v_mfma_f32_16x16x32_bf16 v[8:11], a[152:155], v[24:27], v[8:11]
s_nop 0
v_mfma_f32_16x16x32_bf16 v[8:11], a[156:159], v[28:31], v[8:11]
v_and_b32_dpp v24, v23, v2 row_newbcast:2 row_mask:0xf bank_mask:0xf
v_and_b32_dpp v25, v23, v3 row_newbcast:2 row_mask:0xf bank_mask:0xf
v_and_b32_dpp v26, v23, v4 row_newbcast:2 row_mask:0xf bank_mask:0xf
v_and_b32_dpp v27, v23, v5 row_newbcast:2 row_mask:0xf bank_mask:0xf
v_and_b32_dpp v28, v23, v2 row_newbcast:6 row_mask:0xf bank_mask:0xf
v_and_b32_dpp v29, v23, v3 row_newbcast:6 row_mask:0xf bank_mask:0xf
v_and_b32_dpp v30, v23, v4 row_newbcast:6 row_mask:0xf bank_mask:0xf
v_and_b32_dpp v31, v23, v5 row_newbcast:6 row_mask:0xf bank_mask:0xf
v_mfma_f32_16x16x32_bf16 v[8:11], a[160:163], v[24:27], v[8:11]
v_and_b32_dpp v24, v23, v2 row_newbcast:10 row_mask:0xf bank_mask:0xf
v_and_b32_dpp v25, v23, v3 row_newbcast:10 row_mask:0xf bank_mask:0xf
v_and_b32_dpp v26, v23, v4 row_newbcast:10 row_mask:0xf bank_mask:0xf
v_and_b32_dpp v27, v23, v5 row_newbcast:10 row_mask:0xf bank_mask:0xf
v_mfma_f32_16x16x32_bf16 v[8:11], a[164:167], v[28:31], v[8:11]
v_and_b32_dpp v28, v23, v2 row_newbcast:14 row_mask:0xf bank_mask:0xf
v_and_b32_dpp v29, v23, v3 row_newbcast:14 row_mask:0xf bank_mask:0xf
v_and_b32_dpp v30, v23, v4 row_newbcast:14 row_mask:0xf bank_mask:0xf
v_and_b32_dpp v31, v23, v5 row_newbcast:14 row_mask:0xf bank_mask:0xf
v_mfma_f32_16x16x32_bf16 v[8:11], a[168:171], v[24:27], v[8:11]
s_nop 0
v_mfma_f32_16x16x32_bf16 v[8:11], a[172:175], v[28:31], v[8:11]
v_and_b32_dpp v24, v23, v2 row_newbcast:3 row_mask:0xf bank_mask:0xf
v_and_b32_dpp v25, v23, v3 row_newbcast:3 row_mask:0xf bank_mask:0xf
v_and_b32_dpp v26, v23, v4 row_newbcast:3 row_mask:0xf bank_mask:0xf
v_and_b32_dpp v27, v23, v5 row_newbcast:3 row_mask:0xf bank_mask:0xf
v_and_b32_dpp v28, v23, v2 row_newbcast:7 row_mask:0xf bank_mask:0xf
v_and_b32_dpp v29, v23, v3 row_newbcast:7 row_mask:0xf bank_mask:0xf
v_and_b32_dpp v30, v23, v4 row_newbcast:7 row_mask:0xf bank_mask:0xf
v_and_b32_dpp v31, v23, v5 row_newbcast:7 row_mask:0xf bank_mask:0xf
v_mfma_f32_16x16x32_bf16 v[8:11], a[176:179], v[24:27], v[8:11]
v_and_b32_dpp v24, v23, v2 row_newbcast:11 row_mask:0xf bank_mask:0xf
v_and_b32_dpp v25, v23, v3 row_newbcast:11 row_mask:0xf bank_mask:0xf
v_and_b32_dpp v26, v23, v4 row_newbcast:11 row_mask:0xf bank_mask:0xf
v_and_b32_dpp v27, v23, v5 row_newbcast:11 row_mask:0xf bank_mask:0xf
v_mfma_f32_16x16x32_bf16 v[8:11], a[180:183], v[28:31], v[8:11]
v_and_b32_dpp v28, v23, v2 row_newbcast:15 row_mask:0xf bank_mask:0xf
v_and_b32_dpp v29, v23, v3 row_newbcast:15 row_mask:0xf bank_mask:0xf
v_and_b32_dpp v30, v23, v4 row_newbcast:15 row_mask:0xf bank_mask:0xf
v_and_b32_dpp v31, v23, v5 row_newbcast:15 row_mask:0xf bank_mask:0xf
v_mfma_f32_16x16x32_bf16 v[8:11], a[184:187], v[24:27], v[8:11]
s_nop 0
v_mfma_f32_16x16x32_bf16 v[8:11], a[188:191], v[28:31], v[8:11]
s_waitcnt lgkmcnt(0)
s_min_i32 s20, s20, s21
s_min_i32 s20, s20, s22
s_min_i32 s20, s20, s23
s_min_i32 s20, s20, s34
s_min_i32 s20, s20, s35
s_min_i32 s20, s20, s72
s_min_i32 s20, s20, s74
s_cmp_lt_i32 s20, 4
s_cbranch_scc1 LV_98_SLOW
LV_98_OK:
s_mov_b32 s78, 0
s_add_u32 s56, s63, 1572864
s_mov_b32 s55, 1
LOOP_99:
s_waitcnt vmcnt(16)
v_lshlrev_b32 v22, s78, v46
v_and_b32 v22, 0xffff0000, v22
s_xor_b32 s78, s78, 16
s_lshr_b32 s57, s78, 2
s_add_u32 s75, s75, s57
buffer_load_dword v46, v1, s[16:19], s75 offen sc1
v_fmamk_f32 v23, v22, 0x3e0293ee, v6
v_cmp_lt_f32 vcc, 0, v23
s_cbranch_vccnz RS_100
RB_101:
v_exp_f32 v23, v23
s_nop 0
v_add_f32 v7, v7, v23
v_cvt_pk_bf16_f32 v23, v23, v23
s_nop 1
v_and_b32_dpp v24, v23, v2 row_newbcast:0 row_mask:0xf bank_mask:0xf
v_and_b32_dpp v25, v23, v3 row_newbcast:0 row_mask:0xf bank_mask:0xf
v_and_b32_dpp v26, v23, v4 row_newbcast:0 row_mask:0xf bank_mask:0xf
v_and_b32_dpp v27, v23, v5 row_newbcast:0 row_mask:0xf bank_mask:0xf
v_and_b32_dpp v28, v23, v2 row_newbcast:4 row_mask:0xf bank_mask:0xf
v_and_b32_dpp v29, v23, v3 row_newbcast:4 row_mask:0xf bank_mask:0xf
v_and_b32_dpp v30, v23, v4 row_newbcast:4 row_mask:0xf bank_mask:0xf
v_and_b32_dpp v31, v23, v5 row_newbcast:4 row_mask:0xf bank_mask:0xf
s_waitcnt vmcnt(13)
v_mfma_f32_16x16x32_bf16 v[8:11], a[0:3], v[24:27], v[8:11]
v_and_b32_dpp v24, v23, v2 row_newbcast:8 row_mask:0xf bank_mask:0xf
v_and_b32_dpp v25, v23, v3 row_newbcast:8 row_mask:0xf bank_mask:0xf
v_and_b32_dpp v26, v23, v4 row_newbcast:8 row_mask:0xf bank_mask:0xf
v_and_b32_dpp v27, v23, v5 row_newbcast:8 row_mask:0xf bank_mask:0xf
v_mfma_f32_16x16x32_bf16 v[8:11], a[4:7], v[28:31], v[8:11]
v_and_b32_dpp v28, v23, v2 row_newbcast:12 row_mask:0xf bank_mask:0xf
v_and_b32_dpp v29, v23, v3 row_newbcast:12 row_mask:0xf bank_mask:0xf
v_and_b32_dpp v30, v23, v4 row_newbcast:12 row_mask:0xf bank_mask:0xf
v_and_b32_dpp v31, v23, v5 row_newbcast:12 row_mask:0xf bank_mask:0xf
v_mfma_f32_16x16x32_bf16 v[8:11], a[8:11], v[24:27], v[8:11]
s_nop 0
v_mfma_f32_16x16x32_bf16 v[8:11], a[12:15], v[28:31], v[8:11]
buffer_load_dwordx4 a[0:3], v1, s[12:15], s56 offen offset:0 nt
buffer_load_dwordx4 a[4:7], v1, s[12:15], s56 offen offset:1024 nt
buffer_load_dwordx4 a[8:11], v1, s[12:15], s56 offen offset:2048 nt
buffer_load_dwordx4 a[12:15], v1, s[12:15], s56 offen offset:3072 nt
s_add_u32 s56, s56, 32768
v_and_b32_dpp v24, v23, v2 row_newbcast:1 row_mask:0xf bank_mask:0xf
v_and_b32_dpp v25, v23, v3 row_newbcast:1 row_mask:0xf bank_mask:0xf
v_and_b32_dpp v26, v23, v4 row_newbcast:1 row_mask:0xf bank_mask:0xf
v_and_b32_dpp v27, v23, v5 row_newbcast:1 row_mask:0xf bank_mask:0xf
v_and_b32_dpp v28, v23, v2 row_newbcast:5 row_mask:0xf bank_mask:0xf
v_and_b32_dpp v29, v23, v3 row_newbcast:5 row_mask:0xf bank_mask:0xf
v_and_b32_dpp v30, v23, v4 row_newbcast:5 row_mask:0xf bank_mask:0xf
v_and_b32_dpp v31, v23, v5 row_newbcast:5 row_mask:0xf bank_mask:0xf
s_waitcnt vmcnt(13)
v_mfma_f32_16x16x32_bf16 v[8:11], a[16:19], v[24:27], v[8:11]
v_and_b32_dpp v24, v23, v2 row_newbcast:9 row_mask:0xf bank_mask:0xf
v_and_b32_dpp v25, v23, v3 row_newbcast:9 row_mask:0xf bank_mask:0xf
v_and_b32_dpp v26, v23, v4 row_newbcast:9 row_mask:0xf bank_mask:0xf
v_and_b32_dpp v27, v23, v5 row_newbcast:9 row_mask:0xf bank_mask:0xf
v_mfma_f32_16x16x32_bf16 v[8:11], a[20:23], v[28:31], v[8:11]
v_and_b32_dpp v28, v23, v2 row_newbcast:13 row_mask:0xf bank_mask:0xf
v_and_b32_dpp v29, v23, v3 row_newbcast:13 row_mask:0xf bank_mask:0xf
v_and_b32_dpp v30, v23, v4 row_newbcast:13 row_mask:0xf bank_mask:0xf
v_and_b32_dpp v31, v23, v5 row_newbcast:13 row_mask:0xf bank_mask:0xf
v_mfma_f32_16x16x32_bf16 v[8:11], a[24:27], v[24:27], v[8:11]
s_nop 0
v_mfma_f32_16x16x32_bf16 v[8:11], a[28:31], v[28:31], v[8:11]
buffer_load_dwordx4 a[16:19], v1, s[12:15], s56 offen offset:0 nt
buffer_load_dwordx4 a[20:23], v1, s[12:15], s56 offen offset:1024 nt
buffer_load_dwordx4 a[24:27], v1, s[12:15], s56 offen offset:2048 nt
buffer_load_dwordx4 a[28:31], v1, s[12:15], s56 offen offset:3072 nt
s_add_u32 s56, s56, 32768
v_and_b32_dpp v24, v23, v2 row_newbcast:2 row_mask:0xf bank_mask:0xf
v_and_b32_dpp v25, v23, v3 row_newbcast:2 row_mask:0xf bank_mask:0xf
v_and_b32_dpp v26, v23, v4 row_newbcast:2 row_mask:0xf bank_mask:0xf
v_and_b32_dpp v27, v23, v5 row_newbcast:2 row_mask:0xf bank_mask:0xf
v_and_b32_dpp v28, v23, v2 row_newbcast:6 row_mask:0xf bank_mask:0xf
v_and_b32_dpp v29, v23, v3 row_newbcast:6 row_mask:0xf bank_mask:0xf
v_and_b32_dpp v30, v23, v4 row_newbcast:6 row_mask:0xf bank_mask:0xf
v_and_b32_dpp v31, v23, v5 row_newbcast:6 row_mask:0xf bank_mask:0xf
s_waitcnt vmcnt(13)
v_mfma_f32_16x16x32_bf16 v[8:11], a[32:35], v[24:27], v[8:11]
v_and_b32_dpp v24, v23, v2 row_newbcast:10 row_mask:0xf bank_mask:0xf
v_and_b32_dpp v25, v23, v3 row_newbcast:10 row_mask:0xf bank_mask:0xf
v_and_b32_dpp v26, v23, v4 row_newbcast:10 row_mask:0xf bank_mask:0xf
v_and_b32_dpp v27, v23, v5 row_newbcast:10 row_mask:0xf bank_mask:0xf
v_mfma_f32_16x16x32_bf16 v[8:11], a[36:39], v[28:31], v[8:11]
v_and_b32_dpp v28, v23, v2 row_newbcast:14 row_mask:0xf bank_mask:0xf
v_and_b32_dpp v29, v23, v3 row_newbcast:14 row_mask:0xf bank_mask:0xf
v_and_b32_dpp v30, v23, v4 row_newbcast:14 row_mask:0xf bank_mask:0xf
v_and_b32_dpp v31, v23, v5 row_newbcast:14 row_mask:0xf bank_mask:0xf
v_mfma_f32_16x16x32_bf16 v[8:11], a[40:43], v[24:27], v[8:11]
s_nop 0
v_mfma_f32_16x16x32_bf16 v[8:11], a[44:47], v[28:31], v[8:11]
buffer_load_dwordx4 a[32:35], v1, s[12:15], s56 offen offset:0 nt
buffer_load_dwordx4 a[36:39], v1, s[12:15], s56 offen offset:1024 nt
buffer_load_dwordx4 a[40:43], v1, s[12:15], s56 offen offset:2048 nt
buffer_load_dwordx4 a[44:47], v1, s[12:15], s56 offen offset:3072 nt
s_add_u32 s56, s56, 32768
v_and_b32_dpp v24, v23, v2 row_newbcast:3 row_mask:0xf bank_mask:0xf
v_and_b32_dpp v25, v23, v3 row_newbcast:3 row_mask:0xf bank_mask:0xf
v_and_b32_dpp v26, v23, v4 row_newbcast:3 row_mask:0xf bank_mask:0xf
v_and_b32_dpp v27, v23, v5 row_newbcast:3 row_mask:0xf bank_mask:0xf
v_and_b32_dpp v28, v23, v2 row_newbcast:7 row_mask:0xf bank_mask:0xf
v_and_b32_dpp v29, v23, v3 row_newbcast:7 row_mask:0xf bank_mask:0xf
v_and_b32_dpp v30, v23, v4 row_newbcast:7 row_mask:0xf bank_mask:0xf
v_and_b32_dpp v31, v23, v5 row_newbcast:7 row_mask:0xf bank_mask:0xf
s_waitcnt vmcnt(13)
v_mfma_f32_16x16x32_bf16 v[8:11], a[48:51], v[24:27], v[8:11]
v_and_b32_dpp v24, v23, v2 row_newbcast:11 row_mask:0xf bank_mask:0xf
v_and_b32_dpp v25, v23, v3 row_newbcast:11 row_mask:0xf bank_mask:0xf
v_and_b32_dpp v26, v23, v4 row_newbcast:11 row_mask:0xf bank_mask:0xf
v_and_b32_dpp v27, v23, v5 row_newbcast:11 row_mask:0xf bank_mask:0xf
v_mfma_f32_16x16x32_bf16 v[8:11], a[52:55], v[28:31], v[8:11]
v_and_b32_dpp v28, v23, v2 row_newbcast:15 row_mask:0xf bank_mask:0xf
v_and_b32_dpp v29, v23, v3 row_newbcast:15 row_mask:0xf bank_mask:0xf
v_and_b32_dpp v30, v23, v4 row_newbcast:15 row_mask:0xf bank_mask:0xf
v_and_b32_dpp v31, v23, v5 row_newbcast:15 row_mask:0xf bank_mask:0xf
v_mfma_f32_16x16x32_bf16 v[8:11], a[56:59], v[24:27], v[8:11]
s_nop 0
v_mfma_f32_16x16x32_bf16 v[8:11], a[60:63], v[28:31], v[8:11]
buffer_load_dwordx4 a[48:51], v1, s[12:15], s56 offen offset:0 nt
buffer_load_dwordx4 a[52:55], v1, s[12:15], s56 offen offset:1024 nt
buffer_load_dwordx4 a[56:59], v1, s[12:15], s56 offen offset:2048 nt
buffer_load_dwordx4 a[60:63], v1, s[12:15], s56 offen offset:3072 nt
s_add_u32 s56, s56, 32768
s_sub_u32 s55, s55, 1
s_cmp_lg_u32 s55, 0
s_cbranch_scc1 LOOP_99
POOL_102:
s_waitcnt vmcnt(16)
v_readfirstlane_b32 s79, v47
s_nop 0
s_cmp_ge_u32 s79, 48
s_cbranch_scc1 POOLEND_103
v_lshlrev_b32 v22, s78, v46
v_and_b32 v22, 0xffff0000, v22
v_mov_b32 v47, 1
s_mov_b64 exec, 1
buffer_atomic_add v47, v16, s[16:19], s76 offen sc0 sc1
s_mov_b64 exec, -1
s_bfe_u32 s58, s79, 0x20002
s_and_b32 s59, s79, 3
s_lshl_b32 s56, s58, 21
s_xor_b32 s60, s58, s52
s_and_b32 s60, s60, 1
s_lshl_b32 s60, s60, 13
s_add_u32 s56, s56, s60
s_lshr_b32 s60, s59, 1
s_lshl_b32 s60, s60, 14
s_add_u32 s56, s56, s60
s_and_b32 s60, s59, 1
s_lshl_b32 s60, s60, 12
s_add_u32 s56, s56, s60
s_lshl_b32 s75, s58, 2
s_add_u32 s75, s75, s59
s_lshl_b32 s75, s75, 1
s_bfe_u32 s60, s56, 0x1000d
s_add_u32 s75, s75, s60
s_lshl_b32 s60, s48, 5
s_add_u32 s75, s75, s60
s_lshl_b32 s75, s75, 11
s_add_u32 s75, s75, 4194304
s_lshr_b32 s57, s79, 4
s_add_u32 s57, s57, 13
s_lshr_b32 s58, s57, 1
s_lshl_b32 s58, s58, 2
s_add_u32 s75, s75, s58
s_add_u32 s75, s75, 1008
s_andn2_b32 s78, 1, s57
s_lshl_b32 s78, s78, 4
s_lshl_b32 s57, s57, 17
s_add_u32 s56, s56, s57
buffer_load_dword v46, v1, s[16:19], s75 offen sc1
v_fmamk_f32 v23, v22, 0x3e0293ee, v6
v_cmp_lt_f32 vcc, 0, v23
s_cbranch_vccnz RS_104
RB_105:
v_exp_f32 v23, v23
s_nop 0
v_add_f32 v7, v7, v23
v_cvt_pk_bf16_f32 v23, v23, v23
s_nop 1
v_and_b32_dpp v24, v23, v2 row_newbcast:0 row_mask:0xf bank_mask:0xf
v_and_b32_dpp v25, v23, v3 row_newbcast:0 row_mask:0xf bank_mask:0xf
v_and_b32_dpp v26, v23, v4 row_newbcast:0 row_mask:0xf bank_mask:0xf
v_and_b32_dpp v27, v23, v5 row_newbcast:0 row_mask:0xf bank_mask:0xf
v_and_b32_dpp v28, v23, v2 row_newbcast:4 row_mask:0xf bank_mask:0xf
v_and_b32_dpp v29, v23, v3 row_newbcast:4 row_mask:0xf bank_mask:0xf
v_and_b32_dpp v30, v23, v4 row_newbcast:4 row_mask:0xf bank_mask:0xf
v_and_b32_dpp v31, v23, v5 row_newbcast:4 row_mask:0xf bank_mask:0xf
s_waitcnt vmcnt(14)
v_mfma_f32_16x16x32_bf16 v[8:11], a[0:3], v[24:27], v[8:11]
v_and_b32_dpp v24, v23, v2 row_newbcast:8 row_mask:0xf bank_mask:0xf
v_and_b32_dpp v25, v23, v3 row_newbcast:8 row_mask:0xf bank_mask:0xf
v_and_b32_dpp v26, v23, v4 row_newbcast:8 row_mask:0xf bank_mask:0xf
v_and_b32_dpp v27, v23, v5 row_newbcast:8 row_mask:0xf bank_mask:0xf
v_mfma_f32_16x16x32_bf16 v[8:11], a[4:7], v[28:31], v[8:11]
v_and_b32_dpp v28, v23, v2 row_newbcast:12 row_mask:0xf bank_mask:0xf
v_and_b32_dpp v29, v23, v3 row_newbcast:12 row_mask:0xf bank_mask:0xf
v_and_b32_dpp v30, v23, v4 row_newbcast:12 row_mask:0xf bank_mask:0xf
v_and_b32_dpp v31, v23, v5 row_newbcast:12 row_mask:0xf bank_mask:0xf
v_mfma_f32_16x16x32_bf16 v[8:11], a[8:11], v[24:27], v[8:11]
s_nop 0
v_mfma_f32_16x16x32_bf16 v[8:11], a[12:15], v[28:31], v[8:11]
buffer_load_dwordx4 a[0:3], v1, s[12:15], s56 offen offset:0 nt
buffer_load_dwordx4 a[4:7], v1, s[12:15], s56 offen offset:1024 nt
buffer_load_dwordx4 a[8:11], v1, s[12:15], s56 offen offset:2048 nt
buffer_load_dwordx4 a[12:15], v1, s[12:15], s56 offen offset:3072 nt
s_add_u32 s56, s56, 32768
v_and_b32_dpp v24, v23, v2 row_newbcast:1 row_mask:0xf bank_mask:0xf
v_and_b32_dpp v25, v23, v3 row_newbcast:1 row_mask:0xf bank_mask:0xf
v_and_b32_dpp v26, v23, v4 row_newbcast:1 row_mask:0xf bank_mask:0xf
v_and_b32_dpp v27, v23, v5 row_newbcast:1 row_mask:0xf bank_mask:0xf
v_and_b32_dpp v28, v23, v2 row_newbcast:5 row_mask:0xf bank_mask:0xf
v_and_b32_dpp v29, v23, v3 row_newbcast:5 row_mask:0xf bank_mask:0xf
v_and_b32_dpp v30, v23, v4 row_newbcast:5 row_mask:0xf bank_mask:0xf
v_and_b32_dpp v31, v23, v5 row_newbcast:5 row_mask:0xf bank_mask:0xf
s_waitcnt vmcnt(14)
v_mfma_f32_16x16x32_bf16 v[8:11], a[16:19], v[24:27], v[8:11]
v_and_b32_dpp v24, v23, v2 row_newbcast:9 row_mask:0xf bank_mask:0xf
v_and_b32_dpp v25, v23, v3 row_newbcast:9 row_mask:0xf bank_mask:0xf
v_and_b32_dpp v26, v23, v4 row_newbcast:9 row_mask:0xf bank_mask:0xf
v_and_b32_dpp v27, v23, v5 row_newbcast:9 row_mask:0xf bank_mask:0xf
v_mfma_f32_16x16x32_bf16 v[8:11], a[20:23], v[28:31], v[8:11]
v_and_b32_dpp v28, v23, v2 row_newbcast:13 row_mask:0xf bank_mask:0xf
v_and_b32_dpp v29, v23, v3 row_newbcast:13 row_mask:0xf bank_mask:0xf
v_and_b32_dpp v30, v23, v4 row_newbcast:13 row_mask:0xf bank_mask:0xf
v_and_b32_dpp v31, v23, v5 row_newbcast:13 row_mask:0xf bank_mask:0xf
v_mfma_f32_16x16x32_bf16 v[8:11], a[24:27], v[24:27], v[8:11]
s_nop 0
v_mfma_f32_16x16x32_bf16 v[8:11], a[28:31], v[28:31], v[8:11]
buffer_load_dwordx4 a[16:19], v1, s[12:15], s56 offen offset:0 nt
buffer_load_dwordx4 a[20:23], v1, s[12:15], s56 offen offset:1024 nt
buffer_load_dwordx4 a[24:27], v1, s[12:15], s56 offen offset:2048 nt
buffer_load_dwordx4 a[28:31], v1, s[12:15], s56 offen offset:3072 nt
s_add_u32 s56, s56, 32768
v_and_b32_dpp v24, v23, v2 row_newbcast:2 row_mask:0xf bank_mask:0xf
v_and_b32_dpp v25, v23, v3 row_newbcast:2 row_mask:0xf bank_mask:0xf
v_and_b32_dpp v26, v23, v4 row_newbcast:2 row_mask:0xf bank_mask:0xf
v_and_b32_dpp v27, v23, v5 row_newbcast:2 row_mask:0xf bank_mask:0xf
v_and_b32_dpp v28, v23, v2 row_newbcast:6 row_mask:0xf bank_mask:0xf
v_and_b32_dpp v29, v23, v3 row_newbcast:6 row_mask:0xf bank_mask:0xf
v_and_b32_dpp v30, v23, v4 row_newbcast:6 row_mask:0xf bank_mask:0xf
v_and_b32_dpp v31, v23, v5 row_newbcast:6 row_mask:0xf bank_mask:0xf
s_waitcnt vmcnt(14)
v_mfma_f32_16x16x32_bf16 v[8:11], a[32:35], v[24:27], v[8:11]
v_and_b32_dpp v24, v23, v2 row_newbcast:10 row_mask:0xf bank_mask:0xf
v_and_b32_dpp v25, v23, v3 row_newbcast:10 row_mask:0xf bank_mask:0xf
v_and_b32_dpp v26, v23, v4 row_newbcast:10 row_mask:0xf bank_mask:0xf
v_and_b32_dpp v27, v23, v5 row_newbcast:10 row_mask:0xf bank_mask:0xf
v_mfma_f32_16x16x32_bf16 v[8:11], a[36:39], v[28:31], v[8:11]
v_and_b32_dpp v28, v23, v2 row_newbcast:14 row_mask:0xf bank_mask:0xf
v_and_b32_dpp v29, v23, v3 row_newbcast:14 row_mask:0xf bank_mask:0xf
v_and_b32_dpp v30, v23, v4 row_newbcast:14 row_mask:0xf bank_mask:0xf
v_and_b32_dpp v31, v23, v5 row_newbcast:14 row_mask:0xf bank_mask:0xf
v_mfma_f32_16x16x32_bf16 v[8:11], a[40:43], v[24:27], v[8:11]
s_nop 0
v_mfma_f32_16x16x32_bf16 v[8:11], a[44:47], v[28:31], v[8:11]
buffer_load_dwordx4 a[32:35], v1, s[12:15], s56 offen offset:0 nt
buffer_load_dwordx4 a[36:39], v1, s[12:15], s56 offen offset:1024 nt
buffer_load_dwordx4 a[40:43], v1, s[12:15], s56 offen offset:2048 nt
buffer_load_dwordx4 a[44:47], v1, s[12:15], s56 offen offset:3072 nt
s_add_u32 s56, s56, 32768
v_and_b32_dpp v24, v23, v2 row_newbcast:3 row_mask:0xf bank_mask:0xf
v_and_b32_dpp v25, v23, v3 row_newbcast:3 row_mask:0xf bank_mask:0xf
v_and_b32_dpp v26, v23, v4 row_newbcast:3 row_mask:0xf bank_mask:0xf
v_and_b32_dpp v27, v23, v5 row_newbcast:3 row_mask:0xf bank_mask:0xf
v_and_b32_dpp v28, v23, v2 row_newbcast:7 row_mask:0xf bank_mask:0xf
v_and_b32_dpp v29, v23, v3 row_newbcast:7 row_mask:0xf bank_mask:0xf
v_and_b32_dpp v30, v23, v4 row_newbcast:7 row_mask:0xf bank_mask:0xf
v_and_b32_dpp v31, v23, v5 row_newbcast:7 row_mask:0xf bank_mask:0xf
s_waitcnt vmcnt(14)
v_mfma_f32_16x16x32_bf16 v[8:11], a[48:51], v[24:27], v[8:11]
v_and_b32_dpp v24, v23, v2 row_newbcast:11 row_mask:0xf bank_mask:0xf
v_and_b32_dpp v25, v23, v3 row_newbcast:11 row_mask:0xf bank_mask:0xf
v_and_b32_dpp v26, v23, v4 row_newbcast:11 row_mask:0xf bank_mask:0xf
v_and_b32_dpp v27, v23, v5 row_newbcast:11 row_mask:0xf bank_mask:0xf
v_mfma_f32_16x16x32_bf16 v[8:11], a[52:55], v[28:31], v[8:11]
v_and_b32_dpp v28, v23, v2 row_newbcast:15 row_mask:0xf bank_mask:0xf
v_and_b32_dpp v29, v23, v3 row_newbcast:15 row_mask:0xf bank_mask:0xf
v_and_b32_dpp v30, v23, v4 row_newbcast:15 row_mask:0xf bank_mask:0xf
v_and_b32_dpp v31, v23, v5 row_newbcast:15 row_mask:0xf bank_mask:0xf
v_mfma_f32_16x16x32_bf16 v[8:11], a[56:59], v[24:27], v[8:11]
s_nop 0
v_mfma_f32_16x16x32_bf16 v[8:11], a[60:63], v[28:31], v[8:11]
buffer_load_dwordx4 a[48:51], v1, s[12:15], s56 offen offset:0 nt
buffer_load_dwordx4 a[52:55], v1, s[12:15], s56 offen offset:1024 nt
buffer_load_dwordx4 a[56:59], v1, s[12:15], s56 offen offset:2048 nt
buffer_load_dwordx4 a[60:63], v1, s[12:15], s56 offen offset:3072 nt
s_add_u32 s56, s56, 32768
s_branch POOL_102
POOLEND_103:
v_lshlrev_b32 v22, s78, v46
v_and_b32 v22, 0xffff0000, v22
v_fmamk_f32 v23, v22, 0x3e0293ee, v6
v_cmp_lt_f32 vcc, 0, v23
s_cbranch_vccnz RS_106
RB_107:
v_exp_f32 v23, v23
s_nop 0
v_add_f32 v7, v7, v23
v_cvt_pk_bf16_f32 v23, v23, v23
s_nop 1
v_and_b32_dpp v24, v23, v2 row_newbcast:0 row_mask:0xf bank_mask:0xf
v_and_b32_dpp v25, v23, v3 row_newbcast:0 row_mask:0xf bank_mask:0xf
v_and_b32_dpp v26, v23, v4 row_newbcast:0 row_mask:0xf bank_mask:0xf
v_and_b32_dpp v27, v23, v5 row_newbcast:0 row_mask:0xf bank_mask:0xf
v_and_b32_dpp v28, v23, v2 row_newbcast:4 row_mask:0xf bank_mask:0xf
v_and_b32_dpp v29, v23, v3 row_newbcast:4 row_mask:0xf bank_mask:0xf
v_and_b32_dpp v30, v23, v4 row_newbcast:4 row_mask:0xf bank_mask:0xf
v_and_b32_dpp v31, v23, v5 row_newbcast:4 row_mask:0xf bank_mask:0xf
s_waitcnt vmcnt(12)
v_mfma_f32_16x16x32_bf16 v[8:11], a[0:3], v[24:27], v[8:11]
v_and_b32_dpp v24, v23, v2 row_newbcast:8 row_mask:0xf bank_mask:0xf
v_and_b32_dpp v25, v23, v3 row_newbcast:8 row_mask:0xf bank_mask:0xf
v_and_b32_dpp v26, v23, v4 row_newbcast:8 row_mask:0xf bank_mask:0xf
v_and_b32_dpp v27, v23, v5 row_newbcast:8 row_mask:0xf bank_mask:0xf
v_mfma_f32_16x16x32_bf16 v[8:11], a[4:7], v[28:31], v[8:11]
v_and_b32_dpp v28, v23, v2 row_newbcast:12 row_mask:0xf bank_mask:0xf
v_and_b32_dpp v29, v23, v3 row_newbcast:12 row_mask:0xf bank_mask:0xf
v_and_b32_dpp v30, v23, v4 row_newbcast:12 row_mask:0xf bank_mask:0xf
v_and_b32_dpp v31, v23, v5 row_newbcast:12 row_mask:0xf bank_mask:0xf
v_mfma_f32_16x16x32_bf16 v[8:11], a[8:11], v[24:27], v[8:11]
s_nop 0
v_mfma_f32_16x16x32_bf16 v[8:11], a[12:15], v[28:31], v[8:11]
v_and_b32_dpp v24, v23, v2 row_newbcast:1 row_mask:0xf bank_mask:0xf
v_and_b32_dpp v25, v23, v3 row_newbcast:1 row_mask:0xf bank_mask:0xf
v_and_b32_dpp v26, v23, v4 row_newbcast:1 row_mask:0xf bank_mask:0xf
v_and_b32_dpp v27, v23, v5 row_newbcast:1 row_mask:0xf bank_mask:0xf
v_and_b32_dpp v28, v23, v2 row_newbcast:5 row_mask:0xf bank_mask:0xf
v_and_b32_dpp v29, v23, v3 row_newbcast:5 row_mask:0xf bank_mask:0xf
v_and_b32_dpp v30, v23, v4 row_newbcast:5 row_mask:0xf bank_mask:0xf
v_and_b32_dpp v31, v23, v5 row_newbcast:5 row_mask:0xf bank_mask:0xf
s_waitcnt vmcnt(8)
v_mfma_f32_16x16x32_bf16 v[8:11], a[16:19], v[24:27], v[8:11]
v_and_b32_dpp v24, v23, v2 row_newbcast:9 row_mask:0xf bank_mask:0xf
v_and_b32_dpp v25, v23, v3 row_newbcast:9 row_mask:0xf bank_mask:0xf
v_and_b32_dpp v26, v23, v4 row_newbcast:9 row_mask:0xf bank_mask:0xf
v_and_b32_dpp v27, v23, v5 row_newbcast:9 row_mask:0xf bank_mask:0xf
v_mfma_f32_16x16x32_bf16 v[8:11], a[20:23], v[28:31], v[8:11]
v_and_b32_dpp v28, v23, v2 row_newbcast:13 row_mask:0xf bank_mask:0xf
v_and_b32_dpp v29, v23, v3 row_newbcast:13 row_mask:0xf bank_mask:0xf
v_and_b32_dpp v30, v23, v4 row_newbcast:13 row_mask:0xf bank_mask:0xf
v_and_b32_dpp v31, v23, v5 row_newbcast:13 row_mask:0xf bank_mask:0xf
v_mfma_f32_16x16x32_bf16 v[8:11], a[24:27], v[24:27], v[8:11]
s_nop 0
v_mfma_f32_16x16x32_bf16 v[8:11], a[28:31], v[28:31], v[8:11]
v_and_b32_dpp v24, v23, v2 row_newbcast:2 row_mask:0xf bank_mask:0xf
v_and_b32_dpp v25, v23, v3 row_newbcast:2 row_mask:0xf bank_mask:0xf
v_and_b32_dpp v26, v23, v4 row_newbcast:2 row_mask:0xf bank_mask:0xf
v_and_b32_dpp v27, v23, v5 row_newbcast:2 row_mask:0xf bank_mask:0xf
v_and_b32_dpp v28, v23, v2 row_newbcast:6 row_mask:0xf bank_mask:0xf
v_and_b32_dpp v29, v23, v3 row_newbcast:6 row_mask:0xf bank_mask:0xf
v_and_b32_dpp v30, v23, v4 row_newbcast:6 row_mask:0xf bank_mask:0xf
v_and_b32_dpp v31, v23, v5 row_newbcast:6 row_mask:0xf bank_mask:0xf
s_waitcnt vmcnt(4)
v_mfma_f32_16x16x32_bf16 v[8:11], a[32:35], v[24:27], v[8:11]
v_and_b32_dpp v24, v23, v2 row_newbcast:10 row_mask:0xf bank_mask:0xf
v_and_b32_dpp v25, v23, v3 row_newbcast:10 row_mask:0xf bank_mask:0xf
v_and_b32_dpp v26, v23, v4 row_newbcast:10 row_mask:0xf bank_mask:0xf
v_and_b32_dpp v27, v23, v5 row_newbcast:10 row_mask:0xf bank_mask:0xf
v_mfma_f32_16x16x32_bf16 v[8:11], a[36:39], v[28:31], v[8:11]
v_and_b32_dpp v28, v23, v2 row_newbcast:14 row_mask:0xf bank_mask:0xf
v_and_b32_dpp v29, v23, v3 row_newbcast:14 row_mask:0xf bank_mask:0xf
v_and_b32_dpp v30, v23, v4 row_newbcast:14 row_mask:0xf bank_mask:0xf
v_and_b32_dpp v31, v23, v5 row_newbcast:14 row_mask:0xf bank_mask:0xf
v_mfma_f32_16x16x32_bf16 v[8:11], a[40:43], v[24:27], v[8:11]
s_nop 0
v_mfma_f32_16x16x32_bf16 v[8:11], a[44:47], v[28:31], v[8:11]
v_and_b32_dpp v24, v23, v2 row_newbcast:3 row_mask:0xf bank_mask:0xf
v_and_b32_dpp v25, v23, v3 row_newbcast:3 row_mask:0xf bank_mask:0xf
v_and_b32_dpp v26, v23, v4 row_newbcast:3 row_mask:0xf bank_mask:0xf
v_and_b32_dpp v27, v23, v5 row_newbcast:3 row_mask:0xf bank_mask:0xf
v_and_b32_dpp v28, v23, v2 row_newbcast:7 row_mask:0xf bank_mask:0xf
v_and_b32_dpp v29, v23, v3 row_newbcast:7 row_mask:0xf bank_mask:0xf
v_and_b32_dpp v30, v23, v4 row_newbcast:7 row_mask:0xf bank_mask:0xf
v_and_b32_dpp v31, v23, v5 row_newbcast:7 row_mask:0xf bank_mask:0xf
s_waitcnt vmcnt(0)
v_mfma_f32_16x16x32_bf16 v[8:11], a[48:51], v[24:27], v[8:11]
v_and_b32_dpp v24, v23, v2 row_newbcast:11 row_mask:0xf bank_mask:0xf
v_and_b32_dpp v25, v23, v3 row_newbcast:11 row_mask:0xf bank_mask:0xf
v_and_b32_dpp v26, v23, v4 row_newbcast:11 row_mask:0xf bank_mask:0xf
v_and_b32_dpp v27, v23, v5 row_newbcast:11 row_mask:0xf bank_mask:0xf
v_mfma_f32_16x16x32_bf16 v[8:11], a[52:55], v[28:31], v[8:11]
v_and_b32_dpp v28, v23, v2 row_newbcast:15 row_mask:0xf bank_mask:0xf
v_and_b32_dpp v29, v23, v3 row_newbcast:15 row_mask:0xf bank_mask:0xf
v_and_b32_dpp v30, v23, v4 row_newbcast:15 row_mask:0xf bank_mask:0xf
v_and_b32_dpp v31, v23, v5 row_newbcast:15 row_mask:0xf bank_mask:0xf
v_mfma_f32_16x16x32_bf16 v[8:11], a[56:59], v[24:27], v[8:11]
s_nop 0
v_mfma_f32_16x16x32_bf16 v[8:11], a[60:63], v[28:31], v[8:11]
s_branch CHAIN
FFN:
s_mov_b32 s57, 0x05040100
s_mov_b32 s58, 0x07060302
v_accvgpr_read_b32 v28, a224
v_accvgpr_read_b32 v29, a228
v_perm_b32 v12, v29, v28, s57
v_perm_b32 v13, v29, v28, s58
v_accvgpr_read_b32 v28, a225
v_accvgpr_read_b32 v29, a229
v_perm_b32 v14, v29, v28, s57
v_perm_b32 v15, v29, v28, s58
v_accvgpr_read_b32 v28, a226
v_accvgpr_read_b32 v29, a230
v_perm_b32 v16, v29, v28, s57
v_perm_b32 v17, v29, v28, s58
v_accvgpr_read_b32 v28, a227
v_accvgpr_read_b32 v29, a231
v_perm_b32 v18, v29, v28, s57
v_perm_b32 v19, v29, v28, s58
v_accvgpr_read_b32 v28, a232
v_accvgpr_read_b32 v29, a236
v_perm_b32 v20, v29, v28, s57
v_perm_b32 v21, v29, v28, s58
v_accvgpr_read_b32 v28, a233
v_accvgpr_read_b32 v29, a237
v_perm_b32 v22, v29, v28, s57
v_perm_b32 v23, v29, v28, s58
v_accvgpr_read_b32 v28, a234
v_accvgpr_read_b32 v29, a238
v_perm_b32 v24, v29, v28, s57
v_perm_b32 v25, v29, v28, s58
v_accvgpr_read_b32 v28, a235
v_accvgpr_read_b32 v29, a239
v_perm_b32 v26, v29, v28, s57
v_perm_b32 v27, v29, v28, s58
s_lshl_b32 s59, s49, 11
s_add_u32 s59, s59, 360448
PL_108:
buffer_load_dwordx4 v[8:11], v1, s[16:19], s59 offen sc1
buffer_load_dwordx4 v[28:31], v1, s[16:19], s59 offen offset:1024 sc1
buffer_load_dword v6, v42, s[16:19], s59 offen sc1
buffer_load_dword v7, v43, s[16:19], s59 offen sc1
s_waitcnt vmcnt(0)
v_or3_b32 v44, v6, v7, v8
v_or3_b32 v44, v9, v10, v44
v_or3_b32 v44, v11, v28, v44
v_or3_b32 v44, v29, v30, v44
v_or_b32 v44, v31, v44
v_and_b32 v44, s71, v44
v_cmp_ne_u32 vcc, 0, v44
s_cbranch_vccz PD_109
s_cmp_eq_u32 s54, 0
s_cbranch_scc1 PD_109
s_sub_u32 s54, s54, 1
s_sleep 1
s_branch PL_108
PD_109:
v_and_b32 v6, 0xffff0000, v6
v_and_b32 v7, 0xffff0000, v7
v_readfirstlane_b32 s57, v8
s_nop 1
v_subrev_f32 v8, s57, v8
v_subrev_f32 v9, s57, v9
v_subrev_f32 v10, s57, v10
v_subrev_f32 v11, s57, v11
v_subrev_f32 v28, s57, v28
v_subrev_f32 v29, s57, v29
v_subrev_f32 v30, s57, v30
v_subrev_f32 v31, s57, v31
v_add_f32 v44, v8, v9
v_mul_f32 v45, v8, v8
v_add_f32 v46, v10, v11
v_mul_f32 v47, v9, v9
v_add_f32 v44, v44, v28
v_add_f32 v46, v46, v29
v_add_f32 v44, v44, v30
v_add_f32 v46, v46, v31
v_fmac_f32 v45, v10, v10
v_fmac_f32 v47, v11, v11
v_fmac_f32 v45, v28, v28
v_fmac_f32 v47, v29, v29
v_fmac_f32 v45, v30, v30
v_fmac_f32 v47, v31, v31
v_add_f32 v44, v44, v46
v_add_f32 v45, v45, v47
s_nop 0
v_add_f32_dpp v44, v44, v44 row_ror:8 row_mask:0xf bank_mask:0xf
v_add_f32_dpp v45, v45, v45 row_ror:8 row_mask:0xf bank_mask:0xf
s_nop 0
v_add_f32_dpp v44, v44, v44 row_ror:4 row_mask:0xf bank_mask:0xf
v_add_f32_dpp v45, v45, v45 row_ror:4 row_mask:0xf bank_mask:0xf
s_nop 0
v_add_f32_dpp v44, v44, v44 row_ror:2 row_mask:0xf bank_mask:0xf
v_add_f32_dpp v45, v45, v45 row_ror:2 row_mask:0xf bank_mask:0xf
s_nop 0
v_add_f32_dpp v44, v44, v44 row_ror:1 row_mask:0xf bank_mask:0xf
v_add_f32_dpp v45, v45, v45 row_ror:1 row_mask:0xf bank_mask:0xf
s_nop 0
v_add_f32_dpp v44, v44, v44 row_bcast:15 row_mask:0xa bank_mask:0xf
v_add_f32_dpp v45, v45, v45 row_bcast:15 row_mask:0xa bank_mask:0xf
s_nop 0
v_add_f32_dpp v44, v44, v44 row_bcast:31 row_mask:0xc bank_mask:0xf
v_add_f32_dpp v45, v45, v45 row_bcast:31 row_mask:0xc bank_mask:0xf
v_readlane_b32 s58, v44, 63
v_readlane_b32 s59, v45, 63
v_mov_b32 v46, 0x3b000000
v_mul_f32 v44, s58, v46
v_mul_f32 v45, s59, v46
v_fma_f32 v45, -v44, v44, v45
v_add_f32 v44, s57, v44
v_max_f32 v45, 0, v45
v_cvt_pk_bf16_f32 v44, v44, v44
v_and_b32 v44, 0xffff0000, v44
v_cvt_pk_bf16_f32 v45, v45, v45
v_and_b32 v45, 0xffff0000, v45
v_add_f32 v45, 0x3727c5ac, v45
v_cvt_pk_bf16_f32 v45, v45, v45
v_and_b32 v45, 0xffff0000, v45
v_sqrt_f32 v45, v45
v_sub_f32 v6, v6, v44
v_sub_f32 v7, v7, v44
v_cvt_pk_bf16_f32 v45, v45, v45
v_and_b32 v45, 0xffff0000, v45
v_rcp_f32 v46, v45
v_cvt_pk_bf16_f32 v6, v6, v6
v_and_b32 v6, 0xffff0000, v6
v_cvt_pk_bf16_f32 v7, v7, v7
v_and_b32 v7, 0xffff0000, v7
v_mul_f32 v47, v6, v46
v_fma_f32 v6, -v47, v45, v6
v_fma_f32 v6, v6, v46, v47
v_mul_f32 v47, v7, v46
v_fma_f32 v7, -v47, v45, v7
v_fma_f32 v7, v7, v46, v47
v_cvt_pk_bf16_f32 v6, v6, v7
v_dot2_f32_bf16 v12, v12, v6, 0
v_dot2_f32_bf16 v13, v13, v6, 0
v_dot2_f32_bf16 v14, v14, v6, 0
v_dot2_f32_bf16 v15, v15, v6, 0
v_dot2_f32_bf16 v16, v16, v6, 0
v_dot2_f32_bf16 v17, v17, v6, 0
v_dot2_f32_bf16 v18, v18, v6, 0
v_dot2_f32_bf16 v19, v19, v6, 0
v_dot2_f32_bf16 v20, v20, v6, 0
v_dot2_f32_bf16 v21, v21, v6, 0
v_dot2_f32_bf16 v22, v22, v6, 0
v_dot2_f32_bf16 v23, v23, v6, 0
v_dot2_f32_bf16 v24, v24, v6, 0
v_dot2_f32_bf16 v25, v25, v6, 0
v_dot2_f32_bf16 v26, v26, v6, 0
v_dot2_f32_bf16 v27, v27, v6, 0
v_add_f32_dpp v12, v12, v12 row_ror:8 row_mask:0xf bank_mask:0x3
v_add_f32_dpp v13, v13, v13 row_ror:8 row_mask:0xf bank_mask:0x3
v_add_f32_dpp v14, v14, v14 row_ror:8 row_mask:0xf bank_mask:0x3
v_add_f32_dpp v15, v15, v15 row_ror:8 row_mask:0xf bank_mask:0x3
v_add_f32_dpp v16, v16, v16 row_ror:8 row_mask:0xf bank_mask:0x3
v_add_f32_dpp v17, v17, v17 row_ror:8 row_mask:0xf bank_mask:0x3
v_add_f32_dpp v18, v18, v18 row_ror:8 row_mask:0xf bank_mask:0x3
v_add_f32_dpp v19, v19, v19 row_ror:8 row_mask:0xf bank_mask:0x3
v_add_f32_dpp v12, v20, v20 row_ror:8 row_mask:0xf bank_mask:0xc
v_add_f32_dpp v13, v21, v21 row_ror:8 row_mask:0xf bank_mask:0xc
v_add_f32_dpp v14, v22, v22 row_ror:8 row_mask:0xf bank_mask:0xc
v_add_f32_dpp v15, v23, v23 row_ror:8 row_mask:0xf bank_mask:0xc
v_add_f32_dpp v16, v24, v24 row_ror:8 row_mask:0xf bank_mask:0xc
v_add_f32_dpp v17, v25, v25 row_ror:8 row_mask:0xf bank_mask:0xc
v_add_f32_dpp v18, v26, v26 row_ror:8 row_mask:0xf bank_mask:0xc
v_add_f32_dpp v19, v27, v27 row_ror:8 row_mask:0xf bank_mask:0xc
v_add_f32_dpp v12, v12, v12 row_half_mirror row_mask:0xf bank_mask:0x5
v_add_f32_dpp v13, v13, v13 row_half_mirror row_mask:0xf bank_mask:0x5
v_add_f32_dpp v14, v14, v14 row_half_mirror row_mask:0xf bank_mask:0x5
v_add_f32_dpp v15, v15, v15 row_half_mirror row_mask:0xf bank_mask:0x5
v_add_f32_dpp v12, v16, v16 row_half_mirror row_mask:0xf bank_mask:0xa
v_add_f32_dpp v13, v17, v17 row_half_mirror row_mask:0xf bank_mask:0xa
v_add_f32_dpp v14, v18, v18 row_half_mirror row_mask:0xf bank_mask:0xa
v_add_f32_dpp v15, v19, v19 row_half_mirror row_mask:0xf bank_mask:0xa
v_add_f32_dpp v12, v12, v12 quad_perm:[2,3,0,1] row_mask:0xf bank_mask:0xf
v_add_f32_dpp v13, v13, v13 quad_perm:[2,3,0,1] row_mask:0xf bank_mask:0xf
v_add_f32_dpp v14, v14, v14 quad_perm:[2,3,0,1] row_mask:0xf bank_mask:0xf
v_add_f32_dpp v15, v15, v15 quad_perm:[2,3,0,1] row_mask:0xf bank_mask:0xf
v_cndmask_b32 v12, v12, v14, s[66:67]
v_cndmask_b32 v13, v13, v15, s[66:67]
v_and_b32 v16, 15, v0
v_lshrrev_b32 v17, 4, v0
v_add_f32_dpp v12, v12, v12 quad_perm:[1,0,3,2] row_mask:0xf bank_mask:0xf
v_add_f32_dpp v13, v13, v13 quad_perm:[1,0,3,2] row_mask:0xf bank_mask:0xf
v_cndmask_b32 v12, v12, v13, s[68:69]
s_lshl_b32 s57, s3, 4
s_add_u32 s57, s57, 162048
v_lshlrev_b32 v16, 6, v16
v_lshl_add_u32 v16, v17, 2, v16
v_add_u32 v16, s57, v16
ds_write_b32 v16, v12
v_and_b32 v16, 1, v0
v_lshl_add_u32 v16, v16, 2, v17
v_and_b32 v18, 8, v0
v_add_u32 v16, v16, v18
v_lshlrev_b32 v16, 6, v16
v_add_u32 v16, 162048, v16
s_waitcnt lgkmcnt(0)
s_barrier
ds_read_b128 v[12:15], v16 offset:0
ds_read_b128 v[20:23], v16 offset:16
ds_read_b128 v[24:27], v16 offset:32
ds_read_b128 v[28:31], v16 offset:48
v_lshrrev_b32 v6, 5, v0
s_lshl_b32 s57, s3, 1
v_add_u32 v6, s57, v6
v_mul_u32_u24 v6, 44032, v6
v_bfe_u32 v7, v0, 4, 1
v_lshl_add_u32 v6, v7, 7, v6
v_and_b32 v7, 7, v0
v_lshl_add_u32 v6, v7, 4, v6
s_lshl_b32 s57, s50, 8
s_add_u32 s57, s57, 393216
s_waitcnt lgkmcnt(0)
v_add_f32 v12, v12, v20
v_add_f32 v24, v24, v28
v_add_f32 v13, v13, v21
v_add_f32 v25, v25, v29
v_add_f32 v14, v14, v22
v_add_f32 v26, v26, v30
v_add_f32 v15, v15, v23
v_add_f32 v27, v27, v31
v_add_f32 v12, v12, v24
v_add_f32 v13, v13, v25
v_add_f32 v14, v14, v26
v_add_f32 v15, v15, v27
v_add_f32 v12, v12, v13
v_add_f32 v14, v14, v15
v_add_f32 v12, v12, v14
v_cvt_pk_bf16_f32 v12, v12, v12
v_and_b32 v12, 0xffff0000, v12
s_nop 1
v_mul_f32_dpp v13, v12, v12 row_ror:8 row_mask:0xf bank_mask:0xf
v_cvt_pk_bf16_f32 v13, v13, v13
s_nop 1
v_and_b32_dpp v24, v13, v2 row_newbcast:0 row_mask:0xf bank_mask:0xf
v_and_b32_dpp v25, v13, v3 row_newbcast:0 row_mask:0xf bank_mask:0xf
v_and_b32_dpp v26, v13, v4 row_newbcast:0 row_mask:0xf bank_mask:0xf
v_and_b32_dpp v27, v13, v5 row_newbcast:0 row_mask:0xf bank_mask:0xf
v_and_b32_dpp v28, v13, v2 row_newbcast:1 row_mask:0xf bank_mask:0xf
v_and_b32_dpp v29, v13, v3 row_newbcast:1 row_mask:0xf bank_mask:0xf
v_and_b32_dpp v30, v13, v4 row_newbcast:1 row_mask:0xf bank_mask:0xf
v_and_b32_dpp v31, v13, v5 row_newbcast:1 row_mask:0xf bank_mask:0xf
v_mfma_f32_16x16x32_bf16 v[8:11], a[240:243], v[24:27], 0
s_nop 0
v_mfma_f32_16x16x32_bf16 v[8:11], a[244:247], v[28:31], v[8:11]
s_nop 7
v_and_or_b32 v8, v8, -4, s70
v_and_or_b32 v9, v9, -4, s70
v_and_or_b32 v10, v10, -4, s70
v_and_or_b32 v11, v11, -4, s70
s_mov_b32 exec_lo, 0x00ff00ff
s_mov_b32 exec_hi, 0x00ff00ff
buffer_store_dwordx4 v[8:11], v6, s[16:19], s57 offen sc1
s_mov_b64 exec, -1
s_branch AFTER_FFN
REDUCER:
s_cmp_lg_u32 s3, 1
s_cbranch_scc1 SK_110
s_lshl_b32 s57, s49, 13
s_add_u32 s57, s57, 294912
s_add_u32 s58, s57, 4096
PL_111:
buffer_load_dwordx4 v[8:11], v1, s[16:19], s57 offen offset:0 sc1
buffer_load_dwordx4 v[12:15], v1, s[16:19], s57 offen offset:1024 sc1
buffer_load_dwordx4 v[16:19], v1, s[16:19], s57 offen offset:2048 sc1
buffer_load_dwordx4 v[20:23], v1, s[16:19], s57 offen offset:3072 sc1
buffer_load_dwordx4 v[24:27], v1, s[16:19], s58 offen offset:0 sc1
buffer_load_dwordx4 v[28:31], v1, s[16:19], s58 offen offset:1024 sc1
buffer_load_dwordx4 a[224:227], v1, s[16:19], s58 offen offset:2048 sc1
buffer_load_dwordx4 a[228:231], v1, s[16:19], s58 offen offset:3072 sc1
s_waitcnt vmcnt(2)
v_or3_b32 v6, v8, v9, v10
v_or3_b32 v6, v11, v12, v6
v_or3_b32 v6, v13, v14, v6
v_or3_b32 v6, v15, v16, v6
v_or3_b32 v6, v17, v18, v6
v_or3_b32 v6, v19, v20, v6
v_or3_b32 v6, v21, v22, v6
v_or3_b32 v6, v23, v24, v6
v_or3_b32 v6, v25, v26, v6
v_or3_b32 v6, v27, v28, v6
v_or3_b32 v6, v29, v30, v6
v_or_b32 v6, v31, v6
v_add_f32 v8, v8, v12
v_add_f32 v9, v9, v13
v_add_f32 v10, v10, v14
v_add_f32 v11, v11, v15
v_add_f32 v8, v8, v16
v_add_f32 v9, v9, v17
v_add_f32 v10, v10, v18
v_add_f32 v11, v11, v19
v_add_f32 v8, v8, v20
v_add_f32 v9, v9, v21
v_add_f32 v10, v10, v22
v_add_f32 v11, v11, v23
v_add_f32 v8, v8, v24
v_add_f32 v9, v9, v25
v_add_f32 v10, v10, v26
v_add_f32 v11, v11, v27
v_add_f32 v8, v8, v28
v_add_f32 v9, v9, v29
v_add_f32 v10, v10, v30
v_add_f32 v11, v11, v31
s_waitcnt vmcnt(0)
v_accvgpr_read_b32 v12, a224
v_accvgpr_read_b32 v13, a225
v_accvgpr_read_b32 v14, a226
v_accvgpr_read_b32 v15, a227
v_accvgpr_read_b32 v16, a228
v_accvgpr_read_b32 v17, a229
v_accvgpr_read_b32 v18, a230
v_accvgpr_read_b32 v19, a231
v_or3_b32 v6, v12, v13, v6
v_or3_b32 v6, v14, v15, v6
v_or3_b32 v6, v16, v17, v6
v_or3_b32 v6, v18, v19, v6
v_and_b32 v6, s71, v6
v_cmp_ne_u32 vcc, 0, v6
s_cbranch_vccz PD_112
s_cmp_eq_u32 s54, 0
s_cbranch_scc1 PD_112
s_sub_u32 s54, s54, 1
s_branch PL_111
PD_112:
v_add_f32 v8, v8, v12
v_add_f32 v9, v9, v13
v_add_f32 v10, v10, v14
v_add_f32 v11, v11, v15
v_add_f32 v8, v8, v16
v_add_f32 v9, v9, v17
v_add_f32 v10, v10, v18
v_add_f32 v11, v11, v19
s_nop 0
v_permlane32_swap_b32 v8, v10
v_permlane32_swap_b32 v9, v11
v_add_f32 v8, v8, v10
v_add_f32 v9, v9, v11
s_nop 1
v_permlane16_swap_b32 v8, v9
v_add_f32 v8, v8, v9
v_cvt_pk_bf16_f32 v8, v8, v8
v_and_b32 v8, 0xffff0000, v8
v_add_f32 v8, v40, v8
v_cvt_pk_bf16_f32 v40, v8, v8
v_and_b32 v40, 0xffff0000, v40
v_or_b32 v8, s70, v40
v_or_b32 v9, s70, v40
v_and_b32 v12, 15, v0
v_lshrrev_b32 v13, 4, v0
v_permlane16_swap_b32 v8, v9
v_lshlrev_b32 v12, 4, v12
v_mov_b32 v10, v8
v_mov_b32 v11, v9
v_lshl_add_u32 v12, v13, 11, v12
s_lshl_b32 s57, s49, 8
v_permlane32_swap_b32 v8, v10
v_permlane32_swap_b32 v9, v11
s_add_u32 s57, s57, 360448
s_add_u32 s58, s57, 8192
buffer_store_dwordx4 v[8:11], v12, s[16:19], s57 offen sc1
buffer_store_dwordx4 v[8:11], v12, s[16:19], s58 offen sc1
SK_110:
s_mul_i32 s57, s49, 44032
s_add_u32 s57, s57, 393216
s_mul_i32 s58, s3, 11264
s_add_u32 s57, s57, s58
s_add_u32 s58, s57, 4096
s_add_u32 s59, s57, 8192
v_accvgpr_write_b32 a240, 0
v_accvgpr_write_b32 a241, 0
v_accvgpr_write_b32 a242, 0
v_accvgpr_write_b32 a243, 0
PL_113:
buffer_load_dwordx4 v[8:11], v1, s[16:19], s57 offen offset:0 sc1
buffer_load_dwordx4 v[12:15], v1, s[16:19], s57 offen offset:1024 sc1
buffer_load_dwordx4 v[16:19], v1, s[16:19], s57 offen offset:2048 sc1
buffer_load_dwordx4 v[20:23], v1, s[16:19], s57 offen offset:3072 sc1
buffer_load_dwordx4 v[24:27], v1, s[16:19], s58 offen offset:0 sc1
buffer_load_dwordx4 v[28:31], v1, s[16:19], s58 offen offset:1024 sc1
buffer_load_dwordx4 a[224:227], v1, s[16:19], s58 offen offset:2048 sc1
buffer_load_dwordx4 a[228:231], v1, s[16:19], s58 offen offset:3072 sc1
buffer_load_dwordx4 a[232:235], v1, s[16:19], s59 offen offset:0 sc1
buffer_load_dwordx4 a[236:239], v1, s[16:19], s59 offen offset:1024 sc1
s_cmp_eq_u32 s3, 3
s_cbranch_scc1 SK_115
buffer_load_dwordx4 a[240:243], v1, s[16:19], s59 offen offset:2048 sc1
SK_115:
s_waitcnt vmcnt(4)
v_or3_b32 v6, v8, v9, v10
v_or3_b32 v6, v11, v12, v6
v_or3_b32 v6, v13, v14, v6
v_or3_b32 v6, v15, v16, v6
v_or3_b32 v6, v17, v18, v6
v_or3_b32 v6, v19, v20, v6
v_or3_b32 v6, v21, v22, v6
v_or3_b32 v6, v23, v24, v6
v_or3_b32 v6, v25, v26, v6
v_or3_b32 v6, v27, v28, v6
v_or3_b32 v6, v29, v30, v6
v_or_b32 v6, v31, v6
v_add_f32 v8, v8, v12
v_add_f32 v9, v9, v13
v_add_f32 v10, v10, v14
v_add_f32 v11, v11, v15
v_add_f32 v8, v8, v16
v_add_f32 v9, v9, v17
v_add_f32 v10, v10, v18
v_add_f32 v11, v11, v19
v_add_f32 v8, v8, v20
v_add_f32 v9, v9, v21
v_add_f32 v10, v10, v22
v_add_f32 v11, v11, v23
v_add_f32 v8, v8, v24
v_add_f32 v9, v9, v25
v_add_f32 v10, v10, v26
v_add_f32 v11, v11, v27
v_add_f32 v8, v8, v28
v_add_f32 v9, v9, v29
v_add_f32 v10, v10, v30
v_add_f32 v11, v11, v31
s_waitcnt vmcnt(0)
v_accvgpr_read_b32 v12, a224
v_accvgpr_read_b32 v13, a225
v_accvgpr_read_b32 v14, a226
v_accvgpr_read_b32 v15, a227
v_accvgpr_read_b32 v16, a228
v_accvgpr_read_b32 v17, a229
v_accvgpr_read_b32 v18, a230
v_accvgpr_read_b32 v19, a231
v_accvgpr_read_b32 v20, a232
v_accvgpr_read_b32 v21, a233
v_accvgpr_read_b32 v22, a234
v_accvgpr_read_b32 v23, a235
v_accvgpr_read_b32 v24, a236
v_accvgpr_read_b32 v25, a237
v_accvgpr_read_b32 v26, a238
v_accvgpr_read_b32 v27, a239
v_accvgpr_read_b32 v28, a240
v_accvgpr_read_b32 v29, a241
v_accvgpr_read_b32 v30, a242
v_accvgpr_read_b32 v31, a243
v_or3_b32 v6, v12, v13, v6
v_or3_b32 v6, v14, v15, v6
v_or3_b32 v6, v16, v17, v6
v_or3_b32 v6, v18, v19, v6
v_or3_b32 v6, v20, v21, v6
v_or3_b32 v6, v22, v23, v6
v_or3_b32 v6, v24, v25, v6
v_or3_b32 v6, v26, v27, v6
v_or3_b32 v6, v28, v29, v6
v_or3_b32 v6, v30, v31, v6
v_and_b32 v6, s71, v6
v_cmp_ne_u32 vcc, 0, v6
s_cbranch_vccz PD_114
s_cmp_eq_u32 s54, 0
s_cbranch_scc1 PD_114
s_sub_u32 s54, s54, 1
s_sleep 1
s_branch PL_113
PD_114:
v_add_f32 v8, v8, v12
v_add_f32 v9, v9, v13
v_add_f32 v10, v10, v14
v_add_f32 v11, v11, v15
v_add_f32 v8, v8, v16
v_add_f32 v9, v9, v17
v_add_f32 v10, v10, v18
v_add_f32 v11, v11, v19
v_add_f32 v8, v8, v20
v_add_f32 v9, v9, v21
v_add_f32 v10, v10, v22
v_add_f32 v11, v11, v23
v_add_f32 v8, v8, v24
v_add_f32 v9, v9, v25
v_add_f32 v10, v10, v26
v_add_f32 v11, v11, v27
v_add_f32 v8, v8, v28
v_add_f32 v9, v9, v29
v_add_f32 v10, v10, v30
v_add_f32 v11, v11, v31
s_nop 0
v_permlane32_swap_b32 v8, v10
v_permlane32_swap_b32 v9, v11
v_add_f32 v8, v8, v10
v_add_f32 v9, v9, v11
s_nop 1
v_permlane16_swap_b32 v8, v9
v_add_f32 v8, v8, v9
s_lshl_b32 s57, s3, 8
s_add_u32 s57, s57, 162048
v_lshl_add_u32 v12, v0, 2, s57
v_lshlrev_b32 v14, 2, v0
v_add_u32 v13, 162048, v14
ds_write_b32 v12, v8
s_waitcnt lgkmcnt(0)
s_barrier
s_cmp_lg_u32 s3, 1
s_cbranch_scc1 RED_DONE
ds_read_b32 v8, v13 offset:0
ds_read_b32 v9, v13 offset:256
ds_read_b32 v10, v13 offset:512
ds_read_b32 v11, v13 offset:768
s_waitcnt lgkmcnt(0)
v_add_f32 v8, v8, v9
v_add_f32 v10, v10, v11
v_add_f32 v8, v8, v10
v_cvt_pk_bf16_f32 v8, v8, v8
v_and_b32 v8, 0xffff0000, v8
v_add_f32 v8, v40, v8
v_cvt_pk_bf16_f32 v40, v8, v8
v_and_b32 v40, 0xffff0000, v40
s_cmp_lg_u32 s53, 0
s_cbranch_scc1 OUTPUT
v_or_b32 v8, s70, v40
v_or_b32 v9, s70, v40
v_and_b32 v12, 15, v0
v_lshrrev_b32 v13, 4, v0
v_permlane16_swap_b32 v8, v9
v_lshlrev_b32 v12, 4, v12
v_mov_b32 v10, v8
v_mov_b32 v11, v9
v_lshl_add_u32 v12, v13, 11, v12
s_lshl_b32 s57, s49, 8
v_permlane32_swap_b32 v8, v10
v_permlane32_swap_b32 v9, v11
s_add_u32 s57, s57, 376832
s_add_u32 s58, s57, 8192
buffer_store_dwordx4 v[8:11], v12, s[16:19], s57 offen sc1
buffer_store_dwordx4 v[8:11], v12, s[16:19], s58 offen sc1
RED_DONE:
s_cmp_lg_u32 s53, 0
s_cbranch_scc0 WAIT_X2
s_branch FINISH
OUTPUT:
s_mov_b32 s4, s42
s_and_b32 s5, s43, 0xffff
s_mov_b32 s6, 0x400
s_mov_b32 s7, 0x20000
v_and_b32 v12, 7, v0
v_bfe_u32 v13, v0, 3, 1
v_lshl_add_u32 v12, v13, 5, v12
v_lshrrev_b32 v13, 4, v0
v_lshl_add_u32 v12, v13, 3, v12
s_lshl_b32 s57, s49, 6
v_add_u32 v12, s57, v12
v_lshlrev_b32 v12, 1, v12
v_lshrrev_b32 v8, 16, v40
buffer_store_short v8, v12, s[4:7], 0 offen
s_branch FINISH
FINISH:
END:
s_endpgm
CTR_SLOW:
s_cmp_eq_u32 s54, 0
s_cbranch_scc1 CTR_OK
s_sub_u32 s54, s54, 1
s_sleep 24
global_load_dword v7, v6, s[44:45] sc1
s_waitcnt vmcnt(0)
v_cmp_gt_u32 vcc, 1, v7
s_cbranch_vccnz CTR_SLOW
s_branch CTR_OK
QG_SLOW:
PL_9:
buffer_load_dwordx4 v[16:19], v6, s[16:19], s60 offen offset:0 sc1
buffer_load_dwordx4 v[20:23], v6, s[16:19], s60 offen offset:16 sc1
buffer_load_dwordx4 v[24:27], v6, s[16:19], s60 offen offset:512 sc1
buffer_load_dwordx4 v[28:31], v6, s[16:19], s60 offen offset:528 sc1
s_waitcnt vmcnt(0)
v_or3_b32 v7, v16, v17, v18
v_or3_b32 v7, v19, v20, v7
v_or3_b32 v7, v21, v22, v7
v_or3_b32 v7, v23, v24, v7
v_or3_b32 v7, v25, v26, v7
v_or3_b32 v7, v27, v28, v7
v_or3_b32 v7, v29, v30, v7
v_or_b32 v7, v31, v7
v_and_b32 v7, s71, v7
v_cmp_ne_u32 vcc, 0, v7
s_cbranch_vccz QG_OK
s_cmp_eq_u32 s54, 0
s_cbranch_scc1 QG_OK
s_sub_u32 s54, s54, 1
s_sleep 8
s_branch PL_9
LV_17_SLOW:
s_cmp_eq_u32 s54, 0
s_cbranch_scc1 LV_17_OK
s_sub_u32 s54, s54, 1
s_sleep 16
s_load_dword s20, s[0:1], 0 glc
s_waitcnt lgkmcnt(0)
s_cmp_lt_i32 s20, 1
s_cbranch_scc1 LV_17_SLOW
s_branch LV_17_OK
RS_18:
s_call_b64 s[64:65], RESCALE
s_branch RB_19
RS_20:
s_call_b64 s[64:65], RESCALE
s_branch RB_21
RS_22:
s_call_b64 s[64:65], RESCALE
s_branch RB_23
RS_27:
s_call_b64 s[64:65], RESCALE
s_branch RB_28
RS_33:
s_call_b64 s[64:65], RESCALE
s_branch RB_34
RS_35:
s_call_b64 s[64:65], RESCALE
s_branch RB_36
LV_37_SLOW:
s_cmp_eq_u32 s54, 0
s_cbranch_scc1 LV_37_OK
s_sub_u32 s54, s54, 1
s_sleep 16
s_load_dword s20, s[0:1], 0 glc
s_waitcnt lgkmcnt(0)
s_cmp_lt_i32 s20, 2
s_cbranch_scc1 LV_37_SLOW
s_branch LV_37_OK
RS_38:
s_call_b64 s[64:65], RESCALE
s_branch RB_39
RS_45:
s_call_b64 s[64:65], RESCALE
s_branch RB_46
ALL2_SLOW:
s_cmp_eq_u32 s54, 0
s_cbranch_scc1 ALL2_OK
s_sub_u32 s54, s54, 1
s_sleep 24
buffer_load_dword v19, v18, s[16:19], 0 offen sc1
s_waitcnt vmcnt(0)
v_cmp_eq_u32 vcc, -1, v19
s_cbranch_vccnz ALL2_SLOW
s_branch ALL2_OK
LV_47_SLOW:
s_cmp_eq_u32 s54, 0
s_cbranch_scc1 LV_47_OK
s_sub_u32 s54, s54, 1
s_sleep 16
s_load_dword s20, s[0:1], 0 glc
s_load_dword s21, s[0:1], 128 glc
s_load_dword s22, s[0:1], 256 glc
s_load_dword s23, s[0:1], 384 glc
s_load_dword s34, s[0:1], 512 glc
s_load_dword s35, s[0:1], 640 glc
s_load_dword s72, s[0:1], 768 glc
s_load_dword s74, s[0:1], 896 glc
s_waitcnt lgkmcnt(0)
s_min_i32 s20, s20, s21
s_min_i32 s20, s20, s22
s_min_i32 s20, s20, s23
s_min_i32 s20, s20, s34
s_min_i32 s20, s20, s35
s_min_i32 s20, s20, s72
s_min_i32 s20, s20, s74
s_cmp_lt_i32 s20, 2
s_cbranch_scc1 LV_47_SLOW
s_branch LV_47_OK
RS_50:
s_call_b64 s[64:65], RESCALE
s_branch RB_51
RS_54:
s_call_b64 s[64:65], RESCALE
s_branch RB_55
RS_56:
s_call_b64 s[64:65], RESCALE
s_branch RB_57
LV_71_SLOW:
s_cmp_eq_u32 s54, 0
s_cbranch_scc1 LV_71_OK
s_sub_u32 s54, s54, 1
s_sleep 16
s_load_dword s20, s[0:1], 0 glc
s_waitcnt lgkmcnt(0)
s_cmp_lt_i32 s20, 3
s_cbranch_scc1 LV_71_SLOW
s_branch LV_71_OK
RS_73:
s_call_b64 s[64:65], RESCALE
s_branch RB_74
RS_75:
s_call_b64 s[64:65], RESCALE
s_branch RB_76
RS_77:
s_call_b64 s[64:65], RESCALE
s_branch RB_78
RS_81:
s_call_b64 s[64:65], RESCALE
s_branch RB_82
LV_83_SLOW:
s_cmp_eq_u32 s54, 0
s_cbranch_scc1 LV_83_OK
s_sub_u32 s54, s54, 1
s_sleep 16
s_load_dword s20, s[0:1], 0 glc
s_waitcnt lgkmcnt(0)
s_cmp_lt_i32 s20, 4
s_cbranch_scc1 LV_83_SLOW
s_branch LV_83_OK
RS_84:
s_call_b64 s[64:65], RESCALE
s_branch RB_85
RS_86:
s_call_b64 s[64:65], RESCALE
s_branch RB_87
RS_88:
s_call_b64 s[64:65], RESCALE
s_branch RB_89
RS_90:
s_call_b64 s[64:65], RESCALE
s_branch RB_91
RS_92:
s_call_b64 s[64:65], RESCALE
s_branch RB_93
RS_94:
s_call_b64 s[64:65], RESCALE
s_branch RB_95
RS_96:
s_call_b64 s[64:65], RESCALE
s_branch RB_97
LV_98_SLOW:
s_cmp_eq_u32 s54, 0
s_cbranch_scc1 LV_98_OK
s_sub_u32 s54, s54, 1
s_sleep 16
s_load_dword s20, s[0:1], 0 glc
s_load_dword s21, s[0:1], 128 glc
s_load_dword s22, s[0:1], 256 glc
s_load_dword s23, s[0:1], 384 glc
s_load_dword s34, s[0:1], 512 glc
s_load_dword s35, s[0:1], 640 glc
s_load_dword s72, s[0:1], 768 glc
s_load_dword s74, s[0:1], 896 glc
s_waitcnt lgkmcnt(0)
s_min_i32 s20, s20, s21
s_min_i32 s20, s20, s22
s_min_i32 s20, s20, s23
s_min_i32 s20, s20, s34
s_min_i32 s20, s20, s35
s_min_i32 s20, s20, s72
s_min_i32 s20, s20, s74
s_cmp_lt_i32 s20, 4
s_cbranch_scc1 LV_98_SLOW
s_branch LV_98_OK
RS_100:
s_call_b64 s[64:65], RESCALE
s_branch RB_101
RS_104:
s_call_b64 s[64:65], RESCALE
s_branch RB_105
RS_106:
s_call_b64 s[64:65], RESCALE
s_branch RB_107
RESCALE:
v_mul_f32 v20, 0x3e0293ee, v22
s_nop 1
v_max_f32_dpp v20, v20, v20 row_ror:8 row_mask:0xf bank_mask:0xf
s_nop 1
v_max_f32_dpp v20, v20, v20 row_ror:4 row_mask:0xf bank_mask:0xf
s_nop 1
v_max_f32_dpp v20, v20, v20 row_ror:2 row_mask:0xf bank_mask:0xf
s_nop 1
v_max_f32_dpp v20, v20, v20 row_ror:1 row_mask:0xf bank_mask:0xf
s_nop 1
v_max_f32_dpp v20, v20, v20 row_bcast:15 row_mask:0xa bank_mask:0xf
s_nop 1
v_max_f32_dpp v20, v20, v20 row_bcast:31 row_mask:0xc bank_mask:0xf
s_nop 0
v_readlane_b32 s58, v20, 63
s_nop 1
v_add_f32 v21, s58, v6
v_exp_f32 v21, -v21
v_mov_b32 v6, s58
v_xor_b32 v6, 0x80000000, v6
v_mul_f32 v7, v21, v7
v_mul_f32 v8, v21, v8
v_mul_f32 v9, v21, v9
v_mul_f32 v10, v21, v10
v_mul_f32 v11, v21, v11
v_fmamk_f32 v23, v22, 0x3e0293ee, v6
s_setpc_b64 s[64:65]
CODE_END:
.section .rodata,"a"
.p2align 6
.amdhsa_kernel interleave_layers__gqa_block_cached__glu_gated_bilinear__decode_kernel
  .amdhsa_next_free_vgpr 512
  .amdhsa_next_free_sgpr 102
  .amdhsa_accum_offset 256
  .amdhsa_group_segment_fixed_size 0
  .amdhsa_kernarg_size 96
  .amdhsa_user_sgpr_count 2
  .amdhsa_user_sgpr_kernarg_segment_ptr 1
  .amdhsa_system_sgpr_workgroup_id_x 1
  .amdhsa_float_denorm_mode_32 3
.end_amdhsa_kernel
```
